```python
import torch

def _softmax(x, axis=-1):
    return torch.softmax(x, dim=axis)

def _gelu(x):
    return torch.nn.functional.gelu(x, approximate='tanh')

def _silu(x):
    return torch.nn.functional.silu(x)

def _sigmoid(x):
    return torch.sigmoid(x)

def _layernorm(x, axis=-1, eps=1e-05):
    m = x.mean(dim=axis, keepdim=True)
    v = x.var(dim=axis, keepdim=True, unbiased=False)
    return (x - m) / torch.sqrt(v + eps)

def _scatter_add(tgt, idx, src, axis=0):
    return tgt.clone().index_add_(axis, idx, src)

def _segment_sum(src, seg, n):
    out = torch.zeros((n,) + src.shape[1:], dtype=src.dtype)
    return out.index_add_(0, seg, src)

def _pad(x, pw):
    flat = tuple((v for pair in reversed(pw) for v in pair))
    return torch.nn.functional.pad(x, flat)
kernel_name = 'interleave_layers__spectral_fnet__mixer_gmlp__prompt'

def setup_inputs():

    _w = lambda a: (lambda t: t.to(torch.bfloat16) if t.is_floating_point() else t)(torch.as_tensor(a))

    def _A_setup():
        B, S, D = (1, 2048, 448)
        ns = torch.arange(S)[:, None] * torch.arange(S)[None, :]
        nd = torch.arange(D)[:, None] * torch.arange(D)[None, :]
        Ws_re = torch.cos(-2.0 * torch.pi * ns / S).to(float)
        Ws_im = torch.sin(-2.0 * torch.pi * ns / S).to(float)
        Wd_re = torch.cos(-2.0 * torch.pi * nd / D).to(float)
        Wd_im = torch.sin(-2.0 * torch.pi * nd / D).to(float)
        return {'x': _w((lambda *s: torch.randn(*s, dtype=torch.bfloat16) * 0.05)(B, S, D)), 'dft_seq_re': _w(Ws_re), 'dft_seq_im': _w(Ws_im), 'dft_hid_re': _w(Wd_re), 'dft_hid_im': _w(Wd_im)}
    _A_in = _A_setup()

    def _B_setup():
        B, S, D, F = (1, 2048, 448, 1792)
        Fh = F // 2
        return {'x': _w((lambda *s: torch.randn(*s, dtype=torch.bfloat16) * 0.05)(B, S, D)), 'w_in': _w((lambda *s: torch.randn(*s, dtype=torch.bfloat16) * 1.6)(D, 2 * Fh)), 'w_sp': _w(0.01 * (lambda *s: torch.randn(*s, dtype=torch.bfloat16) * 1.6)(S, S)), 'b_sp': _w(1.0 + 0.01 * (lambda *s: torch.randn(*s, dtype=torch.bfloat16) * 1.6)(S)), 'w_out': _w((lambda *s: torch.randn(*s, dtype=torch.bfloat16) * 1.6)(Fh, D))}
    _B_in = _B_setup()
    return {'A_x': _A_in['x'], 'A_dft_seq_re': _A_in['dft_seq_re'], 'A_dft_seq_im': _A_in['dft_seq_im'], 'A_dft_hid_re': _A_in['dft_hid_re'], 'A_dft_hid_im': _A_in['dft_hid_im'], 'B_x': _B_in['x'], 'B_w_in': _B_in['w_in'], 'B_w_sp': _B_in['w_sp'], 'B_b_sp': _B_in['b_sp'], 'B_w_out': _B_in['w_out']}

def reference(A_x, A_dft_seq_re, A_dft_seq_im, A_dft_hid_re, A_dft_hid_im, B_x, B_w_in, B_w_sp, B_b_sp, B_w_out):

    def _A_ref(x, dft_seq_re, dft_seq_im, dft_hid_re, dft_hid_im):
        a = torch.einsum('bsd,ed->bse', x, dft_hid_re)
        b = torch.einsum('bsd,ed->bse', x, dft_hid_im)
        y = torch.einsum('ts,bse->bte', dft_seq_re, a) - torch.einsum('ts,bse->bte', dft_seq_im, b)
        return y

    def _B_ref(x, w_in, w_sp, b_sp, w_out):
        B, S, D = x.shape
        F = w_in.shape[-1]
        Fh = F // 2
        z = _gelu(torch.einsum('bsd,df->bsf', x, w_in))
        z1 = z[..., :Fh].clone()
        z2 = _layernorm(z[..., Fh:], axis=-1)
        g = torch.einsum('ts,bsf->btf', w_sp, z2) + b_sp[None, :, None]
        return torch.einsum('bsf,fd->bsd', z1 * g, w_out)
    x = A_x
    x = x + _A_ref(_layernorm(x, axis=-1), A_dft_seq_re, A_dft_seq_im, A_dft_hid_re, A_dft_hid_im)
    x = x + _B_ref(_layernorm(x, axis=-1), B_w_in, B_w_sp, B_b_sp, B_w_out)
    x = x + _A_ref(_layernorm(x, axis=-1), A_dft_seq_re, A_dft_seq_im, A_dft_hid_re, A_dft_hid_im)
    x = x + _B_ref(_layernorm(x, axis=-1), B_w_in, B_w_sp, B_b_sp, B_w_out)
    return x
```

```asm
; @launch grid=(256,1,1) block=(256,1,1) lds=163840
.amdgcn_target "amdgcn-amd-amdhsa--gfx950"
.text
.globl interleave_layers__spectral_fnet__mixer_gmlp__prompt_kernel
.p2align 8
.type interleave_layers__spectral_fnet__mixer_gmlp__prompt_kernel,@function
interleave_layers__spectral_fnet__mixer_gmlp__prompt_kernel:
    s_cmp_ge_u32 s2, 256
    s_cbranch_scc1 done
    s_load_dwordx16 s[36:51], s[0:1], 0
    s_load_dwordx8 s[52:59], s[0:1], 64
    s_load_dwordx2 s[8:9], s[0:1], 96
    s_getpc_b64 s[32:33]
codebase:
    s_mov_b32 s34, codeend-codebase
    s_mov_b32 s35, 0x00020000
    s_lshr_b32 s76, s2, 3
    v_lshrrev_b32 v8, 6, v0
    v_and_b32 v0, 63, v0
    v_readfirstlane_b32 s62, v8
    v_and_b32 v1, 15, v0
    v_lshrrev_b32 v2, 4, v0
    s_lshl_b32 s77, s76, 2
    s_add_u32 s77, s77, s62
    s_lshl_b32 s77, s77, 9
    v_lshl_add_u32 v8, v0, 7, s77
    s_mov_b64 exec, 15
    buffer_load_dword v255, v8, s[32:35], 0 offen
    s_mov_b64 exec, -1
    v_mov_b32 v3, 0
    v_lshlrev_b32 v56, 4, v0
    v_lshlrev_b32 v58, 3, v0
    s_and_b32 s67, s2, 7
    s_lshr_b32 s77, s76, 2
    s_and_b32 s76, s76, 3
    s_lshl_b32 s76, s76, 3
    s_add_u32 s76, s76, s77
    s_and_b32 s63, s76, 7
    s_lshr_b32 s90, s76, 3
    s_lshr_b32 s77, s76, 4
    s_lshl_b32 s78, s67, 1
    s_add_u32 s77, s77, s78
    s_sub_u32 s78, 32, s77
    s_cmp_eq_u32 s77, 0
    s_cselect_b32 s78, 16, s78
    s_bitcmp1_b32 s76, 3
    s_cselect_b32 s64, s78, s77
    s_sub_u32 s69, 64, s64
    s_cmp_eq_u32 s64, 0
    s_cselect_b32 s69, 32, s69
    s_cmp_ge_u32 s62, 2
    s_cselect_b32 s66, s69, s64
    s_and_b32 s77, s62, 1
    s_lshl_b32 s77, s77, 10
    s_add_u32 s68, s66, s77
    s_mov_b32 s65, 0
    s_lshl_b32 s91, s62, 10
    s_lshl_b32 s92, s62, 11
    s_mul_i32 s94, s62, 14336
    v_xor_b32 v20, v0, v2
    v_and_b32 v20, 7, v20
    v_lshlrev_b32 v20, 4, v20
    v_xor_b32 v21, 64, v20
    v_xor_b32 v22, v0, v2
    v_and_b32 v22, 7, v22
    v_lshlrev_b32 v22, 4, v22
    v_xor_b32 v23, 64, v22
    v_lshrrev_b32 v252, 3, v0
    v_lshl_add_u32 v252, v252, 6, s68
    v_mul_u32_u24 v252, 896, v252
    v_add_u32 v20, v20, v252
    v_add_u32 v21, v21, v252
    v_add_u32 v21, 458752, v21
    s_and_b32 s76, s62, 1
    s_lshl_b32 s77, s63, 2
    s_add_u32 s76, s76, s77
    s_lshl_b32 s76, s76, 3
    s_add_u32 s76, s76, 1
    v_lshrrev_b32 v252, 5, v0
    v_lshl_add_u32 v252, v252, 4, s76
    v_bfe_u32 v253, v0, 3, 2
    v_add_u32 v252, v252, v253
    v_mul_u32_u24 v252, 896, v252
    v_add_u32 v22, v22, v252
    v_add_u32 v23, v23, v252
    v_add_u32 v23, 3584, v23
    v_lshl_add_u32 v160, v1, 6, s68
    v_lshlrev_b32 v160, 1, v160
    v_lshrrev_b32 v252, 5, v0
    s_lshl_b32 s76, s63, 1
    v_add_u32 v252, s76, v252
    v_lshl_add_u32 v252, v252, 6, s68
    v_and_b32 v161, 31, v0
    v_lshlrev_b32 v161, 7, v161
    v_lshl_add_u32 v252, v252, 12, v161
    s_mov_b32 s6, 1835008
    s_mov_b32 s7, 0x00020000
    s_mov_b32 s14, 401408
    s_mov_b32 s15, 0x00020000
    s_mov_b32 s10, 268435456
    s_mov_b32 s11, 0x00020000
    s_mov_b32 s18, 1605632
    s_mov_b32 s19, 0x00020000
    s_mov_b32 s22, 8388608
    s_mov_b32 s23, 0x00020000
    s_mov_b32 s30, 4096
    s_mov_b32 s31, 0x00020000
    s_cmp_ge_u32 s62, 2
    s_waitcnt lgkmcnt(0)
    s_cselect_b32 s12, s44, s42
    s_cselect_b32 s13, s45, s43
    s_cmp_eq_u32 s63, 7
    s_cbranch_scc1 rp_entry
    s_add_u32 m0, s92, 106496
    s_nop 0
    buffer_load_dwordx4 v22, s[12:15], 0 offen offset:0 lds
    s_add_u32 m0, s92, 107520
    s_nop 0
    buffer_load_dwordx4 v23, s[12:15], 0 offen offset:0 lds
    s_add_u32 m0, s92, 114560
    s_nop 0
    buffer_load_dwordx4 v22, s[12:15], 0 offen offset:128 lds
    s_add_u32 m0, s92, 115584
    s_nop 0
    buffer_load_dwordx4 v23, s[12:15], 0 offen offset:128 lds
    s_add_u32 m0, s92, 122624
    s_nop 0
    buffer_load_dwordx4 v22, s[12:15], 0 offen offset:256 lds
    s_add_u32 m0, s92, 123648
    s_nop 0
    buffer_load_dwordx4 v23, s[12:15], 0 offen offset:256 lds
    s_add_u32 m0, s92, 130688
    s_nop 0
    buffer_load_dwordx4 v22, s[12:15], 0 offen offset:384 lds
    s_add_u32 m0, s92, 131712
    s_nop 0
    buffer_load_dwordx4 v23, s[12:15], 0 offen offset:384 lds
    s_mov_b64 s[20:21], s[50:51]
    s_lshr_b64 exec, -1, 32
    buffer_load_dword v254, v252, s[20:23], 0 offen
    s_mov_b64 exec, -1
    s_mov_b64 s[4:5], s[36:37]
    s_mov_b64 s[16:17], s[48:49]
    s_mov_b64 s[20:21], s[50:51]
    s_mov_b64 s[28:29], s[52:53]
    s_mov_b64 s[24:25], s[54:55]
    s_mov_b32 s32, s58
    s_mov_b32 s33, s59
    s_mov_b32 s34, 256
    s_lshl_b32 s76, s64, 2
    s_add_u32 s76, s76, s62
    s_bfe_u32 s77, s76, 0x10005
    s_lshl_b32 s88, s76, 3
    s_add_u32 s88, s88, s77
    s_lshl_b32 s88, s88, 13
    s_add_u32 s88, s88, 16777216
    s_add_u32 s89, s88, 53248
    s_lshl_b32 s77, s63, 7
    s_add_u32 s51, s89, s77
    s_lshl_b32 s50, s62, 19
    s_and_b32 s77, s63, 6
    s_add_u32 s77, s77, s63
    s_lshl_b32 s77, s77, 12
    s_add_u32 s50, s50, s77
    s_lshl_b32 s77, s64, 7
    s_add_u32 s50, s50, s77
    s_add_u32 s50, s50, 41943040
    s_mov_b32 s1, 0
    s_cmp_eq_u32 s62, 0
    s_cselect_b32 s46, 0xff, 0
    s_mov_b32 s47, 0
    s_mov_b32 s74, 0x05040100
    s_mov_b32 s75, 0x07060302
    s_mov_b32 s38, 0x100001
    s_mov_b32 s39, 0x10000100
    s_mov_b32 s40, 0x200002
    s_mov_b32 s41, 0x20000200
    s_mov_b32 s42, 0x400004
    s_mov_b32 s43, 0x40000400
    s_mov_b32 s44, 0x800008
    s_mov_b32 s45, 0x80000800
    v_mov_b32 v60, 0x3f803f80
    v_mov_b32 v61, 0x3f803f80
    v_mov_b32 v62, 0x3f803f80
    v_mov_b32 v63, 0x3f803f80
    v_lshrrev_b32 v162, 3, v0
    v_and_b32 v163, 0x70, v56
    s_mul_i32 s95, s62, 8448
    s_add_u32 s95, s95, 57344
    v_lshrrev_b32 v170, 2, v0
    v_lshl_add_u32 v170, v170, 7, s95
    v_and_b32 v171, 3, v0
    s_min_u32 s76, s64, 27
    s_cmp_ge_u32 s62, 2
    s_cbranch_scc1 ul_wo
    v_lshl_add_u32 v170, v171, 3, v170
    v_add_u32 v171, 32, v170
    s_lshl_b32 s82, s76, 7
    v_add_u32 v163, s82, v163
    s_lshl_b32 s77, s63, 1
    s_add_u32 s77, s77, s62
    s_mul_i32 s3, s77, 114688
    s_cmp_ge_u32 s77, 7
    s_cselect_b32 s82, 7, 0
    s_cselect_b32 s83, 0, 32256
    s_cselect_b32 s84, 25088, 0
    v_xor_b32 v162, s82, v162
    v_mul_u32_u24 v162, 3584, v162
    v_add_u32 v156, v162, v163
    s_add_u32 s73, s3, s83
    s_add_u32 s3, s3, s84
    s_add_u32 s3, s3, 3584
    v_add_u32 v162, s73, v162
    v_cmp_ne_u32 vcc, 802816, v162
    s_add_u32 s26, s3, 57344
    s_add_u32 s27, s73, 57344
    v_cndmask_b32 v162, 0, v162, vcc
    v_add_u32 v157, v162, v163
    s_lshl_b32 s76, s76, 2
    s_cmp_ge_u32 s76, 56
    s_cselect_b32 s82, 56, 0
    s_cselect_b32 s83, 0, 114688
    s_sub_u32 s76, s76, s82
    s_mul_i32 s77, s77, 7
    s_add_u32 s77, s77, s76
    s_lshl_b32 s77, s77, 10
    s_add_u32 s77, s77, s83
    s_mul_i32 s76, s76, 37
    s_add_u32 s82, s76, 0
    s_lshr_b32 s82, s82, 8
    s_mul_i32 s82, s82, 533504
    s_add_u32 s82, s82, s77
    s_add_u32 s52, s82, 50331648
    s_add_u32 s82, s76, 37
    s_lshr_b32 s82, s82, 8
    s_mul_i32 s82, s82, 533504
    s_add_u32 s82, s82, s77
    s_add_u32 s53, s82, 50332672
    s_add_u32 s82, s76, 74
    s_lshr_b32 s82, s82, 8
    s_mul_i32 s82, s82, 533504
    s_add_u32 s82, s82, s77
    s_add_u32 s54, s82, 50333696
    s_add_u32 s82, s76, 111
    s_lshr_b32 s82, s82, 8
    s_mul_i32 s82, s82, 533504
    s_add_u32 s82, s82, s77
    s_add_u32 s55, s82, 50334720
    s_branch ul_done
ul_wo:
    v_lshl_add_u32 v170, v171, 4, v170
    v_add_u32 v171, 8, v170
    s_and_b32 s77, s76, 7
    s_lshr_b32 s82, s76, 3
    s_cmp_ge_u32 s76, 24
    s_cselect_b32 s83, 2, 1
    s_cselect_b32 s84, 112, 16
    s_mul_i32 s77, s77, s83
    s_mul_i32 s77, s77, 100352
    s_mul_i32 s82, s82, 28672
    s_add_u32 s3, s77, s82
    s_lshl_b32 s77, s63, 7
    s_add_u32 s3, s3, s77
    s_mul_i32 s84, s84, 896
    s_add_u32 s26, s3, s84
    s_add_u32 s27, s26, 7168
    s_add_u32 s73, s3, 7168
    v_mul_u32_u24 v162, 896, v162
    v_add_u32 v156, v162, v163
    v_add_u32 v157, s73, v156
    s_mov_b32 s16, s24
    s_mov_b32 s17, s25
    s_mov_b32 s18, 802816
    s_andn2_b32 s77, s76, 1
    s_add_u32 s76, s76, s77
    s_and_b32 s77, s62, 1
    s_lshl_b32 s77, s77, 1
    s_add_u32 s76, s76, s77
    s_lshl_b32 s77, s63, 6
    s_add_u32 s76, s76, s77
    s_lshl_b32 s76, s76, 12
    s_add_u32 s52, s76, 54525952
    s_add_u32 s53, s76, 54526976
    s_add_u32 s54, s76, 54528000
    s_add_u32 s55, s76, 54529024
ul_done:
    v_lshrrev_b32 v10, 1, v1
    v_xor_b32 v10, v10, v2
    v_lshlrev_b32 v10, 4, v10
    v_lshl_add_u32 v10, v1, 7, v10
    v_add_u32 v8, s94, v10
    v_xor_b32 v9, 64, v8
    v_add_u32 v10, 106496, v10
    v_xor_b32 v11, 64, v10
    v_bfe_u32 v12, v1, 1, 2
    v_lshrrev_b32 v16, 3, v1
    v_lshlrev_b32 v16, 1, v16
    v_xor_b32 v12, v12, v16
    v_xor_b32 v12, v12, v2
    v_lshlrev_b32 v12, 4, v12
    v_lshl_add_u32 v12, v1, 6, v12
    s_add_u32 s76, s91, 98304
    v_add_u32 v12, s76, v12
    v_bfe_u32 v16, v0, 1, 1
    v_bfe_u32 v17, v0, 3, 1
    v_xor_b32 v16, v16, v17
    v_and_b32 v17, 1, v2
    v_lshl_add_u32 v16, v17, 1, v16
    v_and_b32 v17, 1, v0
    v_lshl_add_u32 v16, v16, 1, v17
    v_lshlrev_b32 v16, 3, v16
    v_bfe_u32 v17, v0, 2, 2
    v_lshl_add_u32 v17, v2, 3, v17
    v_lshl_add_u32 v13, v17, 6, v16
    v_add_u32 v13, 98304, v13
    v_xor_b32 v14, 32, v13
    s_lshr_b32 s76, s64, 1
    s_and_b32 s76, s76, 2
    v_xor_b32 v15, s76, v2
    v_and_b32 v16, 1, v1
    v_lshl_add_u32 v15, v16, 2, v15
    v_lshlrev_b32 v15, 4, v15
    v_lshrrev_b32 v16, 1, v1
    v_lshl_add_u32 v15, v16, 16, v15
    s_and_b32 s76, s63, 2
    s_lshl_b32 s76, s76, 12
    v_add_u32 v15, s76, v15
    s_lshl_b32 s78, s64, 2
    s_add_u32 s78, s78, s62
    s_lshr_b32 s79, s78, 6
    s_lshl_b32 s24, s78, 2
    s_add_u32 s24, s24, s79
    s_lshl_b32 s24, s24, 13
    s_add_u32 s24, s24, 37748736
    s_and_b32 s79, s63, 4
    s_add_u32 s79, s79, s63
    s_lshl_b32 s25, s79, 11
    s_add_u32 s25, s25, s24
    s_lshl_b32 s96, s63, 10
    s_add_u32 s96, s96, s88
    s_lshl_b32 s97, s63, 9
    s_add_u32 s97, s97, s88
    s_add_u32 s97, s97, 49152
    s_and_b32 s80, s62, 2
    s_add_u32 s80, s80, s62
    s_lshl_b32 s80, s80, 12
    s_min_u32 s99, s63, 6
    s_lshl_b32 s99, s99, 18
    s_add_u32 s99, s99, 54525952
    s_add_u32 s99, s99, s80
    s_lshl_b32 s80, s62, 12
    s_lshr_b32 s79, s63, 2
    s_lshl_b32 s86, s63, 6
    s_lshl_b32 s86, s86, 13
    s_mul_i32 s86, s63, 540672
    s_add_u32 s86, s86, 50331648
    s_add_u32 s60, s86, s91
    s_add_u32 s61, s86, s92
    s_add_u32 s86, s86, s80
    s_mul_i32 s87, s63, 466944
    s_add_u32 s87, s87, 58720256
    s_lshr_b32 s58, s66, 5
    s_lshl_b32 s58, s58, 3
    s_and_b32 s79, s66, 7
    s_add_u32 s58, s58, s79
    s_lshl_b32 s58, s58, 2
    s_bfe_u32 s79, s66, 0x20003
    s_add_u32 s58, s58, s79
    s_lshl_b32 s58, s58, 8
    s_and_b32 s79, s62, 1
    s_mul_i32 s80, s79, 32768
    s_add_u32 s58, s58, s80
    s_bfe_u32 s80, s63, 0x10001
    s_lshl_b32 s80, s80, 13
    s_add_u32 s58, s58, s87
    s_lshl_b32 s79, s79, 11
    s_and_b32 s49, s66, 31
    s_lshl_b32 s49, s49, 16
    s_add_u32 s49, s49, s79
    s_cmp_ge_u32 s62, 2
    s_cselect_b32 s80, 28672, 0
    s_add_u32 s48, s80, s79
    s_add_u32 s48, s48, 106496
    s_add_u32 s49, s49, 41943040
    s_mul_i32 s93, s62, 3072
    s_lshl_b32 s0, s62, 12
    s_mov_b32 s59, 32
    s_mov_b64 s[36:37], -1
    v_lshl_add_u32 v57, v1, 6, s68
    v_mul_u32_u24 v57, 896, v57
    v_lshl_add_u32 v57, v2, 4, v57
    s_lshl_b32 s79, s63, 7
    v_add_u32 v57, s79, v57
    s_add_u32 m0, s92, 138752
    s_nop 0
    buffer_load_dwordx4 v22, s[12:15], 0 offen offset:512 lds
    s_lshl_b32 s76, s62, 3
    v_lshrrev_b32 v181, 1, v1
    v_add_u32 v181, s76, v181
    v_cvt_f32_u32 v181, v181
    v_mul_f32 v176, 0x3d000000, v181
    v_and_b32 v185, 1, v1
    v_cvt_f32_u32 v182, v2
    v_mul_f32 v182, 0x41000000, v182
    v_mul_f32 v177, v182, v176
    s_cmp_eq_u32 s64, 0
    s_cselect_b32 s77, 0.5, 1.0
    s_cselect_b32 s78, 0, 0x3e800000
    s_cselect_b32 s79, 0, 0x3f400000
    s_cselect_b32 s80, 0, -1
    s_add_u32 m0, s92, 139776
    s_nop 0
    buffer_load_dwordx4 v23, s[12:15], 0 offen offset:512 lds
    v_fma_f32 v178, s77, v176, v177
    v_cvt_f32_u32 v181, v185
    v_fma_f32 v177, s78, v181, v177
    v_fma_f32 v178, s79, v181, v178
    v_add_u32 v179, -1, v185
    v_sub_u32 v180, 0, v185
    v_or_b32 v179, s80, v179
    v_or_b32 v180, s80, v180
    s_add_u32 m0, s94, 0
    s_nop 0
    buffer_load_dwordx4 v20, s[4:7], 0 offen offset:0 sc1 lds
    v_add_f32 v186, v177, v176
    v_cos_f32 v181, v177
    v_cos_f32 v182, v186
    v_sin_f32 v183, v177
    v_sin_f32 v184, v186
    v_add_f32 v177, v186, v176
    v_cvt_pk_bf16_f32 v24, v181, v182
    v_cvt_pk_bf16_f32 v32, v183, v184
    v_and_b32 v24, v24, v179
    v_and_b32 v32, v32, v179
    s_add_u32 m0, s94, 1024
    s_nop 0
    buffer_load_dwordx4 v21, s[4:7], 0 offen offset:0 sc1 lds
    v_add_f32 v186, v177, v176
    v_cos_f32 v181, v177
    v_cos_f32 v182, v186
    v_sin_f32 v183, v177
    v_sin_f32 v184, v186
    v_add_f32 v177, v186, v176
    v_cvt_pk_bf16_f32 v25, v181, v182
    v_cvt_pk_bf16_f32 v33, v183, v184
    v_and_b32 v25, v25, v179
    v_and_b32 v33, v33, v179
    v_add_f32 v186, v177, v176
    s_add_u32 m0, s94, 1920
    s_nop 0
    buffer_load_dwordx4 v20, s[4:7], 0 offen offset:128 sc1 lds
    v_cos_f32 v181, v177
    v_cos_f32 v182, v186
    v_sin_f32 v183, v177
    v_sin_f32 v184, v186
    v_add_f32 v177, v186, v176
    v_cvt_pk_bf16_f32 v26, v181, v182
    v_cvt_pk_bf16_f32 v34, v183, v184
    v_and_b32 v26, v26, v179
    v_and_b32 v34, v34, v179
    v_add_f32 v186, v177, v176
    s_add_u32 m0, s94, 2944
    s_nop 0
    buffer_load_dwordx4 v21, s[4:7], 0 offen offset:128 sc1 lds
    v_cos_f32 v181, v177
    v_cos_f32 v182, v186
    v_sin_f32 v183, v177
    v_sin_f32 v184, v186
    v_add_f32 v177, v186, v176
    v_cvt_pk_bf16_f32 v27, v181, v182
    v_cvt_pk_bf16_f32 v35, v183, v184
    v_and_b32 v27, v27, v179
    v_and_b32 v35, v35, v179
    v_add_f32 v186, v178, v176
    v_cos_f32 v181, v178
    s_add_u32 m0, s94, 3840
    s_nop 0
    buffer_load_dwordx4 v20, s[4:7], 0 offen offset:256 sc1 lds
    v_cos_f32 v182, v186
    v_sin_f32 v183, v178
    v_sin_f32 v184, v186
    v_add_f32 v178, v186, v176
    v_cvt_pk_bf16_f32 v28, v181, v182
    v_cvt_pk_bf16_f32 v36, v183, v184
    v_and_b32 v28, v28, v180
    v_and_b32 v36, v36, v180
    v_add_f32 v186, v178, v176
    v_cos_f32 v181, v178
    v_cos_f32 v182, v186
    s_add_u32 m0, s94, 4864
    s_nop 0
    buffer_load_dwordx4 v21, s[4:7], 0 offen offset:256 sc1 lds
    v_sin_f32 v183, v178
    v_sin_f32 v184, v186
    v_add_f32 v178, v186, v176
    v_cvt_pk_bf16_f32 v29, v181, v182
    v_cvt_pk_bf16_f32 v37, v183, v184
    v_and_b32 v29, v29, v180
    v_and_b32 v37, v37, v180
    v_add_f32 v186, v178, v176
    v_cos_f32 v181, v178
    v_cos_f32 v182, v186
    s_add_u32 m0, s94, 5760
    s_nop 0
    buffer_load_dwordx4 v20, s[4:7], 0 offen offset:384 sc1 lds
    v_sin_f32 v183, v178
    v_sin_f32 v184, v186
    v_add_f32 v178, v186, v176
    v_cvt_pk_bf16_f32 v30, v181, v182
    v_cvt_pk_bf16_f32 v38, v183, v184
    v_and_b32 v30, v30, v180
    v_and_b32 v38, v38, v180
    v_add_f32 v186, v178, v176
    v_cos_f32 v181, v178
    v_cos_f32 v182, v186
    v_sin_f32 v183, v178
    s_add_u32 m0, s94, 6784
    s_nop 0
    buffer_load_dwordx4 v21, s[4:7], 0 offen offset:384 sc1 lds
    v_sin_f32 v184, v186
    v_add_f32 v178, v186, v176
    v_cvt_pk_bf16_f32 v31, v181, v182
    v_cvt_pk_bf16_f32 v39, v183, v184
    v_and_b32 v31, v31, v180
    v_and_b32 v39, v39, v180
    v_lshlrev_b32 v167, 3, v2
    v_sub_u32 v168, v1, v167
    v_add_u32 v167, v1, v167
    v_mov_b32 v169, 0x3f80
    s_add_u32 m0, s94, 7680
    s_nop 0
    buffer_load_dwordx4 v20, s[4:7], 0 offen offset:512 sc1 lds
    v_add_u32 v164, 1, v168
    v_lshlrev_b32 v165, 4, v164
    v_lshlrev_b32 v165, v165, v169
    v_ashrrev_i32 v164, 1, v164
    v_cmp_eq_u32 s[76:77], 0, v164
    v_cmp_eq_u32 s[78:79], 1, v164
    v_cmp_eq_u32 s[80:81], 2, v164
    v_cmp_eq_u32 s[82:83], 3, v164
    v_cndmask_b32 v232, 0, v165, s[76:77]
    v_cndmask_b32 v233, 0, v165, s[78:79]
    v_cndmask_b32 v234, 0, v165, s[80:81]
    s_add_u32 m0, s94, 8704
    s_nop 0
    buffer_load_dwordx4 v21, s[4:7], 0 offen offset:512 sc1 lds
    v_cndmask_b32 v235, 0, v165, s[82:83]
    v_add_u32 v164, 17, v168
    v_ashrrev_i32 v164, 1, v164
    v_cmp_eq_u32 s[76:77], 0, v164
    v_cmp_eq_u32 s[78:79], 1, v164
    v_cmp_eq_u32 s[80:81], 2, v164
    v_cmp_eq_u32 s[82:83], 3, v164
    v_cndmask_b32 v236, 0, v165, s[76:77]
    v_cndmask_b32 v237, 0, v165, s[78:79]
    v_cndmask_b32 v238, 0, v165, s[80:81]
    v_cndmask_b32 v239, 0, v165, s[82:83]
    s_add_u32 m0, s94, 9600
    s_nop 0
    buffer_load_dwordx4 v20, s[4:7], 0 offen offset:640 sc1 lds
    v_add_u32 v164, -15, v168
    v_ashrrev_i32 v164, 1, v164
    v_cmp_eq_u32 s[76:77], 0, v164
    v_cmp_eq_u32 s[78:79], 1, v164
    v_cmp_eq_u32 s[80:81], 2, v164
    v_cmp_eq_u32 s[82:83], 3, v164
    v_cndmask_b32 v240, 0, v165, s[76:77]
    v_cndmask_b32 v241, 0, v165, s[78:79]
    v_cndmask_b32 v242, 0, v165, s[80:81]
    v_cndmask_b32 v243, 0, v165, s[82:83]
    s_add_u32 m0, s94, 10624
    s_nop 0
    buffer_load_dwordx4 v21, s[4:7], 0 offen offset:640 sc1 lds
    v_sub_u32 v164, 15, v167
    v_ashrrev_i32 v164, 1, v164
    v_cmp_eq_u32 s[76:77], 0, v164
    v_cmp_eq_u32 s[78:79], 1, v164
    v_cmp_eq_u32 s[80:81], 2, v164
    v_cmp_eq_u32 s[82:83], 3, v164
    v_cndmask_b32 v244, 0, v165, s[76:77]
    v_cndmask_b32 v245, 0, v165, s[78:79]
    v_cndmask_b32 v246, 0, v165, s[80:81]
    v_cndmask_b32 v247, 0, v165, s[82:83]
    v_sub_u32 v164, 31, v167
    s_add_u32 m0, s94, 11520
    s_nop 0
    buffer_load_dwordx4 v20, s[4:7], 0 offen offset:768 sc1 lds
    v_ashrrev_i32 v164, 1, v164
    v_cmp_eq_u32 s[76:77], 0, v164
    v_cmp_eq_u32 s[78:79], 1, v164
    v_cmp_eq_u32 s[80:81], 2, v164
    v_cmp_eq_u32 s[82:83], 3, v164
    v_cndmask_b32 v248, 0, v165, s[76:77]
    v_cndmask_b32 v249, 0, v165, s[78:79]
    v_cndmask_b32 v250, 0, v165, s[80:81]
    v_cndmask_b32 v251, 0, v165, s[82:83]
    v_mov_b32 v164, -1
    s_add_u32 m0, s94, 12544
    s_nop 0
    buffer_load_dwordx4 v21, s[4:7], 0 offen offset:768 sc1 lds
    v_mov_b32 v165, -1
    v_mov_b32 v166, -1
    v_mov_b32 v167, -1
    v_and_b32 v168, 1, v2
    v_lshlrev_b32 v168, 13, v168
    v_lshl_add_u32 v168, v1, 3, v168
    v_lshrrev_b32 v169, 5, v0
    v_lshl_add_u32 v168, v169, 23, v168
    v_lshl_add_u32 v64, v1, 6, s68
    v_cvt_f32_u32 v65, v64
    v_mul_f32 v65, 0x3a000000, v65
    s_add_u32 m0, s92, 146816
    s_nop 0
    buffer_load_dwordx4 v22, s[12:15], 0 offen offset:640 lds
    v_cvt_f32_u32 v66, v2
    v_mul_f32 v66, 4.0, v66
    v_mul_f32 v66, v66, v65
    s_mov_b32 s76, 0x41500000
    v_cos_f32 v67, v66
    v_sin_f32 v68, v66
    v_add_f32 v66, v66, v65
    v_cvt_pk_bf16_f32 v40, v67, v68
    v_xor_b32 v48, 0x80000000, v40
    v_cos_f32 v67, v66
    v_sin_f32 v68, v66
    s_add_u32 m0, s92, 147840
    s_nop 0
    buffer_load_dwordx4 v23, s[12:15], 0 offen offset:640 lds
    v_add_f32 v66, v66, v65
    v_cvt_pk_bf16_f32 v41, v67, v68
    v_xor_b32 v49, 0x80000000, v41
    v_cos_f32 v67, v66
    v_sin_f32 v68, v66
    v_add_f32 v66, v66, v65
    v_cvt_pk_bf16_f32 v42, v67, v68
    v_xor_b32 v50, 0x80000000, v42
    v_cos_f32 v67, v66
    v_sin_f32 v68, v66
    s_add_u32 m0, s92, 154880
    s_nop 0
    buffer_load_dwordx4 v22, s[12:15], 0 offen offset:768 lds
    v_fma_f32 v66, s76, v65, v66
    v_cvt_pk_bf16_f32 v43, v67, v68
    v_xor_b32 v51, 0x80000000, v43
    v_cos_f32 v67, v66
    v_sin_f32 v68, v66
    v_add_f32 v66, v66, v65
    v_cvt_pk_bf16_f32 v44, v67, v68
    v_xor_b32 v52, 0x80000000, v44
    v_cos_f32 v67, v66
    v_sin_f32 v68, v66
    v_add_f32 v66, v66, v65
    s_add_u32 m0, s92, 155904
    s_nop 0
    buffer_load_dwordx4 v23, s[12:15], 0 offen offset:768 lds
    v_cvt_pk_bf16_f32 v45, v67, v68
    v_xor_b32 v53, 0x80000000, v45
    v_cos_f32 v67, v66
    v_sin_f32 v68, v66
    v_add_f32 v66, v66, v65
    v_cvt_pk_bf16_f32 v46, v67, v68
    v_xor_b32 v54, 0x80000000, v46
    v_cos_f32 v67, v66
    v_sin_f32 v68, v66
    v_fma_f32 v66, s76, v65, v66
    v_cvt_pk_bf16_f32 v47, v67, v68
    v_xor_b32 v55, 0x80000000, v47
    v_lshlrev_b32 v67, 26, v64
    v_sub_u32 v68, 0, v64
    v_lshlrev_b32 v68, 26, v68
    v_and_b32 v67, 0x80000000, v67
    v_and_b32 v68, 0x80000000, v68
    s_mov_b64 exec, 0xffff
    v_or_b32 v40, 0x3f803f80, v67
    v_or_b32 v48, 0x3f803f80, v68
    s_mov_b64 exec, -1
    s_waitcnt vmcnt(18)
    s_barrier
    s_mov_b32 s98, 0
    ds_read_b128 v[64:67], v10 offset:0
    ds_read_b128 v[68:71], v10 offset:2048
    ds_read_b128 v[72:75], v10 offset:4096
    ds_read_b128 v[76:79], v10 offset:6144
    ds_read_b128 v[80:83], v11 offset:0
    ds_read_b128 v[84:87], v11 offset:2048
    ds_read_b128 v[88:91], v11 offset:4096
    ds_read_b128 v[92:95], v11 offset:6144
    s_waitcnt vmcnt(16)
    ds_read_b128 v[176:179], v8 offset:0
    ds_read_b128 v[180:183], v9 offset:0
    s_waitcnt lgkmcnt(0)
    v_mfma_f32_16x16x32_bf16 v[128:131], v[60:63], v[176:179], 0
    v_mfma_f32_16x16x32_bf16 v[132:135], v[176:179], v[176:179], 0
    v_mfma_f32_16x16x32_bf16 v[128:131], v[60:63], v[180:183], v[128:131]
    s_waitcnt vmcnt(14)
    ds_read_b128 v[184:187], v8 offset:2048
    s_add_u32 m0, s95, 0
    v_mfma_f32_16x16x32_bf16 v[132:135], v[180:183], v[180:183], v[132:135]
    ds_read_b128 v[188:191], v9 offset:2048
    buffer_load_dwordx4 v156, s[16:19], s3 offen  lds
    v_mfma_f32_16x16x32_bf16 v[112:115], v[64:67], v[176:179], 0
    s_add_u32 m0, s95, 1024
    s_nop 0
    buffer_load_dwordx4 v157, s[16:19], 0 offen  lds
    v_mfma_f32_16x16x32_bf16 v[116:119], v[68:71], v[176:179], 0
    ds_read_b128 v[96:99], v10 offset:8192
    s_add_u32 m0, s95, 2048
    v_mfma_f32_16x16x32_bf16 v[120:123], v[72:75], v[176:179], 0
    ds_read_b128 v[100:103], v10 offset:10240
    buffer_load_dwordx4 v156, s[16:19], s26 offen  lds
    v_mfma_f32_16x16x32_bf16 v[124:127], v[76:79], v[176:179], 0
    ds_read_b128 v[104:107], v10 offset:12288
    s_add_u32 m0, s95, 3072
    v_mfma_f32_16x16x32_bf16 v[112:115], v[80:83], v[180:183], v[112:115]
    ds_read_b128 v[108:111], v10 offset:14336
    buffer_load_dwordx4 v156, s[16:19], s27 offen  lds
    v_mfma_f32_16x16x32_bf16 v[116:119], v[84:87], v[180:183], v[116:119]
    ds_read_b128 v[64:67], v11 offset:8192
    s_lshl_b64 exec, -1, 32
    buffer_load_dword v252, v252, s[20:23], 0 offen
    s_mov_b64 exec, -1
    v_mfma_f32_16x16x32_bf16 v[120:123], v[88:91], v[180:183], v[120:123]
    ds_read_b128 v[68:71], v11 offset:10240
    buffer_load_ushort v4, v160, s[28:31], 0 offen
    v_mfma_f32_16x16x32_bf16 v[124:127], v[92:95], v[180:183], v[124:127]
    ds_read_b128 v[72:75], v11 offset:12288
    s_andn2_b32 s78, s51, 8192
    s_waitcnt lgkmcnt(7)
    v_mfma_f32_16x16x32_bf16 v[128:131], v[60:63], v[184:187], v[128:131]
    ds_read_b128 v[76:79], v11 offset:14336
    buffer_store_dwordx2 v[164:165], v168, s[8:11], s78 offen sc1
    v_mfma_f32_16x16x32_bf16 v[132:135], v[184:187], v[184:187], v[132:135]
    s_mul_i32 s83, s62, 8448
    s_add_u32 s84, s83, 106496
    v_mfma_f32_16x16x32_bf16 v[128:131], v[60:63], v[188:191], v[128:131]
    s_waitcnt vmcnt(19)
    ds_read_b128 v[192:195], v8 offset:4096
    s_add_u32 s83, s83, 57344
    v_mfma_f32_16x16x32_bf16 v[132:135], v[188:191], v[188:191], v[132:135]
    ds_read_b128 v[196:199], v9 offset:4096
    s_mov_b32 s82, s94
    s_waitcnt lgkmcnt(6)
    v_mfma_f32_16x16x32_bf16 v[112:115], v[96:99], v[184:187], v[112:115]
    v_lshrrev_b32 v163, 5, v0
    v_xor_b32 v23, v0, v163
    v_mfma_f32_16x16x32_bf16 v[116:119], v[100:103], v[184:187], v[116:119]
    v_and_b32 v23, 31, v23
    v_lshlrev_b32 v23, 4, v23
    v_mfma_f32_16x16x32_bf16 v[120:123], v[104:107], v[184:187], v[120:123]
    s_waitcnt vmcnt(17)
    ds_read_b128 v[200:203], v8 offset:6144
    v_lshl_add_u32 v23, v163, 18, v23
    v_mfma_f32_16x16x32_bf16 v[124:127], v[108:111], v[184:187], v[124:127]
    ds_read_b128 v[204:207], v9 offset:6144
    v_and_b32 v163, 1, v1
    s_waitcnt lgkmcnt(4)
    v_mfma_f32_16x16x32_bf16 v[112:115], v[64:67], v[188:191], v[112:115]
    v_xor_b32 v20, v2, v163
    v_lshlrev_b32 v20, 4, v20
    v_mfma_f32_16x16x32_bf16 v[116:119], v[68:71], v[188:191], v[116:119]
    ds_read_b128 v[80:83], v10 offset:16384
    v_lshl_add_u32 v20, v163, 9, v20
    v_mfma_f32_16x16x32_bf16 v[120:123], v[72:75], v[188:191], v[120:123]
    ds_read_b128 v[84:87], v10 offset:18432
    v_lshrrev_b32 v163, 1, v1
    v_mfma_f32_16x16x32_bf16 v[124:127], v[76:79], v[188:191], v[124:127]
    ds_read_b128 v[88:91], v10 offset:20480
    v_mul_u32_u24 v163, 1056, v163
    s_waitcnt lgkmcnt(5)
    v_mfma_f32_16x16x32_bf16 v[128:131], v[60:63], v[192:195], v[128:131]
    ds_read_b128 v[92:95], v10 offset:22528
    v_add_u32 v163, v163, v20
    v_mfma_f32_16x16x32_bf16 v[132:135], v[192:195], v[192:195], v[132:135]
    ds_read_b128 v[96:99], v11 offset:16384
    v_add_u32 v20, s82, v163
    v_mfma_f32_16x16x32_bf16 v[128:131], v[60:63], v[196:199], v[128:131]
    ds_read_b128 v[100:103], v11 offset:18432
    v_add_u32 v21, s83, v163
    v_mfma_f32_16x16x32_bf16 v[132:135], v[196:199], v[196:199], v[132:135]
    ds_read_b128 v[104:107], v11 offset:20480
    v_add_u32 v22, s84, v163
    s_waitcnt lgkmcnt(7)
    v_mfma_f32_16x16x32_bf16 v[128:131], v[60:63], v[200:203], v[128:131]
    ds_read_b128 v[108:111], v11 offset:22528
    v_mfma_f32_16x16x32_bf16 v[132:135], v[200:203], v[200:203], v[132:135]
    v_mfma_f32_16x16x32_bf16 v[128:131], v[60:63], v[204:207], v[128:131]
    s_waitcnt vmcnt(15)
    ds_read_b128 v[208:211], v8 offset:8192
    v_mfma_f32_16x16x32_bf16 v[132:135], v[204:207], v[204:207], v[132:135]
    ds_read_b128 v[212:215], v9 offset:8192
    s_waitcnt lgkmcnt(6)
    v_mfma_f32_16x16x32_bf16 v[112:115], v[80:83], v[192:195], v[112:115]
    v_mfma_f32_16x16x32_bf16 v[116:119], v[84:87], v[192:195], v[116:119]
    ds_read_b128 v[64:67], v10 offset:24576
    v_mfma_f32_16x16x32_bf16 v[120:123], v[88:91], v[192:195], v[120:123]
    ds_read_b128 v[68:71], v10 offset:26624
    v_mfma_f32_16x16x32_bf16 v[124:127], v[92:95], v[192:195], v[124:127]
    ds_read_b128 v[72:75], v10 offset:28672
    s_waitcnt lgkmcnt(5)
    v_mfma_f32_16x16x32_bf16 v[112:115], v[96:99], v[196:199], v[112:115]
    ds_read_b128 v[76:79], v10 offset:30720
    v_mfma_f32_16x16x32_bf16 v[116:119], v[100:103], v[196:199], v[116:119]
    ds_read_b128 v[80:83], v11 offset:24576
    v_mfma_f32_16x16x32_bf16 v[120:123], v[104:107], v[196:199], v[120:123]
    ds_read_b128 v[84:87], v11 offset:26624
    v_mfma_f32_16x16x32_bf16 v[124:127], v[108:111], v[196:199], v[124:127]
    ds_read_b128 v[88:91], v11 offset:28672
    s_waitcnt lgkmcnt(7)
    v_mfma_f32_16x16x32_bf16 v[128:131], v[60:63], v[208:211], v[128:131]
    ds_read_b128 v[92:95], v11 offset:30720
    v_mfma_f32_16x16x32_bf16 v[132:135], v[208:211], v[208:211], v[132:135]
    v_mfma_f32_16x16x32_bf16 v[128:131], v[60:63], v[212:215], v[128:131]
    s_waitcnt vmcnt(13)
    ds_read_b128 v[216:219], v8 offset:10240
    v_mfma_f32_16x16x32_bf16 v[132:135], v[212:215], v[212:215], v[132:135]
    ds_read_b128 v[220:223], v9 offset:10240
    s_waitcnt lgkmcnt(6)
    v_mfma_f32_16x16x32_bf16 v[112:115], v[64:67], v[200:203], v[112:115]
    v_mfma_f32_16x16x32_bf16 v[116:119], v[68:71], v[200:203], v[116:119]
    v_mfma_f32_16x16x32_bf16 v[120:123], v[72:75], v[200:203], v[120:123]
    s_waitcnt vmcnt(11)
    ds_read_b128 v[224:227], v8 offset:12288
    v_mfma_f32_16x16x32_bf16 v[124:127], v[76:79], v[200:203], v[124:127]
    ds_read_b128 v[228:231], v9 offset:12288
    s_waitcnt lgkmcnt(4)
    v_mfma_f32_16x16x32_bf16 v[112:115], v[80:83], v[204:207], v[112:115]
    v_mfma_f32_16x16x32_bf16 v[116:119], v[84:87], v[204:207], v[116:119]
    ds_read_b128 v[96:99], v10 offset:32768
    v_mfma_f32_16x16x32_bf16 v[120:123], v[88:91], v[204:207], v[120:123]
    ds_read_b128 v[100:103], v10 offset:34816
    v_mfma_f32_16x16x32_bf16 v[124:127], v[92:95], v[204:207], v[124:127]
    ds_read_b128 v[104:107], v10 offset:36864
    s_waitcnt lgkmcnt(5)
    v_mfma_f32_16x16x32_bf16 v[128:131], v[60:63], v[216:219], v[128:131]
    ds_read_b128 v[108:111], v10 offset:38912
    v_mfma_f32_16x16x32_bf16 v[132:135], v[216:219], v[216:219], v[132:135]
    ds_read_b128 v[64:67], v11 offset:32768
    v_mfma_f32_16x16x32_bf16 v[128:131], v[60:63], v[220:223], v[128:131]
    ds_read_b128 v[68:71], v11 offset:34816
    v_mfma_f32_16x16x32_bf16 v[132:135], v[220:223], v[220:223], v[132:135]
    ds_read_b128 v[72:75], v11 offset:36864
    s_waitcnt lgkmcnt(7)
    v_mfma_f32_16x16x32_bf16 v[128:131], v[60:63], v[224:227], v[128:131]
    ds_read_b128 v[76:79], v11 offset:38912
    v_mfma_f32_16x16x32_bf16 v[132:135], v[224:227], v[224:227], v[132:135]
    s_waitcnt vmcnt(7)
    s_barrier
    ds_read_b128 v[80:83], v10 offset:40960
    v_mfma_f32_16x16x32_bf16 v[128:131], v[60:63], v[228:231], v[128:131]
    ds_read_b128 v[84:87], v10 offset:43008
    s_add_u32 m0, s82, 0
    s_add_u32 s95, s62, 0
    s_bitcmp1_b32 s95, 1
    s_cselect_b32 s77, s69, s64
    s_and_b32 s95, s95, 1
    s_lshl_b32 s95, s95, 10
    s_add_u32 s95, s95, s77
    s_lshl_b32 s95, s95, 12
    s_add_u32 s95, s95, s91
    s_add_u32 s95, s95, 0
    buffer_load_dwordx4 v23, s[20:23], s95 offen lds
    v_mfma_f32_16x16x32_bf16 v[132:135], v[228:231], v[228:231], v[132:135]
    ds_read_b128 v[88:91], v10 offset:45056
    s_waitcnt lgkmcnt(7)
    v_mfma_f32_16x16x32_bf16 v[112:115], v[96:99], v[208:211], v[112:115]
    ds_read_b128 v[92:95], v10 offset:47104
    v_mfma_f32_16x16x32_bf16 v[116:119], v[100:103], v[208:211], v[116:119]
    ds_read_b128 v[96:99], v11 offset:40960
    s_add_u32 m0, s82, 1056
    s_add_u32 s95, s95, 524288
    buffer_load_dwordx4 v23, s[20:23], s95 offen lds
    v_mfma_f32_16x16x32_bf16 v[120:123], v[104:107], v[208:211], v[120:123]
    ds_read_b128 v[100:103], v11 offset:43008
    v_cndmask_b32 v18, 0, v132, s[38:39]
    v_mfma_f32_16x16x32_bf16 v[124:127], v[108:111], v[208:211], v[124:127]
    ds_read_b128 v[104:107], v11 offset:45056
    v_cndmask_b32 v18, v18, v133, s[40:41]
    s_waitcnt lgkmcnt(7)
    v_mfma_f32_16x16x32_bf16 v[112:115], v[64:67], v[212:215], v[112:115]
    ds_read_b128 v[108:111], v11 offset:47104
    s_add_u32 m0, s82, 2112
    s_add_u32 s95, s95, 524288
    buffer_load_dwordx4 v23, s[20:23], s95 offen lds
    v_mfma_f32_16x16x32_bf16 v[116:119], v[68:71], v[212:215], v[116:119]
    ds_read_b128 v[64:67], v10 offset:49152
    v_cndmask_b32 v18, v18, v134, s[42:43]
    v_mfma_f32_16x16x32_bf16 v[120:123], v[72:75], v[212:215], v[120:123]
    ds_read_b128 v[68:71], v10 offset:51200
    v_cndmask_b32 v18, v18, v135, s[44:45]
    v_mfma_f32_16x16x32_bf16 v[124:127], v[76:79], v[212:215], v[124:127]
    ds_read_b128 v[72:75], v10 offset:53248
    v_mov_b32 v17, v18
    s_waitcnt lgkmcnt(7)
    v_mfma_f32_16x16x32_bf16 v[112:115], v[80:83], v[216:219], v[112:115]
    ds_read_b128 v[76:79], v10 offset:55296
    s_add_u32 m0, s82, 3168
    s_add_u32 s95, s95, 524288
    buffer_load_dwordx4 v23, s[20:23], s95 offen lds
    v_mfma_f32_16x16x32_bf16 v[116:119], v[84:87], v[216:219], v[116:119]
    ds_read_b128 v[80:83], v11 offset:49152
    v_permlane16_swap_b32 v18, v17
    v_mfma_f32_16x16x32_bf16 v[120:123], v[88:91], v[216:219], v[120:123]
    ds_read_b128 v[84:87], v11 offset:51200
    v_add_f32 v18, v18, v17
    v_mfma_f32_16x16x32_bf16 v[124:127], v[92:95], v[216:219], v[124:127]
    ds_read_b128 v[88:91], v11 offset:53248
    v_mov_b32 v17, v18
    s_waitcnt lgkmcnt(7)
    v_mfma_f32_16x16x32_bf16 v[112:115], v[96:99], v[220:223], v[112:115]
    ds_read_b128 v[92:95], v11 offset:55296
    s_add_u32 m0, s82, 4224
    s_add_u32 s95, s95, 524288
    buffer_load_dwordx4 v23, s[20:23], s95 offen lds
    v_mfma_f32_16x16x32_bf16 v[116:119], v[100:103], v[220:223], v[116:119]
    v_permlane32_swap_b32 v18, v17
    v_add_f32 v18, v18, v17
    v_mfma_f32_16x16x32_bf16 v[120:123], v[104:107], v[220:223], v[120:123]
    v_mul_f32 v16, 0x3b124925, v128
    s_add_u32 m0, s82, 5280
    s_add_u32 s95, s95, 524288
    buffer_load_dwordx4 v23, s[20:23], s95 offen lds
    v_mfma_f32_16x16x32_bf16 v[124:127], v[108:111], v[220:223], v[124:127]
    v_mul_f32 v18, 0x3b124925, v18
    s_waitcnt lgkmcnt(4)
    v_mfma_f32_16x16x32_bf16 v[112:115], v[64:67], v[224:227], v[112:115]
    v_fma_f32 v18, -v16, v16, v18
    v_max_f32 v18, 0, v18
    v_mfma_f32_16x16x32_bf16 v[116:119], v[68:71], v[224:227], v[116:119]
    s_add_u32 m0, s82, 6336
    s_add_u32 s95, s95, 524288
    buffer_load_dwordx4 v23, s[20:23], s95 offen lds
    v_mfma_f32_16x16x32_bf16 v[120:123], v[72:75], v[224:227], v[120:123]
    v_add_f32 v18, 0x3727c5ac, v18
    v_rsq_f32 v18, v18
    v_mfma_f32_16x16x32_bf16 v[124:127], v[76:79], v[224:227], v[124:127]
    s_add_u32 m0, s82, 7392
    s_add_u32 s95, s95, 524288
    buffer_load_dwordx4 v23, s[20:23], s95 offen lds
    s_waitcnt lgkmcnt(0)
    v_mfma_f32_16x16x32_bf16 v[112:115], v[80:83], v[228:231], v[112:115]
    v_mfma_f32_16x16x32_bf16 v[116:119], v[84:87], v[228:231], v[116:119]
    v_mfma_f32_16x16x32_bf16 v[120:123], v[88:91], v[228:231], v[120:123]
    v_mfma_f32_16x16x32_bf16 v[124:127], v[92:95], v[228:231], v[124:127]
layer:
    s_nop 4
    v_pk_mul_f32 v[112:113], v[112:113], v[18:19] op_sel_hi:[1,0]
    v_pk_mul_f32 v[114:115], v[114:115], v[18:19] op_sel_hi:[1,0]
    v_pk_mul_f32 v[116:117], v[116:117], v[18:19] op_sel_hi:[1,0]
    v_pk_mul_f32 v[118:119], v[118:119], v[18:19] op_sel_hi:[1,0]
    v_cvt_pk_bf16_f32 v136, v112, v113
    v_cvt_pk_bf16_f32 v137, v114, v115
    v_cvt_pk_bf16_f32 v138, v116, v117
    v_cvt_pk_bf16_f32 v139, v118, v119
    ds_write_b128 v12, v[136:139] offset:0
    v_pk_mul_f32 v[120:121], v[120:121], v[18:19] op_sel_hi:[1,0]
    v_pk_mul_f32 v[122:123], v[122:123], v[18:19] op_sel_hi:[1,0]
    v_pk_mul_f32 v[124:125], v[124:125], v[18:19] op_sel_hi:[1,0]
    v_pk_mul_f32 v[126:127], v[126:127], v[18:19] op_sel_hi:[1,0]
    v_cvt_pk_bf16_f32 v140, v120, v121
    v_cvt_pk_bf16_f32 v141, v122, v123
    v_cvt_pk_bf16_f32 v142, v124, v125
    v_cvt_pk_bf16_f32 v143, v126, v127
    ds_write_b128 v12, v[140:143] offset:4096
    s_waitcnt lgkmcnt(0)
    s_barrier
    ds_read_b64_tr_b16 v[64:65], v13 offset:0
    ds_read_b64_tr_b16 v[66:67], v14 offset:256
    ds_read_b64_tr_b16 v[68:69], v14 offset:0
    ds_read_b64_tr_b16 v[70:71], v13 offset:256
    ds_read_b64_tr_b16 v[72:73], v13 offset:2048
    ds_read_b64_tr_b16 v[74:75], v14 offset:2304
    ds_read_b64_tr_b16 v[76:77], v14 offset:2048
    ds_read_b64_tr_b16 v[78:79], v13 offset:2304
    ds_read_b64_tr_b16 v[80:81], v13 offset:4096
    ds_read_b64_tr_b16 v[82:83], v14 offset:4352
    ds_read_b64_tr_b16 v[84:85], v14 offset:4096
    ds_read_b64_tr_b16 v[86:87], v13 offset:4352
    ds_read_b64_tr_b16 v[88:89], v13 offset:6144
    ds_read_b64_tr_b16 v[90:91], v14 offset:6400
    s_waitcnt lgkmcnt(10)
    v_mfma_f32_16x16x32_bf16 v[144:147], v[64:67], v[24:27], 0
    ds_read_b64_tr_b16 v[92:93], v14 offset:6144
    ds_read_b64_tr_b16 v[94:95], v13 offset:6400
    v_mfma_f32_16x16x32_bf16 v[148:151], v[68:71], v[24:27], 0
    s_waitcnt lgkmcnt(8)
    v_mfma_f32_16x16x32_bf16 v[144:147], v[72:75], v[28:31], v[144:147]
    v_mfma_f32_16x16x32_bf16 v[148:151], v[76:79], v[28:31], v[148:151]
    s_waitcnt lgkmcnt(4)
    v_mfma_f32_16x16x32_bf16 v[144:147], v[80:83], v[32:35], v[144:147]
    v_mfma_f32_16x16x32_bf16 v[148:151], v[84:87], v[32:35], v[148:151]
    s_waitcnt lgkmcnt(2)
    v_mfma_f32_16x16x32_bf16 v[144:147], v[88:91], v[36:39], v[144:147]
    s_waitcnt lgkmcnt(0)
    v_mfma_f32_16x16x32_bf16 v[148:151], v[92:95], v[36:39], v[148:151]
    s_nop 5
    v_cvt_pk_bf16_f32 v152, v144, v145
    v_cvt_pk_bf16_f32 v153, v146, v147
    v_cvt_pk_bf16_f32 v154, v148, v149
    v_cvt_pk_bf16_f32 v155, v150, v151
    buffer_store_dwordx4 v[152:155], v15, s[8:11], s50 offen sc1
a1_join:
    s_cmp_lg_u32 s65, 0
    s_cbranch_scc1 mid1
    v_mov_b32 v253, 0
    buffer_load_dword v254, v253, s[32:35], 0 offen sc1
    s_add_u32 s50, s50, 4194304
    s_waitcnt vmcnt(13)
    s_cmp_eq_u32 s63, 7
    s_cbranch_scc1 g_nounit
    s_cmp_ge_u32 s64, 28
    s_cbranch_scc1 g_nounit
    ds_read_b64_tr_b16 v[96:97], v170 offset:0
    ds_read_b64_tr_b16 v[98:99], v170 offset:2048
    ds_read_b64_tr_b16 v[100:101], v171 offset:0
    ds_read_b64_tr_b16 v[102:103], v171 offset:2048
    ds_read_b64_tr_b16 v[104:105], v170 offset:64
    ds_read_b64_tr_b16 v[106:107], v170 offset:2112
    ds_read_b64_tr_b16 v[108:109], v171 offset:64
    ds_read_b64_tr_b16 v[110:111], v171 offset:2112
    v_add_u32 v8, 8192, v56
    s_waitcnt lgkmcnt(6)
    buffer_store_dwordx4 v[96:99], v56, s[8:11], s52 offen sc1
    s_waitcnt lgkmcnt(4)
    buffer_store_dwordx4 v[100:103], v56, s[8:11], s53 offen sc1
    s_waitcnt lgkmcnt(2)
    buffer_store_dwordx4 v[104:107], v56, s[8:11], s54 offen sc1
    s_waitcnt lgkmcnt(0)
    buffer_store_dwordx4 v[108:111], v56, s[8:11], s55 offen sc1
g_nounit:
    v_mfma_f32_16x16x32_bf16 v[16:19], v[240:243], v[176:179], 0
    s_add_u32 m0, s83, 0
    s_add_u32 s95, s62, 0
    s_bitcmp1_b32 s95, 1
    s_cselect_b32 s77, s69, s64
    s_and_b32 s95, s95, 1
    s_lshl_b32 s95, s95, 10
    s_add_u32 s95, s95, s77
    s_lshl_b32 s95, s95, 12
    s_add_u32 s95, s95, s91
    s_add_u32 s95, s95, 512
    buffer_load_dwordx4 v23, s[20:23], s95 offen lds
    v_mfma_f32_16x16x32_bf16 v[64:67], v[232:235], v[176:179], 0
    v_mfma_f32_16x16x32_bf16 v[68:71], v[236:239], v[176:179], 0
    v_mfma_f32_16x16x32_bf16 v[72:75], v[232:235], v[180:183], 0
    v_mov_b32 v59, v19
    s_add_u32 m0, s83, 1056
    s_add_u32 s95, s95, 524288
    buffer_load_dwordx4 v23, s[20:23], s95 offen lds
    v_mfma_f32_16x16x32_bf16 v[76:79], v[236:239], v[180:183], 0
    v_and_b32 v12, 3, v0
    v_mfma_f32_16x16x32_bf16 v[80:83], v[232:235], v[184:187], 0
    v_and_b32 v13, 1, v2
    v_mfma_f32_16x16x32_bf16 v[84:87], v[236:239], v[184:187], 0
    s_add_u32 m0, s83, 2112
    s_add_u32 s95, s95, 524288
    buffer_load_dwordx4 v23, s[20:23], s95 offen lds
    v_mfma_f32_16x16x32_bf16 v[88:91], v[232:235], v[188:191], 0
    v_lshl_add_u32 v12, v13, 2, v12
    v_lshlrev_b32 v12, 3, v12
    v_mfma_f32_16x16x32_bf16 v[92:95], v[236:239], v[188:191], 0
    v_bfe_u32 v13, v0, 2, 2
    v_mfma_f32_16x16x32_bf16 v[96:99], v[232:235], v[192:195], 0
    s_add_u32 m0, s83, 3168
    s_add_u32 s95, s95, 524288
    buffer_load_dwordx4 v23, s[20:23], s95 offen lds
    v_mfma_f32_16x16x32_bf16 v[100:103], v[236:239], v[192:195], 0
    v_lshl_add_u32 v13, v2, 3, v13
    v_lshl_add_u32 v12, v13, 6, v12
    v_mfma_f32_16x16x32_bf16 v[104:107], v[232:235], v[196:199], 0
    s_cmp_ge_u32 s62, 2
    s_cselect_b32 s78, 28672, 0
    s_cselect_b32 s79, 0, 28672
    v_mfma_f32_16x16x32_bf16 v[108:111], v[236:239], v[196:199], 0
    s_add_u32 m0, s83, 4224
    s_add_u32 s95, s95, 524288
    buffer_load_dwordx4 v23, s[20:23], s95 offen lds
    v_mfma_f32_16x16x32_bf16 v[112:115], v[232:235], v[200:203], 0
    v_add_u32 v12, 106496, v12
    v_add_u32 v8, s78, v12
    v_mfma_f32_16x16x32_bf16 v[116:119], v[236:239], v[200:203], 0
    v_xor_b32 v9, 32, v8
    v_mfma_f32_16x16x32_bf16 v[120:123], v[244:247], v[204:207], 0
    s_add_u32 m0, s83, 5280
    s_add_u32 s95, s95, 524288
    buffer_load_dwordx4 v23, s[20:23], s95 offen lds
    v_mfma_f32_16x16x32_bf16 v[124:127], v[248:251], v[204:207], 0
    v_add_u32 v10, s79, v12
    v_xor_b32 v11, 32, v10
    v_mfma_f32_16x16x32_bf16 v[128:131], v[244:247], v[208:211], 0
    v_add_u32 v12, 50176, v56
    v_mfma_f32_16x16x32_bf16 v[132:135], v[248:251], v[208:211], 0
    s_add_u32 m0, s83, 6336
    s_add_u32 s95, s95, 524288
    buffer_load_dwordx4 v23, s[20:23], s95 offen lds
    v_mfma_f32_16x16x32_bf16 v[136:139], v[244:247], v[212:215], 0
    v_add_u32 v13, 106496, v56
    v_lshlrev_b32 v14, 4, v2
    v_mfma_f32_16x16x32_bf16 v[140:143], v[248:251], v[212:215], 0
    v_add_u32 v14, 100352, v14
    v_mfma_f32_16x16x32_bf16 v[144:147], v[244:247], v[216:219], 0
    s_add_u32 m0, s83, 7392
    s_add_u32 s95, s95, 524288
    buffer_load_dwordx4 v23, s[20:23], s95 offen lds
    v_mfma_f32_16x16x32_bf16 v[148:151], v[248:251], v[216:219], 0
    v_add_u32 v15, s48, v56
    s_lshl_b32 s81, s64, 5
    v_mfma_f32_16x16x32_bf16 v[152:155], v[244:247], v[220:223], 0
    s_lshl_b32 s80, s63, 2
    v_mfma_f32_16x16x32_bf16 v[156:159], v[248:251], v[220:223], 0
    s_add_u32 m0, s84, 0
    s_add_u32 s95, s62, 1
    s_bitcmp1_b32 s95, 1
    s_cselect_b32 s77, s69, s64
    s_and_b32 s95, s95, 1
    s_lshl_b32 s95, s95, 10
    s_add_u32 s95, s95, s77
    s_lshl_b32 s95, s95, 12
    s_add_u32 s95, s95, s91
    s_add_u32 s95, s95, 0
    buffer_load_dwordx4 v23, s[20:23], s95 offen lds
    v_mfma_f32_16x16x32_bf16 v[160:163], v[244:247], v[224:227], 0
    s_add_u32 s81, s81, s80
    s_add_u32 s81, s81, s62
    v_mfma_f32_16x16x32_bf16 v[164:167], v[248:251], v[224:227], 0
    s_mul_i32 s81, s81, 896
    v_mfma_f32_16x16x32_bf16 v[168:171], v[244:247], v[228:231], 0
    s_add_u32 m0, s84, 1056
    s_add_u32 s95, s95, 524288
    buffer_load_dwordx4 v23, s[20:23], s95 offen lds
    v_mfma_f32_16x16x32_bf16 v[172:175], v[248:251], v[228:231], 0
    s_mul_i32 s80, s65, 4194304
    s_add_u32 s81, s81, s80
    v_mfma_f32_16x16x32_bf16 v[68:71], v[240:243], v[180:183], v[68:71]
    s_add_u32 s81, s81, 41943040
    v_mfma_f32_16x16x32_bf16 v[76:79], v[240:243], v[184:187], v[76:79]
    v_mfma_f32_16x16x32_bf16 v[84:87], v[240:243], v[188:191], v[84:87]
    v_mfma_f32_16x16x32_bf16 v[92:95], v[240:243], v[192:195], v[92:95]
    v_mfma_f32_16x16x32_bf16 v[100:103], v[240:243], v[196:199], v[100:103]
    v_mfma_f32_16x16x32_bf16 v[108:111], v[240:243], v[200:203], v[108:111]
    v_mfma_f32_16x16x32_bf16 v[116:119], v[240:243], v[204:207], v[116:119]
    s_waitcnt vmcnt(10)
    s_mov_b32 s98, 0
interleave_layers__spectral_fnet__mixer_gmlp__prompt_kernel_rdy_1:
    v_cmp_eq_u32 vcc, 0, v254
    s_cbranch_vccz interleave_layers__spectral_fnet__mixer_gmlp__prompt_kernel_rdy_1_x
    s_add_u32 s98, s98, 1
    s_cmp_gt_u32 s98, 1048576
    s_cbranch_scc1 interleave_layers__spectral_fnet__mixer_gmlp__prompt_kernel_rdy_1_x
    buffer_load_dword v254, v253, s[32:35], 0 offen sc1
    s_waitcnt vmcnt(0)
    s_branch interleave_layers__spectral_fnet__mixer_gmlp__prompt_kernel_rdy_1
interleave_layers__spectral_fnet__mixer_gmlp__prompt_kernel_rdy_1_x:
    s_barrier
    s_mov_b32 s80, s84
    s_lshl_b32 s84, s63, 7
    v_lshlrev_b32 v253, 10, v0
    v_add_u32 v253, 20480, v253
    v_mov_b32 v254, 1
    s_mov_b64 exec, s[46:47]
    buffer_atomic_add v254, v253, s[8:11], s84 offen sc1
    s_mov_b64 exec, -1
    s_mov_b32 s84, s80
    ds_read_b128 v[176:179], v20 offset:0
    ds_read_b128 v[180:183], v20 offset:64
    ds_read_b128 v[184:187], v20 offset:128
    ds_read_b128 v[188:191], v20 offset:192
    ds_read_b128 v[192:195], v20 offset:256
    ds_read_b128 v[196:199], v20 offset:320
    ds_read_b128 v[200:203], v20 offset:384
    ds_read_b128 v[204:207], v20 offset:448
    s_add_u32 m0, s84, 2112
    s_add_u32 s95, s95, 524288
    buffer_load_dwordx4 v23, s[20:23], s95 offen lds
    v_lshlrev_b32 v4, 16, v4
    v_mov_b32 v5, v4
    v_mov_b32 v6, v4
    v_mov_b32 v7, v4
    s_mov_b32 s28, s56
    s_mov_b32 s29, s57
    s_add_u32 m0, s84, 3168
    s_add_u32 s95, s95, 524288
    buffer_load_dwordx4 v23, s[20:23], s95 offen lds
    s_mov_b32 s30, 1835008
    s_add_u32 s76, s0, 147456
    v_lshlrev_b32 v249, 3, v1
    v_lshl_add_u32 v248, v2, 2, v249
    v_lshl_add_u32 v249, v2, 8, v249
    s_add_u32 m0, s84, 4224
    s_add_u32 s95, s95, 524288
    buffer_load_dwordx4 v23, s[20:23], s95 offen lds
    v_lshrrev_b32 v16, 2, v1
    v_xor_b32 v244, v16, v2
    v_lshl_add_u32 v244, v244, 3, s76
    v_and_b32 v17, 3, v1
    v_lshl_add_u32 v244, v17, 5, v244
    v_bfe_u32 v18, v1, 2, 1
    s_add_u32 m0, s84, 5280
    s_add_u32 s95, s95, 524288
    buffer_load_dwordx4 v23, s[20:23], s95 offen lds
    v_lshl_add_u32 v244, v18, 8, v244
    v_bfe_u32 v18, v1, 3, 1
    v_lshl_add_u32 v244, v18, 7, v244
    v_and_b32 v18, 1, v2
    v_lshlrev_b32 v19, 1, v18
    s_add_u32 m0, s84, 6336
    s_add_u32 s95, s95, 524288
    buffer_load_dwordx4 v23, s[20:23], s95 offen lds
    v_xor_b32 v245, v17, v19
    v_lshl_add_u32 v245, v245, 3, s76
    v_lshl_add_u32 v245, v16, 5, v245
    v_lshl_add_u32 v245, v18, 7, v245
    v_lshrrev_b32 v19, 1, v2
    v_lshl_add_u32 v245, v19, 9, v245
    s_add_u32 m0, s84, 7392
    s_add_u32 s95, s95, 524288
    buffer_load_dwordx4 v23, s[20:23], s95 offen lds
    v_xor_b32 v246, 8, v245
    v_lshlrev_b32 v247, 4, v1
    v_lshl_add_u32 v18, v19, 2, v18
    v_mul_u32_u24 v18, 16384, v18
    v_add_u32 v247, v247, v18
    s_waitcnt lgkmcnt(0)
    s_waitcnt vmcnt(9)
    ds_read_b128 v[208:211], v21 offset:0
    ds_read_b128 v[212:215], v21 offset:64
    ds_read_b128 v[216:219], v21 offset:128
    ds_read_b128 v[220:223], v21 offset:192
    ds_read_b128 v[224:227], v21 offset:256
    ds_read_b128 v[228:231], v21 offset:320
    ds_read_b128 v[232:235], v21 offset:384
    ds_read_b128 v[236:239], v21 offset:448
    s_add_u32 m0, s82, 0
    s_add_u32 s95, s62, 1
    s_bitcmp1_b32 s95, 1
    s_cselect_b32 s77, s69, s64
    s_and_b32 s95, s95, 1
    s_lshl_b32 s95, s95, 10
    s_add_u32 s95, s95, s77
    s_lshl_b32 s95, s95, 12
    s_add_u32 s95, s95, s91
    s_add_u32 s95, s95, 512
    buffer_load_dwordx4 v23, s[20:23], s95 offen lds
    .p2align 3
    v_perm_b32 v240, v184, v176, s74
    v_perm_b32 v241, v200, v192, s74
    v_perm_b32 v242, v184, v176, s75
    v_perm_b32 v243, v200, v192, s75
    v_accvgpr_write_b32 a0, v240
    v_accvgpr_write_b32 a1, v241
    v_accvgpr_write_b32 a4, v242
    v_accvgpr_write_b32 a5, v243
    s_add_u32 m0, s82, 1056
    s_add_u32 s95, s95, 524288
    buffer_load_dwordx4 v23, s[20:23], s95 offen lds
    v_perm_b32 v240, v185, v177, s74
    v_perm_b32 v241, v201, v193, s74
    v_perm_b32 v242, v185, v177, s75
    v_perm_b32 v243, v201, v193, s75
    v_accvgpr_write_b32 a8, v240
    v_accvgpr_write_b32 a9, v241
    v_accvgpr_write_b32 a12, v242
    v_accvgpr_write_b32 a13, v243
    s_add_u32 m0, s82, 2112
    s_add_u32 s95, s95, 524288
    buffer_load_dwordx4 v23, s[20:23], s95 offen lds
    v_perm_b32 v240, v186, v178, s74
    v_perm_b32 v241, v202, v194, s74
    v_perm_b32 v242, v186, v178, s75
    v_perm_b32 v243, v202, v194, s75
    v_accvgpr_write_b32 a16, v240
    v_accvgpr_write_b32 a17, v241
    v_accvgpr_write_b32 a20, v242
    v_accvgpr_write_b32 a21, v243
    s_add_u32 m0, s82, 3168
    s_add_u32 s95, s95, 524288
    buffer_load_dwordx4 v23, s[20:23], s95 offen lds
    v_perm_b32 v240, v187, v179, s74
    v_perm_b32 v241, v203, v195, s74
    v_perm_b32 v242, v187, v179, s75
    v_perm_b32 v243, v203, v195, s75
    v_accvgpr_write_b32 a24, v240
    v_accvgpr_write_b32 a25, v241
    v_accvgpr_write_b32 a28, v242
    v_accvgpr_write_b32 a29, v243
    s_add_u32 m0, s82, 4224
    s_add_u32 s95, s95, 524288
    buffer_load_dwordx4 v23, s[20:23], s95 offen lds
    v_perm_b32 v240, v188, v180, s74
    v_perm_b32 v241, v204, v196, s74
    v_perm_b32 v242, v188, v180, s75
    v_perm_b32 v243, v204, v196, s75
    v_accvgpr_write_b32 a32, v240
    v_accvgpr_write_b32 a33, v241
    v_accvgpr_write_b32 a36, v242
    v_accvgpr_write_b32 a37, v243
    s_add_u32 m0, s82, 5280
    s_add_u32 s95, s95, 524288
    buffer_load_dwordx4 v23, s[20:23], s95 offen lds
    v_perm_b32 v240, v189, v181, s74
    v_perm_b32 v241, v205, v197, s74
    v_perm_b32 v242, v189, v181, s75
    v_perm_b32 v243, v205, v197, s75
    v_accvgpr_write_b32 a40, v240
    v_accvgpr_write_b32 a41, v241
    v_accvgpr_write_b32 a44, v242
    v_accvgpr_write_b32 a45, v243
    s_add_u32 m0, s82, 6336
    s_add_u32 s95, s95, 524288
    buffer_load_dwordx4 v23, s[20:23], s95 offen lds
    v_perm_b32 v240, v190, v182, s74
    v_perm_b32 v241, v206, v198, s74
    v_perm_b32 v242, v190, v182, s75
    v_perm_b32 v243, v206, v198, s75
    v_accvgpr_write_b32 a48, v240
    v_accvgpr_write_b32 a49, v241
    v_accvgpr_write_b32 a52, v242
    v_accvgpr_write_b32 a53, v243
    s_add_u32 m0, s82, 7392
    s_add_u32 s95, s95, 524288
    buffer_load_dwordx4 v23, s[20:23], s95 offen lds
    v_perm_b32 v240, v191, v183, s74
    v_perm_b32 v241, v207, v199, s74
    v_perm_b32 v242, v191, v183, s75
    v_perm_b32 v243, v207, v199, s75
    v_accvgpr_write_b32 a56, v240
    v_accvgpr_write_b32 a57, v241
    v_accvgpr_write_b32 a60, v242
    v_accvgpr_write_b32 a61, v243
    s_waitcnt lgkmcnt(0)
    s_waitcnt vmcnt(8)
    ds_read_b128 v[176:179], v22 offset:0
    ds_read_b128 v[180:183], v22 offset:64
    ds_read_b128 v[184:187], v22 offset:128
    ds_read_b128 v[188:191], v22 offset:192
    ds_read_b128 v[192:195], v22 offset:256
    ds_read_b128 v[196:199], v22 offset:320
    ds_read_b128 v[200:203], v22 offset:384
    ds_read_b128 v[204:207], v22 offset:448
    s_add_u32 m0, s83, 0
    s_add_u32 s95, s62, 2
    s_bitcmp1_b32 s95, 1
    s_cselect_b32 s77, s69, s64
    s_and_b32 s95, s95, 1
    s_lshl_b32 s95, s95, 10
    s_add_u32 s95, s95, s77
    s_lshl_b32 s95, s95, 12
    s_add_u32 s95, s95, s91
    s_add_u32 s95, s95, 0
    buffer_load_dwordx4 v23, s[20:23], s95 offen lds
    .p2align 3
    v_perm_b32 v240, v216, v208, s74
    v_perm_b32 v241, v232, v224, s74
    v_perm_b32 v242, v216, v208, s75
    v_perm_b32 v243, v232, v224, s75
    v_accvgpr_write_b32 a2, v240
    v_accvgpr_write_b32 a3, v241
    v_accvgpr_write_b32 a6, v242
    v_accvgpr_write_b32 a7, v243
    s_add_u32 m0, s83, 1056
    s_add_u32 s95, s95, 524288
    buffer_load_dwordx4 v23, s[20:23], s95 offen lds
    v_perm_b32 v240, v217, v209, s74
    v_perm_b32 v241, v233, v225, s74
    v_perm_b32 v242, v217, v209, s75
    v_perm_b32 v243, v233, v225, s75
    v_accvgpr_write_b32 a10, v240
    v_accvgpr_write_b32 a11, v241
    v_accvgpr_write_b32 a14, v242
    v_accvgpr_write_b32 a15, v243
    s_add_u32 m0, s83, 2112
    s_add_u32 s95, s95, 524288
    buffer_load_dwordx4 v23, s[20:23], s95 offen lds
    v_perm_b32 v240, v218, v210, s74
    v_perm_b32 v241, v234, v226, s74
    v_perm_b32 v242, v218, v210, s75
    v_perm_b32 v243, v234, v226, s75
    v_accvgpr_write_b32 a18, v240
    v_accvgpr_write_b32 a19, v241
    v_accvgpr_write_b32 a22, v242
    v_accvgpr_write_b32 a23, v243
    s_add_u32 m0, s83, 3168
    s_add_u32 s95, s95, 524288
    buffer_load_dwordx4 v23, s[20:23], s95 offen lds
    v_perm_b32 v240, v219, v211, s74
    v_perm_b32 v241, v235, v227, s74
    v_perm_b32 v242, v219, v211, s75
    v_perm_b32 v243, v235, v227, s75
    v_accvgpr_write_b32 a26, v240
    v_accvgpr_write_b32 a27, v241
    v_accvgpr_write_b32 a30, v242
    v_accvgpr_write_b32 a31, v243
    s_add_u32 m0, s83, 4224
    s_add_u32 s95, s95, 524288
    buffer_load_dwordx4 v23, s[20:23], s95 offen lds
    v_perm_b32 v240, v220, v212, s74
    v_perm_b32 v241, v236, v228, s74
    v_perm_b32 v242, v220, v212, s75
    v_perm_b32 v243, v236, v228, s75
    v_accvgpr_write_b32 a34, v240
    v_accvgpr_write_b32 a35, v241
    v_accvgpr_write_b32 a38, v242
    v_accvgpr_write_b32 a39, v243
    s_add_u32 m0, s83, 5280
    s_add_u32 s95, s95, 524288
    buffer_load_dwordx4 v23, s[20:23], s95 offen lds
    v_perm_b32 v240, v221, v213, s74
    v_perm_b32 v241, v237, v229, s74
    v_perm_b32 v242, v221, v213, s75
    v_perm_b32 v243, v237, v229, s75
    v_accvgpr_write_b32 a42, v240
    v_accvgpr_write_b32 a43, v241
    v_accvgpr_write_b32 a46, v242
    v_accvgpr_write_b32 a47, v243
    s_add_u32 m0, s83, 6336
    s_add_u32 s95, s95, 524288
    buffer_load_dwordx4 v23, s[20:23], s95 offen lds
    v_perm_b32 v240, v222, v214, s74
    v_perm_b32 v241, v238, v230, s74
    v_perm_b32 v242, v222, v214, s75
    v_perm_b32 v243, v238, v230, s75
    v_accvgpr_write_b32 a50, v240
    v_accvgpr_write_b32 a51, v241
    v_accvgpr_write_b32 a54, v242
    v_accvgpr_write_b32 a55, v243
    s_add_u32 m0, s83, 7392
    s_add_u32 s95, s95, 524288
    buffer_load_dwordx4 v23, s[20:23], s95 offen lds
    v_perm_b32 v240, v223, v215, s74
    v_perm_b32 v241, v239, v231, s74
    v_perm_b32 v242, v223, v215, s75
    v_perm_b32 v243, v239, v231, s75
    v_accvgpr_write_b32 a58, v240
    v_accvgpr_write_b32 a59, v241
    v_accvgpr_write_b32 a62, v242
    v_accvgpr_write_b32 a63, v243
    s_waitcnt lgkmcnt(0)
    s_waitcnt vmcnt(8)
    ds_read_b128 v[208:211], v20 offset:0
    ds_read_b128 v[212:215], v20 offset:64
    ds_read_b128 v[216:219], v20 offset:128
    ds_read_b128 v[220:223], v20 offset:192
    ds_read_b128 v[224:227], v20 offset:256
    ds_read_b128 v[228:231], v20 offset:320
    ds_read_b128 v[232:235], v20 offset:384
    ds_read_b128 v[236:239], v20 offset:448
    s_add_u32 m0, s84, 0
    s_add_u32 s95, s62, 2
    s_bitcmp1_b32 s95, 1
    s_cselect_b32 s77, s69, s64
    s_and_b32 s95, s95, 1
    s_lshl_b32 s95, s95, 10
    s_add_u32 s95, s95, s77
    s_lshl_b32 s95, s95, 12
    s_add_u32 s95, s95, s91
    s_add_u32 s95, s95, 512
    buffer_load_dwordx4 v23, s[20:23], s95 offen lds
    .p2align 3
    v_perm_b32 v240, v184, v176, s74
    v_perm_b32 v241, v200, v192, s74
    v_perm_b32 v242, v184, v176, s75
    v_perm_b32 v243, v200, v192, s75
    v_accvgpr_write_b32 a64, v240
    v_accvgpr_write_b32 a65, v241
    v_accvgpr_write_b32 a68, v242
    v_accvgpr_write_b32 a69, v243
    s_add_u32 m0, s84, 1056
    s_add_u32 s95, s95, 524288
    buffer_load_dwordx4 v23, s[20:23], s95 offen lds
    v_perm_b32 v240, v185, v177, s74
    v_perm_b32 v241, v201, v193, s74
    v_perm_b32 v242, v185, v177, s75
    v_perm_b32 v243, v201, v193, s75
    v_accvgpr_write_b32 a72, v240
    v_accvgpr_write_b32 a73, v241
    v_accvgpr_write_b32 a76, v242
    v_accvgpr_write_b32 a77, v243
    s_add_u32 m0, s84, 2112
    s_add_u32 s95, s95, 524288
    buffer_load_dwordx4 v23, s[20:23], s95 offen lds
    v_perm_b32 v240, v186, v178, s74
    v_perm_b32 v241, v202, v194, s74
    v_perm_b32 v242, v186, v178, s75
    v_perm_b32 v243, v202, v194, s75
    v_accvgpr_write_b32 a80, v240
    v_accvgpr_write_b32 a81, v241
    v_accvgpr_write_b32 a84, v242
    v_accvgpr_write_b32 a85, v243
    s_add_u32 m0, s84, 3168
    s_add_u32 s95, s95, 524288
    buffer_load_dwordx4 v23, s[20:23], s95 offen lds
    v_perm_b32 v240, v187, v179, s74
    v_perm_b32 v241, v203, v195, s74
    v_perm_b32 v242, v187, v179, s75
    v_perm_b32 v243, v203, v195, s75
    v_accvgpr_write_b32 a88, v240
    v_accvgpr_write_b32 a89, v241
    v_accvgpr_write_b32 a92, v242
    v_accvgpr_write_b32 a93, v243
    s_add_u32 m0, s84, 4224
    s_add_u32 s95, s95, 524288
    buffer_load_dwordx4 v23, s[20:23], s95 offen lds
    v_perm_b32 v240, v188, v180, s74
    v_perm_b32 v241, v204, v196, s74
    v_perm_b32 v242, v188, v180, s75
    v_perm_b32 v243, v204, v196, s75
    v_accvgpr_write_b32 a96, v240
    v_accvgpr_write_b32 a97, v241
    v_accvgpr_write_b32 a100, v242
    v_accvgpr_write_b32 a101, v243
    s_add_u32 m0, s84, 5280
    s_add_u32 s95, s95, 524288
    buffer_load_dwordx4 v23, s[20:23], s95 offen lds
    v_perm_b32 v240, v189, v181, s74
    v_perm_b32 v241, v205, v197, s74
    v_perm_b32 v242, v189, v181, s75
    v_perm_b32 v243, v205, v197, s75
    v_accvgpr_write_b32 a104, v240
    v_accvgpr_write_b32 a105, v241
    v_accvgpr_write_b32 a108, v242
    v_accvgpr_write_b32 a109, v243
    s_add_u32 m0, s84, 6336
    s_add_u32 s95, s95, 524288
    buffer_load_dwordx4 v23, s[20:23], s95 offen lds
    v_perm_b32 v240, v190, v182, s74
    v_perm_b32 v241, v206, v198, s74
    v_perm_b32 v242, v190, v182, s75
    v_perm_b32 v243, v206, v198, s75
    v_accvgpr_write_b32 a112, v240
    v_accvgpr_write_b32 a113, v241
    v_accvgpr_write_b32 a116, v242
    v_accvgpr_write_b32 a117, v243
    s_add_u32 m0, s84, 7392
    s_add_u32 s95, s95, 524288
    buffer_load_dwordx4 v23, s[20:23], s95 offen lds
    v_perm_b32 v240, v191, v183, s74
    v_perm_b32 v241, v207, v199, s74
    v_perm_b32 v242, v191, v183, s75
    v_perm_b32 v243, v207, v199, s75
    v_accvgpr_write_b32 a120, v240
    v_accvgpr_write_b32 a121, v241
    v_accvgpr_write_b32 a124, v242
    v_accvgpr_write_b32 a125, v243
    s_waitcnt lgkmcnt(0)
    s_waitcnt vmcnt(8)
    ds_read_b128 v[176:179], v21 offset:0
    ds_read_b128 v[180:183], v21 offset:64
    ds_read_b128 v[184:187], v21 offset:128
    ds_read_b128 v[188:191], v21 offset:192
    ds_read_b128 v[192:195], v21 offset:256
    ds_read_b128 v[196:199], v21 offset:320
    ds_read_b128 v[200:203], v21 offset:384
    ds_read_b128 v[204:207], v21 offset:448
    s_add_u32 m0, s82, 0
    s_add_u32 s95, s62, 3
    s_bitcmp1_b32 s95, 1
    s_cselect_b32 s77, s69, s64
    s_and_b32 s95, s95, 1
    s_lshl_b32 s95, s95, 10
    s_add_u32 s95, s95, s77
    s_lshl_b32 s95, s95, 12
    s_add_u32 s95, s95, s91
    s_add_u32 s95, s95, 0
    buffer_load_dwordx4 v23, s[20:23], s95 offen lds
    .p2align 3
    v_perm_b32 v240, v216, v208, s74
    v_perm_b32 v241, v232, v224, s74
    v_perm_b32 v242, v216, v208, s75
    v_perm_b32 v243, v232, v224, s75
    v_accvgpr_write_b32 a66, v240
    v_accvgpr_write_b32 a67, v241
    v_accvgpr_write_b32 a70, v242
    v_accvgpr_write_b32 a71, v243
    s_add_u32 m0, s82, 1056
    s_add_u32 s95, s95, 524288
    buffer_load_dwordx4 v23, s[20:23], s95 offen lds
    v_perm_b32 v240, v217, v209, s74
    v_perm_b32 v241, v233, v225, s74
    v_perm_b32 v242, v217, v209, s75
    v_perm_b32 v243, v233, v225, s75
    v_accvgpr_write_b32 a74, v240
    v_accvgpr_write_b32 a75, v241
    v_accvgpr_write_b32 a78, v242
    v_accvgpr_write_b32 a79, v243
    s_add_u32 m0, s82, 2112
    s_add_u32 s95, s95, 524288
    buffer_load_dwordx4 v23, s[20:23], s95 offen lds
    v_perm_b32 v240, v218, v210, s74
    v_perm_b32 v241, v234, v226, s74
    v_perm_b32 v242, v218, v210, s75
    v_perm_b32 v243, v234, v226, s75
    v_accvgpr_write_b32 a82, v240
    v_accvgpr_write_b32 a83, v241
    v_accvgpr_write_b32 a86, v242
    v_accvgpr_write_b32 a87, v243
    s_add_u32 m0, s82, 3168
    s_add_u32 s95, s95, 524288
    buffer_load_dwordx4 v23, s[20:23], s95 offen lds
    v_perm_b32 v240, v219, v211, s74
    v_perm_b32 v241, v235, v227, s74
    v_perm_b32 v242, v219, v211, s75
    v_perm_b32 v243, v235, v227, s75
    v_accvgpr_write_b32 a90, v240
    v_accvgpr_write_b32 a91, v241
    v_accvgpr_write_b32 a94, v242
    v_accvgpr_write_b32 a95, v243
    s_add_u32 m0, s82, 4224
    s_add_u32 s95, s95, 524288
    buffer_load_dwordx4 v23, s[20:23], s95 offen lds
    v_perm_b32 v240, v220, v212, s74
    v_perm_b32 v241, v236, v228, s74
    v_perm_b32 v242, v220, v212, s75
    v_perm_b32 v243, v236, v228, s75
    v_accvgpr_write_b32 a98, v240
    v_accvgpr_write_b32 a99, v241
    v_accvgpr_write_b32 a102, v242
    v_accvgpr_write_b32 a103, v243
    s_add_u32 m0, s82, 5280
    s_add_u32 s95, s95, 524288
    buffer_load_dwordx4 v23, s[20:23], s95 offen lds
    v_perm_b32 v240, v221, v213, s74
    v_perm_b32 v241, v237, v229, s74
    v_perm_b32 v242, v221, v213, s75
    v_perm_b32 v243, v237, v229, s75
    v_accvgpr_write_b32 a106, v240
    v_accvgpr_write_b32 a107, v241
    v_accvgpr_write_b32 a110, v242
    v_accvgpr_write_b32 a111, v243
    s_add_u32 m0, s82, 6336
    s_add_u32 s95, s95, 524288
    buffer_load_dwordx4 v23, s[20:23], s95 offen lds
    v_perm_b32 v240, v222, v214, s74
    v_perm_b32 v241, v238, v230, s74
    v_perm_b32 v242, v222, v214, s75
    v_perm_b32 v243, v238, v230, s75
    v_accvgpr_write_b32 a114, v240
    v_accvgpr_write_b32 a115, v241
    v_accvgpr_write_b32 a118, v242
    v_accvgpr_write_b32 a119, v243
    s_add_u32 m0, s82, 7392
    s_add_u32 s95, s95, 524288
    buffer_load_dwordx4 v23, s[20:23], s95 offen lds
    v_perm_b32 v240, v223, v215, s74
    v_perm_b32 v241, v239, v231, s74
    v_perm_b32 v242, v223, v215, s75
    v_perm_b32 v243, v239, v231, s75
    v_accvgpr_write_b32 a122, v240
    v_accvgpr_write_b32 a123, v241
    v_accvgpr_write_b32 a126, v242
    v_accvgpr_write_b32 a127, v243
    s_waitcnt lgkmcnt(0)
    s_waitcnt vmcnt(8)
    ds_read_b128 v[208:211], v22 offset:0
    ds_read_b128 v[212:215], v22 offset:64
    ds_read_b128 v[216:219], v22 offset:128
    ds_read_b128 v[220:223], v22 offset:192
    ds_read_b128 v[224:227], v22 offset:256
    ds_read_b128 v[228:231], v22 offset:320
    ds_read_b128 v[232:235], v22 offset:384
    ds_read_b128 v[236:239], v22 offset:448
    s_lshl_b32 s76, s67, 10
    s_add_u32 s76, s76, 20480
    s_mov_b32 s78, 32
    v_lshl_add_u32 v253, v0, 7, s76
    s_mov_b64 exec, s[46:47]
    buffer_load_dword v254, v253, s[8:11], 0 offen sc1
    s_mov_b64 exec, -1
    s_add_u32 m0, s83, 0
    s_add_u32 s95, s62, 3
    s_bitcmp1_b32 s95, 1
    s_cselect_b32 s77, s69, s64
    s_and_b32 s95, s95, 1
    s_lshl_b32 s95, s95, 10
    s_add_u32 s95, s95, s77
    s_lshl_b32 s95, s95, 12
    s_add_u32 s95, s95, s91
    s_add_u32 s95, s95, 512
    buffer_load_dwordx4 v23, s[20:23], s95 offen lds
    .p2align 3
    v_perm_b32 v240, v184, v176, s74
    v_perm_b32 v241, v200, v192, s74
    v_perm_b32 v242, v184, v176, s75
    v_perm_b32 v243, v200, v192, s75
    v_accvgpr_write_b32 a128, v240
    v_accvgpr_write_b32 a129, v241
    v_accvgpr_write_b32 a132, v242
    v_accvgpr_write_b32 a133, v243
    s_add_u32 m0, s83, 1056
    s_add_u32 s95, s95, 524288
    buffer_load_dwordx4 v23, s[20:23], s95 offen lds
    v_perm_b32 v240, v185, v177, s74
    v_perm_b32 v241, v201, v193, s74
    v_perm_b32 v242, v185, v177, s75
    v_perm_b32 v243, v201, v193, s75
    v_accvgpr_write_b32 a136, v240
    v_accvgpr_write_b32 a137, v241
    v_accvgpr_write_b32 a140, v242
    v_accvgpr_write_b32 a141, v243
    s_add_u32 m0, s83, 2112
    s_add_u32 s95, s95, 524288
    buffer_load_dwordx4 v23, s[20:23], s95 offen lds
    v_perm_b32 v240, v186, v178, s74
    v_perm_b32 v241, v202, v194, s74
    v_perm_b32 v242, v186, v178, s75
    v_perm_b32 v243, v202, v194, s75
    v_accvgpr_write_b32 a144, v240
    v_accvgpr_write_b32 a145, v241
    v_accvgpr_write_b32 a148, v242
    v_accvgpr_write_b32 a149, v243
    s_add_u32 m0, s83, 3168
    s_add_u32 s95, s95, 524288
    buffer_load_dwordx4 v23, s[20:23], s95 offen lds
    v_perm_b32 v240, v187, v179, s74
    v_perm_b32 v241, v203, v195, s74
    v_perm_b32 v242, v187, v179, s75
    v_perm_b32 v243, v203, v195, s75
    v_accvgpr_write_b32 a152, v240
    v_accvgpr_write_b32 a153, v241
    v_accvgpr_write_b32 a156, v242
    v_accvgpr_write_b32 a157, v243
    s_add_u32 m0, s83, 4224
    s_add_u32 s95, s95, 524288
    buffer_load_dwordx4 v23, s[20:23], s95 offen lds
    v_perm_b32 v240, v188, v180, s74
    v_perm_b32 v241, v204, v196, s74
    v_perm_b32 v242, v188, v180, s75
    v_perm_b32 v243, v204, v196, s75
    v_accvgpr_write_b32 a160, v240
    v_accvgpr_write_b32 a161, v241
    v_accvgpr_write_b32 a164, v242
    v_accvgpr_write_b32 a165, v243
    s_add_u32 m0, s83, 5280
    s_add_u32 s95, s95, 524288
    buffer_load_dwordx4 v23, s[20:23], s95 offen lds
    v_perm_b32 v240, v189, v181, s74
    v_perm_b32 v241, v205, v197, s74
    v_perm_b32 v242, v189, v181, s75
    v_perm_b32 v243, v205, v197, s75
    v_accvgpr_write_b32 a168, v240
    v_accvgpr_write_b32 a169, v241
    v_accvgpr_write_b32 a172, v242
    v_accvgpr_write_b32 a173, v243
    s_add_u32 m0, s83, 6336
    s_add_u32 s95, s95, 524288
    buffer_load_dwordx4 v23, s[20:23], s95 offen lds
    v_perm_b32 v240, v190, v182, s74
    v_perm_b32 v241, v206, v198, s74
    v_perm_b32 v242, v190, v182, s75
    v_perm_b32 v243, v206, v198, s75
    v_accvgpr_write_b32 a176, v240
    v_accvgpr_write_b32 a177, v241
    v_accvgpr_write_b32 a180, v242
    v_accvgpr_write_b32 a181, v243
    s_add_u32 m0, s83, 7392
    s_add_u32 s95, s95, 524288
    buffer_load_dwordx4 v23, s[20:23], s95 offen lds
    v_perm_b32 v240, v191, v183, s74
    v_perm_b32 v241, v207, v199, s74
    v_perm_b32 v242, v191, v183, s75
    v_perm_b32 v243, v207, v199, s75
    v_accvgpr_write_b32 a184, v240
    v_accvgpr_write_b32 a185, v241
    v_accvgpr_write_b32 a188, v242
    v_accvgpr_write_b32 a189, v243
    s_waitcnt lgkmcnt(0)
    s_waitcnt vmcnt(9)
    ds_read_b128 v[176:179], v20 offset:0
    ds_read_b128 v[180:183], v20 offset:64
    ds_read_b128 v[184:187], v20 offset:128
    ds_read_b128 v[188:191], v20 offset:192
    ds_read_b128 v[192:195], v20 offset:256
    ds_read_b128 v[196:199], v20 offset:320
    ds_read_b128 v[200:203], v20 offset:384
    ds_read_b128 v[204:207], v20 offset:448
    s_waitcnt vmcnt(8)
    s_mov_b64 exec, s[46:47]
    v_cmp_gt_u32 vcc, s78, v254
    s_cbranch_vccz wg_done
    s_mov_b32 s98, 0
interleave_layers__spectral_fnet__mixer_gmlp__prompt_kernel_poll_2:
    buffer_load_dword v254, v253, s[8:11], 0 offen sc1
    s_add_u32 s98, s98, 1
    s_cmp_gt_u32 s98, 1048576
    s_cbranch_scc1 interleave_layers__spectral_fnet__mixer_gmlp__prompt_kernel_poll_2_x
    s_waitcnt vmcnt(0)
    v_cmp_gt_u32 vcc, s78, v254
    s_cbranch_vccnz interleave_layers__spectral_fnet__mixer_gmlp__prompt_kernel_poll_2
interleave_layers__spectral_fnet__mixer_gmlp__prompt_kernel_poll_2_x:
wg_done:
    s_mov_b64 exec, -1
    s_barrier
    s_mov_b32 s98, 0
    v_mov_b32 v253, 0
    buffer_load_dword v254, v253, s[32:35], 0 offen offset:128 sc1
    s_add_u32 m0, s48, 0
    s_add_u32 s85, s49, 0
    buffer_load_dwordx4 v56, s[8:11], s85 offen sc1 lds
    .p2align 3
    v_perm_b32 v240, v216, v208, s74
    v_perm_b32 v241, v232, v224, s74
    v_perm_b32 v242, v216, v208, s75
    v_perm_b32 v243, v232, v224, s75
    v_accvgpr_write_b32 a130, v240
    v_accvgpr_write_b32 a131, v241
    v_accvgpr_write_b32 a134, v242
    v_accvgpr_write_b32 a135, v243
    buffer_load_dwordx4 v56, s[8:11], s85 offen offset:1024 sc1 lds
    v_perm_b32 v240, v217, v209, s74
    v_perm_b32 v241, v233, v225, s74
    v_perm_b32 v242, v217, v209, s75
    v_perm_b32 v243, v233, v225, s75
    v_accvgpr_write_b32 a138, v240
    v_accvgpr_write_b32 a139, v241
    v_accvgpr_write_b32 a142, v242
    v_accvgpr_write_b32 a143, v243
    s_add_u32 m0, s48, 4096
    s_add_u32 s85, s49, 4096
    buffer_load_dwordx4 v56, s[8:11], s85 offen sc1 lds
    v_perm_b32 v240, v218, v210, s74
    v_perm_b32 v241, v234, v226, s74
    v_perm_b32 v242, v218, v210, s75
    v_perm_b32 v243, v234, v226, s75
    v_accvgpr_write_b32 a146, v240
    v_accvgpr_write_b32 a147, v241
    v_accvgpr_write_b32 a150, v242
    v_accvgpr_write_b32 a151, v243
    buffer_load_dwordx4 v56, s[8:11], s85 offen offset:1024 sc1 lds
    v_perm_b32 v240, v219, v211, s74
    v_perm_b32 v241, v235, v227, s74
    v_perm_b32 v242, v219, v211, s75
    v_perm_b32 v243, v235, v227, s75
    v_accvgpr_write_b32 a154, v240
    v_accvgpr_write_b32 a155, v241
    v_accvgpr_write_b32 a158, v242
    v_accvgpr_write_b32 a159, v243
    s_add_u32 m0, s48, 8192
    s_add_u32 s85, s49, 24576
    buffer_load_dwordx4 v56, s[8:11], s85 offen sc1 lds
    v_perm_b32 v240, v220, v212, s74
    v_perm_b32 v241, v236, v228, s74
    v_perm_b32 v242, v220, v212, s75
    v_perm_b32 v243, v236, v228, s75
    v_accvgpr_write_b32 a162, v240
    v_accvgpr_write_b32 a163, v241
    v_accvgpr_write_b32 a166, v242
    v_accvgpr_write_b32 a167, v243
    buffer_load_dwordx4 v56, s[8:11], s85 offen offset:1024 sc1 lds
    v_perm_b32 v240, v221, v213, s74
    v_perm_b32 v241, v237, v229, s74
    v_perm_b32 v242, v221, v213, s75
    v_perm_b32 v243, v237, v229, s75
    v_accvgpr_write_b32 a170, v240
    v_accvgpr_write_b32 a171, v241
    v_accvgpr_write_b32 a174, v242
    v_accvgpr_write_b32 a175, v243
    s_add_u32 m0, s48, 12288
    s_add_u32 s85, s49, 28672
    buffer_load_dwordx4 v56, s[8:11], s85 offen sc1 lds
    v_perm_b32 v240, v222, v214, s74
    v_perm_b32 v241, v238, v230, s74
    v_perm_b32 v242, v222, v214, s75
    v_perm_b32 v243, v238, v230, s75
    v_accvgpr_write_b32 a178, v240
    v_accvgpr_write_b32 a179, v241
    v_accvgpr_write_b32 a182, v242
    v_accvgpr_write_b32 a183, v243
    buffer_load_dwordx4 v56, s[8:11], s85 offen offset:1024 sc1 lds
    v_perm_b32 v240, v223, v215, s74
    v_perm_b32 v241, v239, v231, s74
    v_perm_b32 v242, v223, v215, s75
    v_perm_b32 v243, v239, v231, s75
    v_accvgpr_write_b32 a186, v240
    v_accvgpr_write_b32 a187, v241
    v_accvgpr_write_b32 a190, v242
    v_accvgpr_write_b32 a191, v243
    s_waitcnt lgkmcnt(0)
    s_waitcnt vmcnt(9)
    ds_read_b128 v[208:211], v21 offset:0
    ds_read_b128 v[212:215], v21 offset:64
    ds_read_b128 v[216:219], v21 offset:128
    ds_read_b128 v[220:223], v21 offset:192
    ds_read_b128 v[224:227], v21 offset:256
    ds_read_b128 v[228:231], v21 offset:320
    ds_read_b128 v[232:235], v21 offset:384
    ds_read_b128 v[236:239], v21 offset:448
    s_add_u32 m0, s48, 16384
    s_add_u32 s85, s49, 32768
    buffer_load_dwordx4 v56, s[8:11], s85 offen sc1 lds
    .p2align 3
    v_perm_b32 v240, v184, v176, s74
    v_perm_b32 v241, v200, v192, s74
    v_perm_b32 v242, v184, v176, s75
    v_perm_b32 v243, v200, v192, s75
    v_accvgpr_write_b32 a192, v240
    v_accvgpr_write_b32 a193, v241
    v_accvgpr_write_b32 a196, v242
    v_accvgpr_write_b32 a197, v243
    v_perm_b32 v240, v185, v177, s74
    v_perm_b32 v241, v201, v193, s74
    buffer_load_dwordx4 v56, s[8:11], s85 offen offset:1024 sc1 lds
    v_perm_b32 v242, v185, v177, s75
    v_perm_b32 v243, v201, v193, s75
    v_accvgpr_write_b32 a200, v240
    v_accvgpr_write_b32 a201, v241
    v_accvgpr_write_b32 a204, v242
    v_accvgpr_write_b32 a205, v243
    v_perm_b32 v240, v186, v178, s74
    v_perm_b32 v241, v202, v194, s74
    v_perm_b32 v242, v186, v178, s75
    v_perm_b32 v243, v202, v194, s75
    v_accvgpr_write_b32 a208, v240
    s_add_u32 m0, s48, 20480
    s_add_u32 s85, s49, 36864
    buffer_load_dwordx4 v56, s[8:11], s85 offen sc1 lds
    v_accvgpr_write_b32 a209, v241
    v_accvgpr_write_b32 a212, v242
    v_accvgpr_write_b32 a213, v243
    v_perm_b32 v240, v187, v179, s74
    v_perm_b32 v241, v203, v195, s74
    v_perm_b32 v242, v187, v179, s75
    v_perm_b32 v243, v203, v195, s75
    v_accvgpr_write_b32 a216, v240
    v_accvgpr_write_b32 a217, v241
    v_accvgpr_write_b32 a220, v242
    v_accvgpr_write_b32 a221, v243
    buffer_load_dwordx4 v56, s[8:11], s85 offen offset:1024 sc1 lds
    v_perm_b32 v240, v188, v180, s74
    v_perm_b32 v241, v204, v196, s74
    v_perm_b32 v242, v188, v180, s75
    v_perm_b32 v243, v204, v196, s75
    v_accvgpr_write_b32 a224, v240
    v_accvgpr_write_b32 a225, v241
    v_accvgpr_write_b32 a228, v242
    v_accvgpr_write_b32 a229, v243
    v_perm_b32 v240, v189, v181, s74
    v_perm_b32 v241, v205, v197, s74
    v_perm_b32 v242, v189, v181, s75
    s_add_u32 m0, s48, 24576
    s_add_u32 s85, s49, 57344
    buffer_load_dwordx4 v56, s[8:11], s85 offen sc1 lds
    v_perm_b32 v243, v205, v197, s75
    v_accvgpr_write_b32 a232, v240
    v_accvgpr_write_b32 a233, v241
    v_accvgpr_write_b32 a236, v242
    v_accvgpr_write_b32 a237, v243
    v_perm_b32 v240, v190, v182, s74
    v_perm_b32 v241, v206, v198, s74
    v_perm_b32 v242, v190, v182, s75
    v_perm_b32 v243, v206, v198, s75
    v_accvgpr_write_b32 a240, v240
    v_accvgpr_write_b32 a241, v241
    buffer_load_dwordx4 v56, s[8:11], s85 offen offset:1024 sc1 lds
    v_accvgpr_write_b32 a244, v242
    v_accvgpr_write_b32 a245, v243
    v_perm_b32 v240, v191, v183, s74
    v_perm_b32 v241, v207, v199, s74
    v_perm_b32 v242, v191, v183, s75
    v_perm_b32 v243, v207, v199, s75
    v_accvgpr_write_b32 a248, v240
    v_accvgpr_write_b32 a249, v241
    v_accvgpr_write_b32 a252, v242
    v_accvgpr_write_b32 a253, v243
    s_waitcnt lgkmcnt(0)
    .p2align 3
    v_perm_b32 v240, v216, v208, s74
    v_perm_b32 v241, v232, v224, s74
    v_perm_b32 v242, v216, v208, s75
    v_perm_b32 v243, v232, v224, s75
    v_accvgpr_write_b32 a194, v240
    v_accvgpr_write_b32 a195, v241
    v_accvgpr_write_b32 a198, v242
    v_accvgpr_write_b32 a199, v243
    v_perm_b32 v240, v217, v209, s74
    v_perm_b32 v241, v233, v225, s74
    v_perm_b32 v242, v217, v209, s75
    v_perm_b32 v243, v233, v225, s75
    v_accvgpr_write_b32 a202, v240
    v_accvgpr_write_b32 a203, v241
    v_accvgpr_write_b32 a206, v242
    v_accvgpr_write_b32 a207, v243
    v_perm_b32 v240, v218, v210, s74
    v_perm_b32 v241, v234, v226, s74
    v_perm_b32 v242, v218, v210, s75
    v_perm_b32 v243, v234, v226, s75
    v_accvgpr_write_b32 a210, v240
    v_accvgpr_write_b32 a211, v241
    v_accvgpr_write_b32 a214, v242
    v_accvgpr_write_b32 a215, v243
    v_perm_b32 v240, v219, v211, s74
    v_perm_b32 v241, v235, v227, s74
    v_perm_b32 v242, v219, v211, s75
    v_perm_b32 v243, v235, v227, s75
    v_accvgpr_write_b32 a218, v240
    v_accvgpr_write_b32 a219, v241
    v_accvgpr_write_b32 a222, v242
    v_accvgpr_write_b32 a223, v243
    v_perm_b32 v240, v220, v212, s74
    v_perm_b32 v241, v236, v228, s74
    v_perm_b32 v242, v220, v212, s75
    v_perm_b32 v243, v236, v228, s75
    v_accvgpr_write_b32 a226, v240
    v_accvgpr_write_b32 a227, v241
    v_accvgpr_write_b32 a230, v242
    v_accvgpr_write_b32 a231, v243
    v_perm_b32 v240, v221, v213, s74
    v_perm_b32 v241, v237, v229, s74
    v_perm_b32 v242, v221, v213, s75
    v_perm_b32 v243, v237, v229, s75
    v_accvgpr_write_b32 a234, v240
    v_accvgpr_write_b32 a235, v241
    v_accvgpr_write_b32 a238, v242
    v_accvgpr_write_b32 a239, v243
    v_perm_b32 v240, v222, v214, s74
    v_perm_b32 v241, v238, v230, s74
    v_perm_b32 v242, v222, v214, s75
    v_perm_b32 v243, v238, v230, s75
    v_accvgpr_write_b32 a242, v240
    v_accvgpr_write_b32 a243, v241
    v_accvgpr_write_b32 a246, v242
    v_accvgpr_write_b32 a247, v243
    v_perm_b32 v240, v223, v215, s74
    v_perm_b32 v241, v239, v231, s74
    v_perm_b32 v242, v223, v215, s75
    v_perm_b32 v243, v239, v231, s75
    v_accvgpr_write_b32 a250, v240
    v_accvgpr_write_b32 a251, v241
    v_accvgpr_write_b32 a254, v242
    v_accvgpr_write_b32 a255, v243
    s_waitcnt vmcnt(14)
    v_readfirstlane_b32 s26, v254
    s_nop 0
    s_lshr_b32 s27, s26, s67
    s_and_b32 s27, s27, 1
    s_lshl_b32 s27, s27, 13
    s_xor_b32 s88, s88, s27
    s_xor_b32 s89, s89, s27
    s_xor_b32 s51, s51, s27
    s_xor_b32 s96, s96, s27
    s_xor_b32 s97, s97, s27
    s_xor_b32 s24, s24, s27
    s_xor_b32 s25, s25, s27
    s_xor_b32 s99, s99, s27
    v_lshrrev_b32 v250, 3, v0
    s_lshl_b32 s76, s62, 3
    v_add_u32 v251, s76, v250
    v_sub_u32 v252, 32, v251
    v_min_u32 v251, v251, v252
    v_bfe_u32 v251, v251, 1, 3
    v_bfe_u32 v251, s26, v251, 1
    v_lshl_add_u32 v250, v250, 3, v251
    v_and_b32 v251, 0x70, v56
    v_lshl_add_u32 v250, v250, 13, v251
    v_mov_b32 v240, -1
    v_mov_b32 v241, -1
    v_mov_b32 v242, -1
    v_mov_b32 v243, -1
    s_mov_b32 s78, 0
    s_mov_b32 s79, 0xffff0000
    s_waitcnt vmcnt(12)
    s_barrier
    ds_read_b64_tr_b16 v[176:177], v8 offset:0
    ds_read_b64_tr_b16 v[178:179], v8 offset:256
    ds_read_b64_tr_b16 v[180:181], v9 offset:0
    ds_read_b64_tr_b16 v[182:183], v9 offset:256
    ds_read_b64_tr_b16 v[184:185], v8 offset:2048
    ds_read_b64_tr_b16 v[186:187], v8 offset:2304
    ds_read_b64_tr_b16 v[188:189], v9 offset:2048
    ds_read_b64_tr_b16 v[190:191], v9 offset:2304
    ds_read_b64_tr_b16 v[192:193], v10 offset:0
    ds_read_b64_tr_b16 v[194:195], v10 offset:256
    ds_read_b64_tr_b16 v[196:197], v11 offset:0
    ds_read_b64_tr_b16 v[198:199], v11 offset:256
    s_waitcnt lgkmcnt(8)
    v_mfma_f32_16x16x32_bf16 v[64:67], v[176:179], v[40:43], v[64:67]
    ds_read_b64_tr_b16 v[200:201], v10 offset:2048
    ds_read_b64_tr_b16 v[202:203], v10 offset:2304
    ds_read_b64_tr_b16 v[204:205], v11 offset:2048
    v_mfma_f32_16x16x32_bf16 v[68:71], v[180:183], v[40:43], v[68:71]
    ds_read_b64_tr_b16 v[206:207], v11 offset:2304
    s_waitcnt vmcnt(8)
    s_barrier
    ds_read_b64_tr_b16 v[208:209], v8 offset:4096
    ds_read_b64_tr_b16 v[210:211], v8 offset:4352
    s_waitcnt lgkmcnt(10)
    v_mfma_f32_16x16x32_bf16 v[64:67], v[184:187], v[44:47], v[64:67]
    ds_read_b64_tr_b16 v[212:213], v9 offset:4096
    ds_read_b64_tr_b16 v[214:215], v9 offset:4352
    v_mfma_f32_16x16x32_bf16 v[68:71], v[188:191], v[44:47], v[68:71]
    ds_read_b64_tr_b16 v[216:217], v8 offset:6144
    ds_read_b64_tr_b16 v[218:219], v8 offset:6400
    s_waitcnt lgkmcnt(10)
    v_mfma_f32_16x16x32_bf16 v[172:175], v[192:195], v[48:51], v[172:175]
    ds_read_b64_tr_b16 v[220:221], v9 offset:6144
    ds_read_b64_tr_b16 v[222:223], v9 offset:6400
    s_add_u32 m0, s0, 0
    v_mfma_f32_16x16x32_bf16 v[168:171], v[196:199], v[48:51], v[168:171]
    ds_read_b64_tr_b16 v[176:177], v10 offset:4096
    ds_read_b64_tr_b16 v[178:179], v10 offset:4352
    s_add_u32 s85, s86, 0
    s_waitcnt lgkmcnt(12)
    v_mfma_f32_16x16x32_bf16 v[172:175], v[200:203], v[52:55], v[172:175]
    ds_read_b64_tr_b16 v[180:181], v11 offset:4096
    ds_read_b64_tr_b16 v[182:183], v11 offset:4352
    buffer_load_dwordx4 v56, s[8:11], s85 offen offset:0 sc1 lds
    s_waitcnt lgkmcnt(10)
    v_mfma_f32_16x16x32_bf16 v[168:171], v[204:207], v[52:55], v[168:171]
    ds_read_b64_tr_b16 v[184:185], v10 offset:6144
    v_cvt_pk_bf16_f32 v64, v64, v65
    v_mfma_f32_16x16x32_bf16 v[72:75], v[208:211], v[40:43], v[72:75]
    ds_read_b64_tr_b16 v[186:187], v10 offset:6400
    v_cvt_pk_bf16_f32 v65, v66, v67
    s_waitcnt lgkmcnt(10)
    v_mfma_f32_16x16x32_bf16 v[76:79], v[212:215], v[40:43], v[76:79]
    ds_read_b64_tr_b16 v[188:189], v11 offset:6144
    ds_read_b64_tr_b16 v[190:191], v11 offset:6400
    v_cvt_pk_bf16_f32 v66, v68, v69
    v_cvt_pk_bf16_f32 v67, v70, v71
    s_nop 1
    v_mfma_f32_16x16x32_bf16 v[224:227], v[60:63], v[64:67], 0
    ds_read_b64_tr_b16 v[192:193], v8 offset:8192
    buffer_load_dwordx4 v56, s[8:11], s85 offen offset:1024 sc1 lds
    s_waitcnt lgkmcnt(9)
    v_mfma_f32_16x16x32_bf16 v[72:75], v[216:219], v[44:47], v[72:75]
    ds_read_b64_tr_b16 v[194:195], v8 offset:8448
    v_cvt_pk_bf16_f32 v168, v168, v169
    v_mfma_f32_16x16x32_bf16 v[76:79], v[220:223], v[44:47], v[76:79]
    ds_read_b64_tr_b16 v[196:197], v9 offset:8192
    ds_read_b64_tr_b16 v[198:199], v9 offset:8448
    v_cvt_pk_bf16_f32 v169, v170, v171
    v_mfma_f32_16x16x32_bf16 v[228:231], v[64:67], v[64:67], 0
    ds_read_b64_tr_b16 v[200:201], v8 offset:10240
    v_cvt_pk_bf16_f32 v170, v172, v173
    s_waitcnt lgkmcnt(9)
    v_mfma_f32_16x16x32_bf16 v[164:167], v[176:179], v[48:51], v[164:167]
    ds_read_b64_tr_b16 v[202:203], v8 offset:10496
    v_cvt_pk_bf16_f32 v171, v174, v175
    v_mfma_f32_16x16x32_bf16 v[160:163], v[180:183], v[48:51], v[160:163]
    ds_read_b64_tr_b16 v[204:205], v9 offset:10240
    ds_read_b64_tr_b16 v[206:207], v9 offset:10496
    buffer_load_dwordx4 v56, s[8:11], s85 offen offset:2048 sc1 lds
    v_mfma_f32_16x16x32_bf16 v[224:227], v[60:63], v[168:171], v[224:227]
    ds_read_b64_tr_b16 v[208:209], v10 offset:8192
    buffer_load_dwordx4 v56, s[8:11], s85 offen offset:3072 sc1 lds
    s_waitcnt lgkmcnt(9)
    v_mfma_f32_16x16x32_bf16 v[164:167], v[184:187], v[52:55], v[164:167]
    ds_read_b64_tr_b16 v[210:211], v10 offset:8448
    v_cvt_pk_bf16_f32 v72, v72, v73
    v_mfma_f32_16x16x32_bf16 v[160:163], v[188:191], v[52:55], v[160:163]
    ds_read_b64_tr_b16 v[212:213], v11 offset:8192
    ds_read_b64_tr_b16 v[214:215], v11 offset:8448
    v_cvt_pk_bf16_f32 v73, v74, v75
    v_mfma_f32_16x16x32_bf16 v[228:231], v[168:171], v[168:171], v[228:231]
    ds_read_b64_tr_b16 v[216:217], v10 offset:10240
    v_cvt_pk_bf16_f32 v74, v76, v77
    s_waitcnt lgkmcnt(9)
    v_mfma_f32_16x16x32_bf16 v[80:83], v[192:195], v[40:43], v[80:83]
    ds_read_b64_tr_b16 v[218:219], v10 offset:10496
    v_cvt_pk_bf16_f32 v75, v78, v79
    v_mfma_f32_16x16x32_bf16 v[84:87], v[196:199], v[40:43], v[84:87]
    ds_read_b64_tr_b16 v[220:221], v11 offset:10240
    ds_read_b64_tr_b16 v[222:223], v11 offset:10496
    s_add_u32 m0, s0, 16384
    v_mfma_f32_16x16x32_bf16 v[224:227], v[60:63], v[72:75], v[224:227]
    s_waitcnt vmcnt(8)
    s_barrier
    ds_read_b64_tr_b16 v[176:177], v8 offset:12288
    s_add_u32 s85, s86, 16384
    s_waitcnt lgkmcnt(9)
    v_mfma_f32_16x16x32_bf16 v[80:83], v[200:203], v[44:47], v[80:83]
    ds_read_b64_tr_b16 v[178:179], v8 offset:12544
    buffer_load_dwordx4 v56, s[8:11], s85 offen offset:0 sc1 lds
    v_mfma_f32_16x16x32_bf16 v[84:87], v[204:207], v[44:47], v[84:87]
    ds_read_b64_tr_b16 v[180:181], v9 offset:12288
    ds_read_b64_tr_b16 v[182:183], v9 offset:12544
    buffer_load_dwordx4 v56, s[8:11], s85 offen offset:1024 sc1 lds
    v_mfma_f32_16x16x32_bf16 v[228:231], v[72:75], v[72:75], v[228:231]
    ds_read_b64_tr_b16 v[184:185], v8 offset:14336
    v_cvt_pk_bf16_f32 v160, v160, v161
    s_waitcnt lgkmcnt(9)
    v_mfma_f32_16x16x32_bf16 v[156:159], v[208:211], v[48:51], v[156:159]
    ds_read_b64_tr_b16 v[186:187], v8 offset:14592
    v_cvt_pk_bf16_f32 v161, v162, v163
    v_mfma_f32_16x16x32_bf16 v[152:155], v[212:215], v[48:51], v[152:155]
    ds_read_b64_tr_b16 v[188:189], v9 offset:14336
    ds_read_b64_tr_b16 v[190:191], v9 offset:14592
    v_cvt_pk_bf16_f32 v162, v164, v165
    v_cvt_pk_bf16_f32 v163, v166, v167
    s_nop 1
    v_mfma_f32_16x16x32_bf16 v[224:227], v[60:63], v[160:163], v[224:227]
    ds_read_b64_tr_b16 v[192:193], v10 offset:12288
    buffer_load_dwordx4 v56, s[8:11], s85 offen offset:2048 sc1 lds
    s_waitcnt lgkmcnt(9)
    v_mfma_f32_16x16x32_bf16 v[156:159], v[216:219], v[52:55], v[156:159]
    ds_read_b64_tr_b16 v[194:195], v10 offset:12544
    buffer_load_dwordx4 v56, s[8:11], s85 offen offset:3072 sc1 lds
    v_mfma_f32_16x16x32_bf16 v[152:155], v[220:223], v[52:55], v[152:155]
    ds_read_b64_tr_b16 v[196:197], v11 offset:12288
    ds_read_b64_tr_b16 v[198:199], v11 offset:12544
    v_cvt_pk_bf16_f32 v80, v80, v81
    v_mfma_f32_16x16x32_bf16 v[228:231], v[160:163], v[160:163], v[228:231]
    ds_read_b64_tr_b16 v[200:201], v10 offset:14336
    v_cvt_pk_bf16_f32 v81, v82, v83
    s_waitcnt lgkmcnt(9)
    v_mfma_f32_16x16x32_bf16 v[88:91], v[176:179], v[40:43], v[88:91]
    ds_read_b64_tr_b16 v[202:203], v10 offset:14592
    v_cvt_pk_bf16_f32 v82, v84, v85
    v_mfma_f32_16x16x32_bf16 v[92:95], v[180:183], v[40:43], v[92:95]
    ds_read_b64_tr_b16 v[204:205], v11 offset:14336
    ds_read_b64_tr_b16 v[206:207], v11 offset:14592
    v_cvt_pk_bf16_f32 v83, v86, v87
    s_nop 1
    v_mfma_f32_16x16x32_bf16 v[224:227], v[60:63], v[80:83], v[224:227]
    ds_read_b64_tr_b16 v[208:209], v8 offset:16384
    s_add_u32 m0, s0, 32768
    s_waitcnt lgkmcnt(9)
    v_mfma_f32_16x16x32_bf16 v[88:91], v[184:187], v[44:47], v[88:91]
    ds_read_b64_tr_b16 v[210:211], v8 offset:16640
    s_add_u32 s85, s86, 32768
    v_mfma_f32_16x16x32_bf16 v[92:95], v[188:191], v[44:47], v[92:95]
    ds_read_b64_tr_b16 v[212:213], v9 offset:16384
    ds_read_b64_tr_b16 v[214:215], v9 offset:16640
    buffer_load_dwordx4 v56, s[8:11], s85 offen offset:0 sc1 lds
    v_mfma_f32_16x16x32_bf16 v[228:231], v[80:83], v[80:83], v[228:231]
    ds_read_b64_tr_b16 v[216:217], v8 offset:18432
    buffer_load_dwordx4 v56, s[8:11], s85 offen offset:1024 sc1 lds
    s_waitcnt lgkmcnt(9)
    v_mfma_f32_16x16x32_bf16 v[148:151], v[192:195], v[48:51], v[148:151]
    ds_read_b64_tr_b16 v[218:219], v8 offset:18688
    v_cvt_pk_bf16_f32 v152, v152, v153
    v_mfma_f32_16x16x32_bf16 v[144:147], v[196:199], v[48:51], v[144:147]
    ds_read_b64_tr_b16 v[220:221], v9 offset:18432
    ds_read_b64_tr_b16 v[222:223], v9 offset:18688
    v_cvt_pk_bf16_f32 v153, v154, v155
    v_cvt_pk_bf16_f32 v154, v156, v157
    v_cvt_pk_bf16_f32 v155, v158, v159
    s_nop 1
    v_mfma_f32_16x16x32_bf16 v[224:227], v[60:63], v[152:155], v[224:227]
    ds_read_b64_tr_b16 v[176:177], v10 offset:16384
    buffer_load_dwordx4 v56, s[8:11], s85 offen offset:2048 sc1 lds
    s_waitcnt lgkmcnt(9)
    v_mfma_f32_16x16x32_bf16 v[148:151], v[200:203], v[52:55], v[148:151]
    ds_read_b64_tr_b16 v[178:179], v10 offset:16640
    buffer_load_dwordx4 v56, s[8:11], s85 offen offset:3072 sc1 lds
    v_mfma_f32_16x16x32_bf16 v[144:147], v[204:207], v[52:55], v[144:147]
    ds_read_b64_tr_b16 v[180:181], v11 offset:16384
    ds_read_b64_tr_b16 v[182:183], v11 offset:16640
    v_cvt_pk_bf16_f32 v88, v88, v89
    v_mfma_f32_16x16x32_bf16 v[228:231], v[152:155], v[152:155], v[228:231]
    ds_read_b64_tr_b16 v[184:185], v10 offset:18432
    v_cvt_pk_bf16_f32 v89, v90, v91
    s_waitcnt lgkmcnt(9)
    v_mfma_f32_16x16x32_bf16 v[96:99], v[208:211], v[40:43], v[96:99]
    ds_read_b64_tr_b16 v[186:187], v10 offset:18688
    v_cvt_pk_bf16_f32 v90, v92, v93
    v_mfma_f32_16x16x32_bf16 v[100:103], v[212:215], v[40:43], v[100:103]
    ds_read_b64_tr_b16 v[188:189], v11 offset:18432
    ds_read_b64_tr_b16 v[190:191], v11 offset:18688
    v_cvt_pk_bf16_f32 v91, v94, v95
    s_nop 1
    v_mfma_f32_16x16x32_bf16 v[224:227], v[60:63], v[88:91], v[224:227]
    s_waitcnt vmcnt(12)
    s_barrier
    ds_read_b64_tr_b16 v[192:193], v8 offset:20480
    s_add_u32 m0, s0, 49152
    s_waitcnt lgkmcnt(9)
    v_mfma_f32_16x16x32_bf16 v[96:99], v[216:219], v[44:47], v[96:99]
    ds_read_b64_tr_b16 v[194:195], v8 offset:20736
    s_add_u32 s85, s86, 49152
    v_mfma_f32_16x16x32_bf16 v[100:103], v[220:223], v[44:47], v[100:103]
    ds_read_b64_tr_b16 v[196:197], v9 offset:20480
    ds_read_b64_tr_b16 v[198:199], v9 offset:20736
    buffer_load_dwordx4 v56, s[8:11], s85 offen offset:0 sc1 lds
    v_mfma_f32_16x16x32_bf16 v[228:231], v[88:91], v[88:91], v[228:231]
    ds_read_b64_tr_b16 v[200:201], v8 offset:22528
    buffer_load_dwordx4 v56, s[8:11], s85 offen offset:1024 sc1 lds
    s_waitcnt lgkmcnt(9)
    v_mfma_f32_16x16x32_bf16 v[140:143], v[176:179], v[48:51], v[140:143]
    ds_read_b64_tr_b16 v[202:203], v8 offset:22784
    v_cvt_pk_bf16_f32 v144, v144, v145
    v_mfma_f32_16x16x32_bf16 v[136:139], v[180:183], v[48:51], v[136:139]
    ds_read_b64_tr_b16 v[204:205], v9 offset:22528
    ds_read_b64_tr_b16 v[206:207], v9 offset:22784
    v_cvt_pk_bf16_f32 v145, v146, v147
    v_cvt_pk_bf16_f32 v146, v148, v149
    v_cvt_pk_bf16_f32 v147, v150, v151
    s_nop 1
    v_mfma_f32_16x16x32_bf16 v[224:227], v[60:63], v[144:147], v[224:227]
    ds_read_b64_tr_b16 v[208:209], v10 offset:20480
    buffer_load_dwordx4 v56, s[8:11], s85 offen offset:2048 sc1 lds
    s_waitcnt lgkmcnt(9)
    v_mfma_f32_16x16x32_bf16 v[140:143], v[184:187], v[52:55], v[140:143]
    ds_read_b64_tr_b16 v[210:211], v10 offset:20736
    buffer_load_dwordx4 v56, s[8:11], s85 offen offset:3072 sc1 lds
    v_mfma_f32_16x16x32_bf16 v[136:139], v[188:191], v[52:55], v[136:139]
    ds_read_b64_tr_b16 v[212:213], v11 offset:20480
    ds_read_b64_tr_b16 v[214:215], v11 offset:20736
    v_cvt_pk_bf16_f32 v96, v96, v97
    v_mfma_f32_16x16x32_bf16 v[228:231], v[144:147], v[144:147], v[228:231]
    ds_read_b64_tr_b16 v[216:217], v10 offset:22528
    v_cvt_pk_bf16_f32 v97, v98, v99
    s_waitcnt lgkmcnt(9)
    v_mfma_f32_16x16x32_bf16 v[104:107], v[192:195], v[40:43], v[104:107]
    ds_read_b64_tr_b16 v[218:219], v10 offset:22784
    v_cvt_pk_bf16_f32 v98, v100, v101
    v_mfma_f32_16x16x32_bf16 v[108:111], v[196:199], v[40:43], v[108:111]
    ds_read_b64_tr_b16 v[220:221], v11 offset:22528
    ds_read_b64_tr_b16 v[222:223], v11 offset:22784
    v_cvt_pk_bf16_f32 v99, v102, v103
    s_nop 1
    v_mfma_f32_16x16x32_bf16 v[224:227], v[60:63], v[96:99], v[224:227]
    ds_read_b64_tr_b16 v[176:177], v8 offset:24576
    s_add_u32 m0, s0, 65536
    s_waitcnt lgkmcnt(9)
    v_mfma_f32_16x16x32_bf16 v[104:107], v[200:203], v[44:47], v[104:107]
    ds_read_b64_tr_b16 v[178:179], v8 offset:24832
    s_add_u32 s85, s86, 65536
    v_mfma_f32_16x16x32_bf16 v[108:111], v[204:207], v[44:47], v[108:111]
    ds_read_b64_tr_b16 v[180:181], v9 offset:24576
    ds_read_b64_tr_b16 v[182:183], v9 offset:24832
    buffer_load_dwordx4 v56, s[8:11], s85 offen offset:0 sc1 lds
    v_mfma_f32_16x16x32_bf16 v[228:231], v[96:99], v[96:99], v[228:231]
    ds_read_b64_tr_b16 v[184:185], v8 offset:26624
    buffer_load_dwordx4 v56, s[8:11], s85 offen offset:1024 sc1 lds
    s_waitcnt lgkmcnt(9)
    v_mfma_f32_16x16x32_bf16 v[132:135], v[208:211], v[48:51], v[132:135]
    ds_read_b64_tr_b16 v[186:187], v8 offset:26880
    v_cvt_pk_bf16_f32 v136, v136, v137
    v_mfma_f32_16x16x32_bf16 v[128:131], v[212:215], v[48:51], v[128:131]
    ds_read_b64_tr_b16 v[188:189], v9 offset:26624
    ds_read_b64_tr_b16 v[190:191], v9 offset:26880
    v_cvt_pk_bf16_f32 v137, v138, v139
    v_cvt_pk_bf16_f32 v138, v140, v141
    v_cvt_pk_bf16_f32 v139, v142, v143
    s_nop 1
    v_mfma_f32_16x16x32_bf16 v[224:227], v[60:63], v[136:139], v[224:227]
    ds_read_b64_tr_b16 v[192:193], v10 offset:24576
    buffer_load_dwordx4 v56, s[8:11], s85 offen offset:2048 sc1 lds
    s_waitcnt lgkmcnt(9)
    v_mfma_f32_16x16x32_bf16 v[132:135], v[216:219], v[52:55], v[132:135]
    ds_read_b64_tr_b16 v[194:195], v10 offset:24832
    buffer_load_dwordx4 v56, s[8:11], s85 offen offset:3072 sc1 lds
    v_mfma_f32_16x16x32_bf16 v[128:131], v[220:223], v[52:55], v[128:131]
    ds_read_b64_tr_b16 v[196:197], v11 offset:24576
    ds_read_b64_tr_b16 v[198:199], v11 offset:24832
    v_cvt_pk_bf16_f32 v104, v104, v105
    v_mfma_f32_16x16x32_bf16 v[228:231], v[136:139], v[136:139], v[228:231]
    ds_read_b64_tr_b16 v[200:201], v10 offset:26624
    v_cvt_pk_bf16_f32 v105, v106, v107
    s_waitcnt lgkmcnt(9)
    v_mfma_f32_16x16x32_bf16 v[112:115], v[176:179], v[40:43], v[112:115]
    ds_read_b64_tr_b16 v[202:203], v10 offset:26880
    v_cvt_pk_bf16_f32 v106, v108, v109
    v_mfma_f32_16x16x32_bf16 v[116:119], v[180:183], v[40:43], v[116:119]
    ds_read_b64_tr_b16 v[204:205], v11 offset:26624
    ds_read_b64_tr_b16 v[206:207], v11 offset:26880
    v_cvt_pk_bf16_f32 v107, v110, v111
    s_nop 1
    v_mfma_f32_16x16x32_bf16 v[224:227], v[60:63], v[104:107], v[224:227]
    s_waitcnt vmcnt(12)
    s_barrier
    ds_read_b128 v[208:211], v56 offset:0
    s_add_u32 m0, s0, 81920
    s_waitcnt lgkmcnt(9)
    v_mfma_f32_16x16x32_bf16 v[112:115], v[184:187], v[44:47], v[112:115]
    ds_read_b128 v[212:215], v56 offset:1024
    s_add_u32 s85, s86, 81920
    v_mfma_f32_16x16x32_bf16 v[116:119], v[188:191], v[44:47], v[116:119]
    ds_read_b128 v[216:219], v56 offset:2048
    buffer_load_dwordx4 v56, s[8:11], s85 offen offset:0 sc1 lds
    v_mfma_f32_16x16x32_bf16 v[228:231], v[104:107], v[104:107], v[228:231]
    ds_read_b128 v[220:223], v56 offset:3072
    buffer_load_dwordx4 v56, s[8:11], s85 offen offset:1024 sc1 lds
    s_waitcnt lgkmcnt(8)
    v_mfma_f32_16x16x32_bf16 v[124:127], v[192:195], v[48:51], v[124:127]
    ds_read_b128 v[176:179], v56 offset:4096
    v_cvt_pk_bf16_f32 v128, v128, v129
    v_mfma_f32_16x16x32_bf16 v[120:123], v[196:199], v[48:51], v[120:123]
    ds_read_b128 v[180:183], v56 offset:5120
    v_cvt_pk_bf16_f32 v129, v130, v131
    v_cvt_pk_bf16_f32 v130, v132, v133
    v_cvt_pk_bf16_f32 v131, v134, v135
    s_nop 1
    v_mfma_f32_16x16x32_bf16 v[224:227], v[60:63], v[128:131], v[224:227]
    ds_read_b128 v[184:187], v56 offset:6144
    buffer_load_dwordx4 v56, s[8:11], s85 offen offset:2048 sc1 lds
    s_waitcnt lgkmcnt(7)
    v_mfma_f32_16x16x32_bf16 v[124:127], v[200:203], v[52:55], v[124:127]
    ds_read_b128 v[188:191], v56 offset:7168
    buffer_load_dwordx4 v56, s[8:11], s85 offen offset:3072 sc1 lds
    v_mfma_f32_16x16x32_bf16 v[120:123], v[204:207], v[52:55], v[120:123]
    ds_read_b128 v[192:195], v56 offset:8192
    v_cvt_pk_bf16_f32 v112, v112, v113
    v_mfma_f32_16x16x32_bf16 v[228:231], v[128:131], v[128:131], v[228:231]
    ds_read_b128 v[196:199], v56 offset:9216
    v_cvt_pk_bf16_f32 v113, v114, v115
    s_waitcnt lgkmcnt(6)
    v_mfma_f32_16x16x32_bf16 v[68:71], v[208:211], v[64:67], 0
    ds_read_b128 v[200:203], v56 offset:10240
    ds_read_b128 v[204:207], v56 offset:11264
    v_mfma_f32_16x16x32_bf16 v[76:79], v[212:215], v[64:67], 0
    ds_read_b128 v[208:211], v56 offset:12288
    v_cvt_pk_bf16_f32 v114, v116, v117
    v_mfma_f32_16x16x32_bf16 v[84:87], v[216:219], v[64:67], 0
    ds_read_b128 v[212:215], v56 offset:13312
    v_cvt_pk_bf16_f32 v115, v118, v119
    v_mfma_f32_16x16x32_bf16 v[92:95], v[220:223], v[64:67], 0
    s_add_u32 m0, s91, 98304
    s_waitcnt lgkmcnt(6)
    v_mfma_f32_16x16x32_bf16 v[100:103], v[176:179], v[64:67], 0
    s_add_u32 s85, s60, 98304
    buffer_load_dwordx4 v56, s[8:11], s85 offen offset:0 sc1 lds
    v_mfma_f32_16x16x32_bf16 v[108:111], v[180:183], v[64:67], 0
    ds_read_b128 v[216:219], v56 offset:14336
    s_add_u32 s80, s96, 0
    v_mfma_f32_16x16x32_bf16 v[116:119], v[184:187], v[64:67], 0
    ds_read_b128 v[220:223], v56 offset:15360
    buffer_store_dwordx4 v[240:243], v56, s[8:11], s80 offen sc1
    v_mfma_f32_16x16x32_bf16 v[68:71], v[188:191], v[72:75], v[68:71]
    ds_read_b128 v[176:179], v56 offset:16384
    s_waitcnt lgkmcnt(5)
    v_mfma_f32_16x16x32_bf16 v[76:79], v[192:195], v[72:75], v[76:79]
    ds_read_b128 v[180:183], v56 offset:17408
    v_cvt_pk_bf16_f32 v120, v120, v121
    v_mfma_f32_16x16x32_bf16 v[84:87], v[196:199], v[72:75], v[84:87]
    ds_read_b128 v[184:187], v56 offset:18432
    v_cndmask_b32 v123, v123, v59, s[78:79]
    v_mfma_f32_16x16x32_bf16 v[92:95], v[200:203], v[72:75], v[92:95]
    ds_read_b128 v[188:191], v56 offset:19456
    v_cvt_pk_bf16_f32 v121, v122, v123
    v_mfma_f32_16x16x32_bf16 v[100:103], v[204:207], v[72:75], v[100:103]
    ds_read_b128 v[192:195], v56 offset:20480
    s_waitcnt lgkmcnt(7)
    v_mfma_f32_16x16x32_bf16 v[108:111], v[208:211], v[72:75], v[108:111]
    ds_read_b128 v[196:199], v56 offset:21504
    v_cvt_pk_bf16_f32 v122, v124, v125
    v_mfma_f32_16x16x32_bf16 v[116:119], v[212:215], v[72:75], v[116:119]
    ds_read_b128 v[200:203], v56 offset:22528
    v_cvt_pk_bf16_f32 v123, v126, v127
    v_mfma_f32_16x16x32_bf16 v[224:227], v[60:63], v[112:115], v[224:227]
    ds_read_b128 v[204:207], v56 offset:23552
    s_barrier
    v_mfma_f32_16x16x32_bf16 v[228:231], v[112:115], v[112:115], v[228:231]
    ds_read_b128 v[208:211], v56 offset:24576
    s_add_u32 s80, s96, 16384
    v_mfma_f32_16x16x32_bf16 v[224:227], v[60:63], v[120:123], v[224:227]
    ds_read_b128 v[212:215], v56 offset:25600
    buffer_store_dwordx4 v[240:243], v56, s[8:11], s80 offen sc1
    v_mfma_f32_16x16x32_bf16 v[228:231], v[120:123], v[120:123], v[228:231]
    s_waitcnt lgkmcnt(8)
    v_mfma_f32_16x16x32_bf16 v[68:71], v[216:219], v[80:83], v[68:71]
    ds_read_b128 v[216:219], v56 offset:26624
    v_mfma_f32_16x16x32_bf16 v[76:79], v[220:223], v[80:83], v[76:79]
    ds_read_b128 v[220:223], v56 offset:27648
    s_add_u32 s80, s96, 32768
    v_mfma_f32_16x16x32_bf16 v[84:87], v[176:179], v[80:83], v[84:87]
    s_waitcnt vmcnt(11)
    s_barrier
    ds_read_b128 v[176:179], v56 offset:28672
    v_mfma_f32_16x16x32_bf16 v[92:95], v[180:183], v[80:83], v[92:95]
    ds_read_b128 v[180:183], v56 offset:29696
    s_waitcnt lgkmcnt(8)
    v_mfma_f32_16x16x32_bf16 v[100:103], v[184:187], v[80:83], v[100:103]
    ds_read_b128 v[184:187], v56 offset:30720
    buffer_store_dwordx4 v[240:243], v56, s[8:11], s80 offen sc1
    v_mfma_f32_16x16x32_bf16 v[108:111], v[188:191], v[80:83], v[108:111]
    ds_read_b128 v[188:191], v56 offset:31744
    v_cndmask_b32 v18, 0, v228, s[38:39]
    v_mfma_f32_16x16x32_bf16 v[116:119], v[192:195], v[80:83], v[116:119]
    ds_read_b128 v[192:195], v56 offset:32768
    v_cndmask_b32 v18, v18, v229, s[40:41]
    v_mfma_f32_16x16x32_bf16 v[68:71], v[196:199], v[88:91], v[68:71]
    ds_read_b128 v[196:199], v56 offset:33792
    s_waitcnt lgkmcnt(8)
    v_mfma_f32_16x16x32_bf16 v[76:79], v[200:203], v[88:91], v[76:79]
    ds_read_b128 v[200:203], v56 offset:34816
    v_cndmask_b32 v18, v18, v230, s[42:43]
    v_mfma_f32_16x16x32_bf16 v[84:87], v[204:207], v[88:91], v[84:87]
    ds_read_b128 v[204:207], v56 offset:35840
    v_cndmask_b32 v18, v18, v231, s[44:45]
    v_mfma_f32_16x16x32_bf16 v[92:95], v[208:211], v[88:91], v[92:95]
    ds_read_b128 v[208:211], v56 offset:36864
    v_mfma_f32_16x16x32_bf16 v[100:103], v[212:215], v[88:91], v[100:103]
    ds_read_b128 v[212:215], v56 offset:37888
    s_waitcnt lgkmcnt(8)
    v_mfma_f32_16x16x32_bf16 v[108:111], v[216:219], v[88:91], v[108:111]
    ds_read_b128 v[216:219], v56 offset:38912
    v_mov_b32 v252, v18
    v_mfma_f32_16x16x32_bf16 v[116:119], v[220:223], v[88:91], v[116:119]
    ds_read_b128 v[220:223], v56 offset:39936
    buffer_store_dwordx2 v[240:241], v58, s[8:11], s97 offen sc1
    v_mfma_f32_16x16x32_bf16 v[68:71], v[176:179], v[96:99], v[68:71]
    ds_read_b128 v[176:179], v56 offset:40960
    v_permlane16_swap_b32 v18, v252
    v_mfma_f32_16x16x32_bf16 v[76:79], v[180:183], v[96:99], v[76:79]
    ds_read_b128 v[180:183], v56 offset:41984
    s_waitcnt lgkmcnt(8)
    v_mfma_f32_16x16x32_bf16 v[84:87], v[184:187], v[96:99], v[84:87]
    ds_read_b128 v[184:187], v56 offset:43008
    v_add_f32 v18, v18, v252
    v_mfma_f32_16x16x32_bf16 v[92:95], v[188:191], v[96:99], v[92:95]
    ds_read_b128 v[188:191], v56 offset:44032
    v_mov_b32 v252, v18
    v_mfma_f32_16x16x32_bf16 v[100:103], v[192:195], v[96:99], v[100:103]
    ds_read_b128 v[192:195], v56 offset:45056
    v_mfma_f32_16x16x32_bf16 v[108:111], v[196:199], v[96:99], v[108:111]
    ds_read_b128 v[196:199], v56 offset:46080
    s_waitcnt lgkmcnt(8)
    v_mfma_f32_16x16x32_bf16 v[116:119], v[200:203], v[96:99], v[116:119]
    ds_read_b128 v[200:203], v56 offset:47104
    v_permlane32_swap_b32 v18, v252
    v_mfma_f32_16x16x32_bf16 v[68:71], v[204:207], v[104:107], v[68:71]
    ds_read_b128 v[204:207], v56 offset:48128
    v_add_f32 v18, v18, v252
    v_mfma_f32_16x16x32_bf16 v[76:79], v[208:211], v[104:107], v[76:79]
    ds_read_b128 v[208:211], v56 offset:49152
    s_cmp_eq_u32 s63, 7
    s_cselect_b64 exec, 0, -1
    buffer_store_dwordx4 v[240:243], v56, s[8:11], s25 offen offset:0 sc1
    buffer_store_dwordx4 v[240:243], v56, s[8:11], s25 offen offset:1024 sc1
    buffer_store_dwordx4 v[240:243], v250, s[8:11], s50 offen sc1
    s_mov_b64 exec, -1
    v_mfma_f32_16x16x32_bf16 v[84:87], v[212:215], v[104:107], v[84:87]
    ds_read_b128 v[212:215], v12 offset:0
    s_waitcnt lgkmcnt(8)
    v_mfma_f32_16x16x32_bf16 v[92:95], v[216:219], v[104:107], v[92:95]
    ds_read_b128 v[216:219], v12 offset:1024
    v_mul_f32 v19, 0x3b124925, v224
    v_mfma_f32_16x16x32_bf16 v[100:103], v[220:223], v[104:107], v[100:103]
    ds_read_b128 v[220:223], v12 offset:2048
    v_mul_f32 v18, 0x3b124925, v18
    v_mfma_f32_16x16x32_bf16 v[108:111], v[176:179], v[104:107], v[108:111]
    ds_read_b128 v[176:179], v12 offset:3072
    v_mfma_f32_16x16x32_bf16 v[116:119], v[180:183], v[104:107], v[116:119]
    ds_read_b128 v[180:183], v12 offset:4096
    s_waitcnt lgkmcnt(8)
    v_mfma_f32_16x16x32_bf16 v[68:71], v[184:187], v[112:115], v[68:71]
    ds_read_b128 v[184:187], v12 offset:5120
    v_fma_f32 v18, -v19, v19, v18
    v_mfma_f32_16x16x32_bf16 v[76:79], v[188:191], v[112:115], v[76:79]
    ds_read_b128 v[188:191], v12 offset:6144
    v_max_f32 v18, 0, v18
    v_mfma_f32_16x16x32_bf16 v[84:87], v[192:195], v[112:115], v[84:87]
    ds_read_b128 v[192:195], v12 offset:7168
    v_mfma_f32_16x16x32_bf16 v[92:95], v[196:199], v[112:115], v[92:95]
    ds_read_b128 v[196:199], v12 offset:8192
    s_waitcnt lgkmcnt(8)
    v_mfma_f32_16x16x32_bf16 v[100:103], v[200:203], v[112:115], v[100:103]
    ds_read_b128 v[200:203], v12 offset:9216
    v_add_f32 v18, 0x3727c5ac, v18
    v_mfma_f32_16x16x32_bf16 v[108:111], v[204:207], v[112:115], v[108:111]
    ds_read_b128 v[204:207], v12 offset:10240
    s_add_u32 m0, s0, 106496
    v_mfma_f32_16x16x32_bf16 v[116:119], v[208:211], v[112:115], v[116:119]
    ds_read_b128 v[208:211], v12 offset:11264
    s_add_u32 s85, s86, 114688
    v_mfma_f32_16x16x32_bf16 v[68:71], v[212:215], v[120:123], v[68:71]
    ds_read_b128 v[212:215], v12 offset:12288
    s_waitcnt lgkmcnt(8)
    v_mfma_f32_16x16x32_bf16 v[76:79], v[216:219], v[120:123], v[76:79]
    ds_read_b128 v[216:219], v12 offset:13312
    buffer_load_dwordx4 v56, s[8:11], s85 offen offset:0 sc1 lds
    v_mfma_f32_16x16x32_bf16 v[84:87], v[220:223], v[120:123], v[84:87]
    s_waitcnt vmcnt(8)
    s_barrier
    ds_read_b128 v[220:223], v12 offset:14336
    v_mfma_f32_16x16x32_bf16 v[92:95], v[176:179], v[120:123], v[92:95]
    ds_read_b128 v[176:179], v12 offset:15360
    v_rsq_f32 v252, v18
    v_mfma_f32_16x16x32_bf16 v[100:103], v[180:183], v[120:123], v[100:103]
    ds_read_b128 v[180:183], v12 offset:16384
    s_waitcnt lgkmcnt(8)
    v_mfma_f32_16x16x32_bf16 v[108:111], v[184:187], v[120:123], v[108:111]
    ds_read_b128 v[184:187], v12 offset:17408
    s_barrier
    v_mfma_f32_16x16x32_bf16 v[116:119], v[188:191], v[120:123], v[116:119]
    ds_read_b128 v[188:191], v12 offset:18432
    v_sub_f32 v19, 0, v19
    v_mfma_f32_16x16x32_bf16 v[68:71], v[192:195], v[128:131], v[68:71]
    ds_read_b128 v[192:195], v12 offset:19456
    buffer_load_dwordx4 v56, s[8:11], s85 offen offset:1024 sc1 lds
    v_mfma_f32_16x16x32_bf16 v[76:79], v[196:199], v[128:131], v[76:79]
    ds_read_b128 v[196:199], v12 offset:20480
    s_waitcnt lgkmcnt(8)
    v_mfma_f32_16x16x32_bf16 v[84:87], v[200:203], v[128:131], v[84:87]
    ds_read_b128 v[200:203], v12 offset:21504
    v_mul_f32 v18, v18, v252
    v_mfma_f32_16x16x32_bf16 v[92:95], v[204:207], v[128:131], v[92:95]
    ds_read_b128 v[204:207], v12 offset:22528
    v_mul_f32 v17, 0xc0135761, v252
    v_mfma_f32_16x16x32_bf16 v[100:103], v[208:211], v[128:131], v[100:103]
    ds_read_b128 v[208:211], v12 offset:23552
    v_mul_f32 v252, v252, v252
    v_mfma_f32_16x16x32_bf16 v[108:111], v[212:215], v[128:131], v[108:111]
    ds_read_b128 v[212:215], v12 offset:24576
    s_waitcnt lgkmcnt(8)
    v_mfma_f32_16x16x32_bf16 v[116:119], v[216:219], v[128:131], v[116:119]
    ds_read_b128 v[216:219], v12 offset:25600
    buffer_load_dwordx4 v56, s[8:11], s85 offen offset:2048 sc1 lds
    v_mfma_f32_16x16x32_bf16 v[68:71], v[220:223], v[136:139], v[68:71]
    ds_read_b128 v[220:223], v12 offset:26624
    v_mul_f32 v252, 0x3d372713, v252
    v_mfma_f32_16x16x32_bf16 v[76:79], v[176:179], v[136:139], v[76:79]
    ds_read_b128 v[176:179], v12 offset:27648
    v_mul_f32 v16, v252, v17
    v_mfma_f32_16x16x32_bf16 v[84:87], v[180:183], v[136:139], v[84:87]
    ds_read_b128 v[180:183], v12 offset:28672
    s_waitcnt lgkmcnt(8)
    v_mfma_f32_16x16x32_bf16 v[92:95], v[184:187], v[136:139], v[92:95]
    ds_read_b128 v[184:187], v12 offset:29696
    buffer_load_dwordx4 v56, s[8:11], s85 offen offset:3072 sc1 lds
    v_mfma_f32_16x16x32_bf16 v[100:103], v[188:191], v[136:139], v[100:103]
    ds_read_b128 v[188:191], v12 offset:30720
    s_add_u32 m0, s0, 122880
    v_mfma_f32_16x16x32_bf16 v[108:111], v[192:195], v[136:139], v[108:111]
    ds_read_b128 v[192:195], v12 offset:31744
    s_add_u32 s85, s86, 131072
    v_mfma_f32_16x16x32_bf16 v[116:119], v[196:199], v[136:139], v[116:119]
    ds_read_b128 v[196:199], v12 offset:32768
    s_waitcnt lgkmcnt(8)
    v_mfma_f32_16x16x32_bf16 v[68:71], v[200:203], v[144:147], v[68:71]
    ds_read_b128 v[200:203], v12 offset:33792
    buffer_load_dwordx4 v56, s[8:11], s85 offen offset:0 sc1 lds
    v_mfma_f32_16x16x32_bf16 v[76:79], v[204:207], v[144:147], v[76:79]
    ds_read_b128 v[204:207], v12 offset:34816
    buffer_load_dwordx4 v56, s[8:11], s85 offen offset:1024 sc1 lds
    v_mfma_f32_16x16x32_bf16 v[84:87], v[208:211], v[144:147], v[84:87]
    ds_read_b128 v[208:211], v12 offset:35840
    v_mfma_f32_16x16x32_bf16 v[92:95], v[212:215], v[144:147], v[92:95]
    ds_read_b128 v[212:215], v12 offset:36864
    s_waitcnt lgkmcnt(8)
    v_mfma_f32_16x16x32_bf16 v[100:103], v[216:219], v[144:147], v[100:103]
    ds_read_b128 v[216:219], v12 offset:37888
    v_mfma_f32_16x16x32_bf16 v[108:111], v[220:223], v[144:147], v[108:111]
    ds_read_b128 v[220:223], v12 offset:38912
    buffer_load_dwordx4 v56, s[8:11], s85 offen offset:2048 sc1 lds
    v_mfma_f32_16x16x32_bf16 v[116:119], v[176:179], v[144:147], v[116:119]
    ds_read_b128 v[176:179], v12 offset:39936
    v_mfma_f32_16x16x32_bf16 v[68:71], v[180:183], v[152:155], v[68:71]
    ds_read_b128 v[180:183], v12 offset:40960
    s_waitcnt lgkmcnt(8)
    v_mfma_f32_16x16x32_bf16 v[76:79], v[184:187], v[152:155], v[76:79]
    ds_read_b128 v[184:187], v12 offset:41984
    v_mfma_f32_16x16x32_bf16 v[84:87], v[188:191], v[152:155], v[84:87]
    ds_read_b128 v[188:191], v12 offset:43008
    v_mfma_f32_16x16x32_bf16 v[92:95], v[192:195], v[152:155], v[92:95]
    ds_read_b128 v[192:195], v12 offset:44032
    buffer_load_dwordx4 v56, s[8:11], s85 offen offset:3072 sc1 lds
    v_mfma_f32_16x16x32_bf16 v[100:103], v[196:199], v[152:155], v[100:103]
    ds_read_b128 v[196:199], v12 offset:45056
    s_waitcnt lgkmcnt(8)
    v_mfma_f32_16x16x32_bf16 v[108:111], v[200:203], v[152:155], v[108:111]
    ds_read_b128 v[200:203], v12 offset:46080
    v_mfma_f32_16x16x32_bf16 v[116:119], v[204:207], v[152:155], v[116:119]
    ds_read_b128 v[204:207], v12 offset:47104
    v_mfma_f32_16x16x32_bf16 v[68:71], v[208:211], v[160:163], v[68:71]
    ds_read_b128 v[208:211], v12 offset:48128
    v_mfma_f32_16x16x32_bf16 v[76:79], v[212:215], v[160:163], v[76:79]
    ds_read_b128 v[212:215], v12 offset:49152
    s_waitcnt lgkmcnt(8)
    v_mfma_f32_16x16x32_bf16 v[84:87], v[216:219], v[160:163], v[84:87]
    ds_read_b128 v[124:127], v14 offset:0
    v_mfma_f32_16x16x32_bf16 v[92:95], v[220:223], v[160:163], v[92:95]
    ds_read_b128 v[132:135], v14 offset:64
    ds_read_b128 v[140:143], v14 offset:128
    v_mfma_f32_16x16x32_bf16 v[100:103], v[176:179], v[160:163], v[100:103]
    ds_read_b128 v[148:151], v14 offset:192
    ds_read_b128 v[156:159], v14 offset:256
    v_mfma_f32_16x16x32_bf16 v[108:111], v[180:183], v[160:163], v[108:111]
    ds_read_b128 v[164:167], v14 offset:320
    s_waitcnt lgkmcnt(10)
    v_mfma_f32_16x16x32_bf16 v[116:119], v[184:187], v[160:163], v[116:119]
    ds_read_b128 v[172:175], v14 offset:384
    v_mfma_f32_16x16x32_bf16 v[68:71], v[188:191], v[168:171], v[68:71]
    v_mfma_f32_16x16x32_bf16 v[76:79], v[192:195], v[168:171], v[76:79]
    v_mfma_f32_16x16x32_bf16 v[84:87], v[196:199], v[168:171], v[84:87]
    s_waitcnt lgkmcnt(7)
    v_mfma_f32_16x16x32_bf16 v[92:95], v[200:203], v[168:171], v[92:95]
    v_mfma_f32_16x16x32_bf16 v[100:103], v[204:207], v[168:171], v[100:103]
    v_mfma_f32_16x16x32_bf16 v[108:111], v[208:211], v[168:171], v[108:111]
    v_mfma_f32_16x16x32_bf16 v[116:119], v[212:215], v[168:171], v[116:119]
    s_add_u32 m0, s0, 139264
    s_add_u32 s85, s86, 147456
    buffer_load_dwordx4 v56, s[8:11], s85 offen offset:0 sc1 lds
    s_waitcnt lgkmcnt(0)
    v_pk_fma_f32 v[68:69], v[124:125], v[18:19], v[68:69] op_sel:[0,1,0] op_sel_hi:[1,1,1]
    v_pk_fma_f32 v[70:71], v[126:127], v[18:19], v[70:71] op_sel:[0,1,0] op_sel_hi:[1,1,1]
    v_pk_mul_f32 v[176:177], v[68:69], v[68:69]
    v_pk_mul_f32 v[178:179], v[70:71], v[70:71]
    v_pk_fma_f32 v[176:177], v[176:177], v[16:17], v[16:17] op_sel:[0,0,1] op_sel_hi:[1,0,1]
    v_pk_fma_f32 v[178:179], v[178:179], v[16:17], v[16:17] op_sel:[0,0,1] op_sel_hi:[1,0,1]
    v_pk_mul_f32 v[176:177], v[176:177], v[68:69]
    v_pk_mul_f32 v[178:179], v[178:179], v[70:71]
    v_exp_f32 v176, v176
    v_exp_f32 v177, v177
    v_exp_f32 v178, v178
    v_exp_f32 v179, v179
    buffer_load_dwordx4 v56, s[8:11], s85 offen offset:1024 sc1 lds
    v_pk_fma_f32 v[176:177], v[176:177], v[18:19], v[18:19] op_sel_hi:[1,0,0]
    v_pk_fma_f32 v[178:179], v[178:179], v[18:19], v[18:19] op_sel_hi:[1,0,0]
    v_rcp_f32 v176, v176
    v_rcp_f32 v177, v177
    v_rcp_f32 v178, v178
    v_rcp_f32 v179, v179
    v_pk_mul_f32 v[68:69], v[68:69], v[176:177]
    v_pk_mul_f32 v[70:71], v[70:71], v[178:179]
    v_pk_add_f32 v[20:21], v[68:69], v[70:71]
    v_pk_mul_f32 v[22:23], v[68:69], v[68:69]
    v_pk_fma_f32 v[22:23], v[70:71], v[70:71], v[22:23]
    v_pk_fma_f32 v[76:77], v[132:133], v[18:19], v[76:77] op_sel:[0,1,0] op_sel_hi:[1,1,1]
    v_pk_fma_f32 v[78:79], v[134:135], v[18:19], v[78:79] op_sel:[0,1,0] op_sel_hi:[1,1,1]
    buffer_load_dwordx4 v56, s[8:11], s85 offen offset:2048 sc1 lds
    v_pk_mul_f32 v[176:177], v[76:77], v[76:77]
    v_pk_mul_f32 v[178:179], v[78:79], v[78:79]
    v_pk_fma_f32 v[176:177], v[176:177], v[16:17], v[16:17] op_sel:[0,0,1] op_sel_hi:[1,0,1]
    v_pk_fma_f32 v[178:179], v[178:179], v[16:17], v[16:17] op_sel:[0,0,1] op_sel_hi:[1,0,1]
    v_pk_mul_f32 v[176:177], v[176:177], v[76:77]
    v_pk_mul_f32 v[178:179], v[178:179], v[78:79]
    v_exp_f32 v176, v176
    v_exp_f32 v177, v177
    v_exp_f32 v178, v178
    v_exp_f32 v179, v179
    v_pk_fma_f32 v[176:177], v[176:177], v[18:19], v[18:19] op_sel_hi:[1,0,0]
    v_pk_fma_f32 v[178:179], v[178:179], v[18:19], v[18:19] op_sel_hi:[1,0,0]
    v_rcp_f32 v176, v176
    buffer_load_dwordx4 v56, s[8:11], s85 offen offset:3072 sc1 lds
    v_rcp_f32 v177, v177
    v_rcp_f32 v178, v178
    v_rcp_f32 v179, v179
    v_pk_mul_f32 v[76:77], v[76:77], v[176:177]
    v_pk_mul_f32 v[78:79], v[78:79], v[178:179]
    v_pk_add_f32 v[20:21], v[20:21], v[76:77]
    v_pk_fma_f32 v[22:23], v[76:77], v[76:77], v[22:23]
    v_pk_add_f32 v[20:21], v[20:21], v[78:79]
    v_pk_fma_f32 v[22:23], v[78:79], v[78:79], v[22:23]
    v_pk_fma_f32 v[84:85], v[140:141], v[18:19], v[84:85] op_sel:[0,1,0] op_sel_hi:[1,1,1]
    v_pk_fma_f32 v[86:87], v[142:143], v[18:19], v[86:87] op_sel:[0,1,0] op_sel_hi:[1,1,1]
    v_pk_mul_f32 v[176:177], v[84:85], v[84:85]
    v_pk_mul_f32 v[178:179], v[86:87], v[86:87]
    s_add_u32 m0, s92, 155648
    s_add_u32 s85, s61, 163840
    buffer_load_dwordx4 v56, s[8:11], s85 offen offset:0 sc1 lds
    v_pk_fma_f32 v[176:177], v[176:177], v[16:17], v[16:17] op_sel:[0,0,1] op_sel_hi:[1,0,1]
    v_pk_fma_f32 v[178:179], v[178:179], v[16:17], v[16:17] op_sel:[0,0,1] op_sel_hi:[1,0,1]
    v_pk_mul_f32 v[176:177], v[176:177], v[84:85]
    v_pk_mul_f32 v[178:179], v[178:179], v[86:87]
    v_exp_f32 v176, v176
    v_exp_f32 v177, v177
    v_exp_f32 v178, v178
    v_exp_f32 v179, v179
    v_pk_fma_f32 v[176:177], v[176:177], v[18:19], v[18:19] op_sel_hi:[1,0,0]
    v_pk_fma_f32 v[178:179], v[178:179], v[18:19], v[18:19] op_sel_hi:[1,0,0]
    v_rcp_f32 v176, v176
    v_rcp_f32 v177, v177
    v_rcp_f32 v178, v178
    buffer_load_dwordx4 v56, s[8:11], s85 offen offset:1024 sc1 lds
    v_rcp_f32 v179, v179
    v_pk_mul_f32 v[84:85], v[84:85], v[176:177]
    v_pk_mul_f32 v[86:87], v[86:87], v[178:179]
    v_pk_add_f32 v[20:21], v[20:21], v[84:85]
    v_pk_fma_f32 v[22:23], v[84:85], v[84:85], v[22:23]
    v_pk_add_f32 v[20:21], v[20:21], v[86:87]
    v_pk_fma_f32 v[22:23], v[86:87], v[86:87], v[22:23]
    v_pk_fma_f32 v[92:93], v[148:149], v[18:19], v[92:93] op_sel:[0,1,0] op_sel_hi:[1,1,1]
    v_pk_fma_f32 v[94:95], v[150:151], v[18:19], v[94:95] op_sel:[0,1,0] op_sel_hi:[1,1,1]
    v_pk_mul_f32 v[176:177], v[92:93], v[92:93]
    v_pk_mul_f32 v[178:179], v[94:95], v[94:95]
    v_pk_fma_f32 v[176:177], v[176:177], v[16:17], v[16:17] op_sel:[0,0,1] op_sel_hi:[1,0,1]
    v_pk_fma_f32 v[178:179], v[178:179], v[16:17], v[16:17] op_sel:[0,0,1] op_sel_hi:[1,0,1]
    s_add_u32 m0, s0, 0
    s_add_u32 s85, s86, 172032
    buffer_load_dwordx4 v56, s[8:11], s85 offen offset:0 sc1 lds
    v_pk_mul_f32 v[176:177], v[176:177], v[92:93]
    v_pk_mul_f32 v[178:179], v[178:179], v[94:95]
    v_exp_f32 v176, v176
    v_exp_f32 v177, v177
    v_exp_f32 v178, v178
    v_exp_f32 v179, v179
    v_pk_fma_f32 v[176:177], v[176:177], v[18:19], v[18:19] op_sel_hi:[1,0,0]
    v_pk_fma_f32 v[178:179], v[178:179], v[18:19], v[18:19] op_sel_hi:[1,0,0]
    v_rcp_f32 v176, v176
    v_rcp_f32 v177, v177
    v_rcp_f32 v178, v178
    v_rcp_f32 v179, v179
    v_pk_mul_f32 v[92:93], v[92:93], v[176:177]
    buffer_load_dwordx4 v56, s[8:11], s85 offen offset:1024 sc1 lds
    v_pk_mul_f32 v[94:95], v[94:95], v[178:179]
    v_pk_add_f32 v[20:21], v[20:21], v[92:93]
    v_pk_fma_f32 v[22:23], v[92:93], v[92:93], v[22:23]
    v_pk_add_f32 v[20:21], v[20:21], v[94:95]
    v_pk_fma_f32 v[22:23], v[94:95], v[94:95], v[22:23]
    v_pk_fma_f32 v[100:101], v[156:157], v[18:19], v[100:101] op_sel:[0,1,0] op_sel_hi:[1,1,1]
    v_pk_fma_f32 v[102:103], v[158:159], v[18:19], v[102:103] op_sel:[0,1,0] op_sel_hi:[1,1,1]
    v_pk_mul_f32 v[176:177], v[100:101], v[100:101]
    v_pk_mul_f32 v[178:179], v[102:103], v[102:103]
    v_pk_fma_f32 v[176:177], v[176:177], v[16:17], v[16:17] op_sel:[0,0,1] op_sel_hi:[1,0,1]
    v_pk_fma_f32 v[178:179], v[178:179], v[16:17], v[16:17] op_sel:[0,0,1] op_sel_hi:[1,0,1]
    v_pk_mul_f32 v[176:177], v[176:177], v[100:101]
    v_pk_mul_f32 v[178:179], v[178:179], v[102:103]
    buffer_load_dwordx4 v56, s[8:11], s85 offen offset:2048 sc1 lds
    v_exp_f32 v176, v176
    v_exp_f32 v177, v177
    v_exp_f32 v178, v178
    v_exp_f32 v179, v179
    v_pk_fma_f32 v[176:177], v[176:177], v[18:19], v[18:19] op_sel_hi:[1,0,0]
    v_pk_fma_f32 v[178:179], v[178:179], v[18:19], v[18:19] op_sel_hi:[1,0,0]
    v_rcp_f32 v176, v176
    v_rcp_f32 v177, v177
    v_rcp_f32 v178, v178
    v_rcp_f32 v179, v179
    v_pk_mul_f32 v[100:101], v[100:101], v[176:177]
    v_pk_mul_f32 v[102:103], v[102:103], v[178:179]
    v_pk_add_f32 v[20:21], v[20:21], v[100:101]
    buffer_load_dwordx4 v56, s[8:11], s85 offen offset:3072 sc1 lds
    v_pk_fma_f32 v[22:23], v[100:101], v[100:101], v[22:23]
    v_pk_add_f32 v[20:21], v[20:21], v[102:103]
    v_pk_fma_f32 v[22:23], v[102:103], v[102:103], v[22:23]
    v_pk_fma_f32 v[108:109], v[164:165], v[18:19], v[108:109] op_sel:[0,1,0] op_sel_hi:[1,1,1]
    v_pk_fma_f32 v[110:111], v[166:167], v[18:19], v[110:111] op_sel:[0,1,0] op_sel_hi:[1,1,1]
    v_pk_mul_f32 v[176:177], v[108:109], v[108:109]
    v_pk_mul_f32 v[178:179], v[110:111], v[110:111]
    v_pk_fma_f32 v[176:177], v[176:177], v[16:17], v[16:17] op_sel:[0,0,1] op_sel_hi:[1,0,1]
    v_pk_fma_f32 v[178:179], v[178:179], v[16:17], v[16:17] op_sel:[0,0,1] op_sel_hi:[1,0,1]
    v_pk_mul_f32 v[176:177], v[176:177], v[108:109]
    v_pk_mul_f32 v[178:179], v[178:179], v[110:111]
    v_exp_f32 v176, v176
    v_exp_f32 v177, v177
    s_add_u32 m0, s0, 16384
    s_add_u32 s85, s86, 188416
    buffer_load_dwordx4 v56, s[8:11], s85 offen offset:0 sc1 lds
    v_exp_f32 v178, v178
    v_exp_f32 v179, v179
    v_pk_fma_f32 v[176:177], v[176:177], v[18:19], v[18:19] op_sel_hi:[1,0,0]
    v_pk_fma_f32 v[178:179], v[178:179], v[18:19], v[18:19] op_sel_hi:[1,0,0]
    v_rcp_f32 v176, v176
    v_rcp_f32 v177, v177
    v_rcp_f32 v178, v178
    v_rcp_f32 v179, v179
    v_pk_mul_f32 v[108:109], v[108:109], v[176:177]
    v_pk_mul_f32 v[110:111], v[110:111], v[178:179]
    v_pk_add_f32 v[20:21], v[20:21], v[108:109]
    v_pk_fma_f32 v[22:23], v[108:109], v[108:109], v[22:23]
    v_pk_add_f32 v[20:21], v[20:21], v[110:111]
    v_pk_fma_f32 v[22:23], v[110:111], v[110:111], v[22:23]
    v_pk_fma_f32 v[116:117], v[172:173], v[18:19], v[116:117] op_sel:[0,1,0] op_sel_hi:[1,1,1]
    v_pk_fma_f32 v[118:119], v[174:175], v[18:19], v[118:119] op_sel:[0,1,0] op_sel_hi:[1,1,1]
    v_pk_mul_f32 v[176:177], v[116:117], v[116:117]
    v_pk_mul_f32 v[178:179], v[118:119], v[118:119]
    v_pk_fma_f32 v[176:177], v[176:177], v[16:17], v[16:17] op_sel:[0,0,1] op_sel_hi:[1,0,1]
    v_pk_fma_f32 v[178:179], v[178:179], v[16:17], v[16:17] op_sel:[0,0,1] op_sel_hi:[1,0,1]
    v_pk_mul_f32 v[176:177], v[176:177], v[116:117]
    v_pk_mul_f32 v[178:179], v[178:179], v[118:119]
    v_exp_f32 v176, v176
    v_exp_f32 v177, v177
    v_exp_f32 v178, v178
    v_exp_f32 v179, v179
    v_pk_fma_f32 v[176:177], v[176:177], v[18:19], v[18:19] op_sel_hi:[1,0,0]
    v_pk_fma_f32 v[178:179], v[178:179], v[18:19], v[18:19] op_sel_hi:[1,0,0]
    v_rcp_f32 v176, v176
    v_rcp_f32 v177, v177
    v_rcp_f32 v178, v178
    v_rcp_f32 v179, v179
    v_pk_mul_f32 v[116:117], v[116:117], v[176:177]
    v_pk_mul_f32 v[118:119], v[118:119], v[178:179]
    v_pk_add_f32 v[20:21], v[20:21], v[116:117]
    v_pk_fma_f32 v[22:23], v[116:117], v[116:117], v[22:23]
    v_pk_add_f32 v[20:21], v[20:21], v[118:119]
    v_pk_fma_f32 v[22:23], v[118:119], v[118:119], v[22:23]
    v_add_f32 v20, v20, v21
    v_add_f32 v22, v22, v23
    s_waitcnt vmcnt(19)
    s_nop 0
    v_permlane16_swap_b32 v20, v22
    v_add_f32 v20, v20, v22
    v_mov_b32 v22, v20
    s_nop 1
    v_permlane32_swap_b32 v20, v22
    v_add_f32 v20, v20, v22
    v_and_b32 v20, -2, v20
    s_mov_b32 exec_hi, 0
    buffer_store_dword v20, v248, s[8:11], s51 offen sc1
    s_mov_b32 exec_hi, -1
    s_waitcnt vmcnt(6)
    s_barrier
    ds_read_b128 v[176:179], v13 offset:0
    ds_read_b128 v[180:183], v13 offset:1024
    ds_read_b128 v[184:187], v13 offset:2048
    ds_read_b128 v[188:191], v13 offset:3072
    ds_read_b128 v[192:195], v13 offset:4096
    ds_read_b128 v[196:199], v13 offset:5120
    ds_read_b128 v[200:203], v13 offset:6144
    ds_read_b128 v[204:207], v13 offset:7168
    ds_read_b128 v[208:211], v13 offset:8192
    ds_read_b128 v[212:215], v13 offset:9216
    s_waitcnt lgkmcnt(8)
    v_mfma_f32_16x16x32_bf16 v[124:127], v[176:179], v[64:67], 0
    ds_read_b128 v[216:219], v13 offset:10240
    v_mfma_f32_16x16x32_bf16 v[132:135], v[180:183], v[64:67], 0
    ds_read_b128 v[220:223], v13 offset:11264
    s_waitcnt lgkmcnt(8)
    v_mfma_f32_16x16x32_bf16 v[140:143], v[184:187], v[64:67], 0
    ds_read_b128 v[176:179], v13 offset:12288
    buffer_load_dwordx4 v56, s[8:11], s85 offen offset:1024 sc1 lds
    v_mfma_f32_16x16x32_bf16 v[148:151], v[188:191], v[64:67], 0
    ds_read_b128 v[180:183], v13 offset:13312
    s_waitcnt lgkmcnt(8)
    v_mfma_f32_16x16x32_bf16 v[156:159], v[192:195], v[64:67], 0
    ds_read_b128 v[184:187], v13 offset:14336
    v_mfma_f32_16x16x32_bf16 v[164:167], v[196:199], v[64:67], 0
    ds_read_b128 v[188:191], v13 offset:15360
    s_waitcnt lgkmcnt(8)
    v_mfma_f32_16x16x32_bf16 v[172:175], v[200:203], v[64:67], 0
    ds_read_b128 v[192:195], v13 offset:16384
    v_mfma_f32_16x16x32_bf16 v[124:127], v[204:207], v[72:75], v[124:127]
    ds_read_b128 v[196:199], v13 offset:17408
    s_waitcnt lgkmcnt(8)
    v_mfma_f32_16x16x32_bf16 v[132:135], v[208:211], v[72:75], v[132:135]
    ds_read_b128 v[200:203], v13 offset:18432
    buffer_load_dwordx4 v56, s[8:11], s85 offen offset:2048 sc1 lds
    v_mfma_f32_16x16x32_bf16 v[140:143], v[212:215], v[72:75], v[140:143]
    ds_read_b128 v[204:207], v13 offset:19456
    s_waitcnt lgkmcnt(8)
    v_mfma_f32_16x16x32_bf16 v[148:151], v[216:219], v[72:75], v[148:151]
    ds_read_b128 v[208:211], v13 offset:20480
    v_mfma_f32_16x16x32_bf16 v[156:159], v[220:223], v[72:75], v[156:159]
    ds_read_b128 v[212:215], v13 offset:21504
    s_waitcnt lgkmcnt(8)
    v_mfma_f32_16x16x32_bf16 v[164:167], v[176:179], v[72:75], v[164:167]
    ds_read_b128 v[216:219], v13 offset:22528
    buffer_load_dwordx4 v56, s[8:11], s85 offen offset:3072 sc1 lds
    v_mfma_f32_16x16x32_bf16 v[172:175], v[180:183], v[72:75], v[172:175]
    ds_read_b128 v[220:223], v13 offset:23552
    s_waitcnt lgkmcnt(8)
    v_mfma_f32_16x16x32_bf16 v[124:127], v[184:187], v[80:83], v[124:127]
    ds_read_b128 v[176:179], v13 offset:24576
    v_mfma_f32_16x16x32_bf16 v[132:135], v[188:191], v[80:83], v[132:135]
    ds_read_b128 v[180:183], v13 offset:25600
    s_waitcnt lgkmcnt(8)
    v_mfma_f32_16x16x32_bf16 v[140:143], v[192:195], v[80:83], v[140:143]
    ds_read_b128 v[184:187], v13 offset:26624
    v_mfma_f32_16x16x32_bf16 v[148:151], v[196:199], v[80:83], v[148:151]
    ds_read_b128 v[188:191], v13 offset:27648
    s_waitcnt lgkmcnt(8)
    v_mfma_f32_16x16x32_bf16 v[156:159], v[200:203], v[80:83], v[156:159]
    ds_read_b128 v[192:195], v13 offset:28672
    s_add_u32 m0, s92, 32768
    v_mfma_f32_16x16x32_bf16 v[164:167], v[204:207], v[80:83], v[164:167]
    ds_read_b128 v[196:199], v13 offset:29696
    s_waitcnt lgkmcnt(8)
    v_mfma_f32_16x16x32_bf16 v[172:175], v[208:211], v[80:83], v[172:175]
    ds_read_b128 v[200:203], v13 offset:30720
    s_add_u32 s85, s61, 204800
    v_mfma_f32_16x16x32_bf16 v[124:127], v[212:215], v[88:91], v[124:127]
    ds_read_b128 v[204:207], v13 offset:31744
    s_waitcnt lgkmcnt(8)
    v_mfma_f32_16x16x32_bf16 v[132:135], v[216:219], v[88:91], v[132:135]
    ds_read_b128 v[208:211], v13 offset:32768
    buffer_load_dwordx4 v56, s[8:11], s85 offen offset:0 sc1 lds
    v_mfma_f32_16x16x32_bf16 v[140:143], v[220:223], v[88:91], v[140:143]
    ds_read_b128 v[212:215], v13 offset:33792
    s_waitcnt lgkmcnt(8)
    v_mfma_f32_16x16x32_bf16 v[148:151], v[176:179], v[88:91], v[148:151]
    ds_read_b128 v[216:219], v13 offset:34816
    buffer_load_dwordx4 v56, s[8:11], s85 offen offset:1024 sc1 lds
    v_mfma_f32_16x16x32_bf16 v[156:159], v[180:183], v[88:91], v[156:159]
    ds_read_b128 v[220:223], v13 offset:35840
    s_waitcnt lgkmcnt(8)
    v_mfma_f32_16x16x32_bf16 v[164:167], v[184:187], v[88:91], v[164:167]
    ds_read_b128 v[176:179], v13 offset:36864
    v_mfma_f32_16x16x32_bf16 v[172:175], v[188:191], v[88:91], v[172:175]
    ds_read_b128 v[180:183], v13 offset:37888
    s_waitcnt lgkmcnt(8)
    v_mfma_f32_16x16x32_bf16 v[124:127], v[192:195], v[96:99], v[124:127]
    ds_read_b128 v[184:187], v13 offset:38912
    s_add_u32 m0, s91, 40960
    v_mfma_f32_16x16x32_bf16 v[132:135], v[196:199], v[96:99], v[132:135]
    ds_read_b128 v[188:191], v13 offset:39936
    s_waitcnt lgkmcnt(8)
    v_mfma_f32_16x16x32_bf16 v[140:143], v[200:203], v[96:99], v[140:143]
    ds_read_b128 v[192:195], v13 offset:40960
    s_add_u32 s85, s60, 212992
    v_mfma_f32_16x16x32_bf16 v[148:151], v[204:207], v[96:99], v[148:151]
    ds_read_b128 v[196:199], v13 offset:41984
    s_waitcnt lgkmcnt(8)
    v_mfma_f32_16x16x32_bf16 v[156:159], v[208:211], v[96:99], v[156:159]
    ds_read_b128 v[200:203], v13 offset:43008
    buffer_load_dwordx4 v56, s[8:11], s85 offen offset:0 sc1 lds
    v_mfma_f32_16x16x32_bf16 v[164:167], v[212:215], v[96:99], v[164:167]
    ds_read_b128 v[204:207], v13 offset:44032
    s_waitcnt lgkmcnt(8)
    v_mfma_f32_16x16x32_bf16 v[172:175], v[216:219], v[96:99], v[172:175]
    ds_read_b128 v[208:211], v13 offset:45056
    v_mfma_f32_16x16x32_bf16 v[124:127], v[220:223], v[104:107], v[124:127]
    ds_read_b128 v[212:215], v13 offset:46080
    s_waitcnt lgkmcnt(8)
    v_mfma_f32_16x16x32_bf16 v[132:135], v[176:179], v[104:107], v[132:135]
    ds_read_b128 v[216:219], v13 offset:47104
    buffer_load_dwordx2 v[20:21], v249, s[8:11], s89 offen sc1
    v_mfma_f32_16x16x32_bf16 v[140:143], v[180:183], v[104:107], v[140:143]
    ds_read_b128 v[220:223], v13 offset:48128
    s_waitcnt lgkmcnt(8)
    v_mfma_f32_16x16x32_bf16 v[148:151], v[184:187], v[104:107], v[148:151]
    ds_read_b128 v[176:179], v13 offset:49152
    buffer_load_dwordx2 v[22:23], v249, s[8:11], s89 offen offset:128 sc1
    v_mfma_f32_16x16x32_bf16 v[156:159], v[188:191], v[104:107], v[156:159]
    ds_read_b128 v[180:183], v13 offset:50176
    s_waitcnt lgkmcnt(8)
    v_mfma_f32_16x16x32_bf16 v[164:167], v[192:195], v[104:107], v[164:167]
    ds_read_b128 v[184:187], v13 offset:51200
    s_add_u32 m0, s0, 49152
    v_mfma_f32_16x16x32_bf16 v[172:175], v[196:199], v[104:107], v[172:175]
    ds_read_b128 v[188:191], v13 offset:52224
    s_waitcnt lgkmcnt(8)
    v_mfma_f32_16x16x32_bf16 v[124:127], v[200:203], v[112:115], v[124:127]
    ds_read_b128 v[192:195], v13 offset:53248
    s_add_u32 s85, s99, 0
    v_mfma_f32_16x16x32_bf16 v[132:135], v[204:207], v[112:115], v[132:135]
    ds_read_b128 v[196:199], v13 offset:54272
    s_waitcnt lgkmcnt(8)
    v_mfma_f32_16x16x32_bf16 v[140:143], v[208:211], v[112:115], v[140:143]
    ds_read_b128 v[200:203], v13 offset:55296
    buffer_load_dwordx4 v56, s[8:11], s85 offen offset:0 sc1 lds
    v_mfma_f32_16x16x32_bf16 v[148:151], v[212:215], v[112:115], v[148:151]
    ds_read_b128 v[204:207], v13 offset:56320
    s_waitcnt lgkmcnt(8)
    v_mfma_f32_16x16x32_bf16 v[156:159], v[216:219], v[112:115], v[156:159]
    s_waitcnt vmcnt(11)
    s_barrier
    ds_read_b128 v[208:211], v56 offset:0
    v_mfma_f32_16x16x32_bf16 v[164:167], v[220:223], v[112:115], v[164:167]
    ds_read_b128 v[212:215], v56 offset:1024
    s_waitcnt lgkmcnt(8)
    v_mfma_f32_16x16x32_bf16 v[172:175], v[176:179], v[112:115], v[172:175]
    ds_read_b128 v[216:219], v56 offset:2048
    buffer_load_dwordx4 v56, s[8:11], s85 offen offset:1024 sc1 lds
    v_mfma_f32_16x16x32_bf16 v[124:127], v[180:183], v[120:123], v[124:127]
    ds_read_b128 v[220:223], v56 offset:3072
    s_waitcnt lgkmcnt(8)
    v_mfma_f32_16x16x32_bf16 v[132:135], v[184:187], v[120:123], v[132:135]
    ds_read_b128 v[176:179], v56 offset:4096
    buffer_load_dwordx4 v56, s[8:11], s85 offen offset:2048 sc1 lds
    v_mfma_f32_16x16x32_bf16 v[140:143], v[188:191], v[120:123], v[140:143]
    ds_read_b128 v[180:183], v56 offset:5120
    s_waitcnt lgkmcnt(8)
    v_mfma_f32_16x16x32_bf16 v[148:151], v[192:195], v[120:123], v[148:151]
    ds_read_b128 v[184:187], v56 offset:6144
    v_mfma_f32_16x16x32_bf16 v[156:159], v[196:199], v[120:123], v[156:159]
    buffer_load_dwordx4 v56, s[8:11], s85 offen offset:3072 sc1 lds
    s_waitcnt lgkmcnt(7)
    v_mfma_f32_16x16x32_bf16 v[164:167], v[200:203], v[120:123], v[164:167]
    v_mfma_f32_16x16x32_bf16 v[172:175], v[204:207], v[120:123], v[172:175]
    s_waitcnt lgkmcnt(5)
    v_mfma_f32_16x16x32_bf16 v[124:127], v[208:211], v[128:131], v[124:127]
    v_mfma_f32_16x16x32_bf16 v[132:135], v[212:215], v[128:131], v[132:135]
    s_waitcnt lgkmcnt(3)
    v_mfma_f32_16x16x32_bf16 v[140:143], v[216:219], v[128:131], v[140:143]
    s_add_u32 m0, s0, 65536
    s_add_u32 s85, s99, 32768
    v_mfma_f32_16x16x32_bf16 v[148:151], v[220:223], v[128:131], v[148:151]
    buffer_load_dwordx4 v56, s[8:11], s85 offen offset:0 sc1 lds
    s_waitcnt lgkmcnt(1)
    v_mfma_f32_16x16x32_bf16 v[156:159], v[176:179], v[128:131], v[156:159]
    s_barrier
    v_mfma_f32_16x16x32_bf16 v[164:167], v[180:183], v[128:131], v[164:167]
    s_waitcnt lgkmcnt(0)
    v_mfma_f32_16x16x32_bf16 v[172:175], v[184:187], v[128:131], v[172:175]
    s_waitcnt vmcnt(5)
    s_mov_b32 s98, 0
interleave_layers__spectral_fnet__mixer_gmlp__prompt_kernel_st_3:
    v_max3_u32 v252, v20, v21, v22
    v_max_u32 v252, v252, v23
    v_cmp_eq_u32 vcc, -1, v252
    s_cbranch_vccz interleave_layers__spectral_fnet__mixer_gmlp__prompt_kernel_st_3_x
    s_add_u32 s98, s98, 1
    s_cmp_gt_u32 s98, 1048576
    s_cbranch_scc1 interleave_layers__spectral_fnet__mixer_gmlp__prompt_kernel_st_3_x
    buffer_load_dwordx2 v[20:21], v249, s[8:11], s89 offen sc1
    buffer_load_dwordx2 v[22:23], v249, s[8:11], s89 offen offset:128 sc1
    s_waitcnt vmcnt(0)
    s_branch interleave_layers__spectral_fnet__mixer_gmlp__prompt_kernel_st_3
interleave_layers__spectral_fnet__mixer_gmlp__prompt_kernel_st_3_x:
    v_pk_add_f32 v[20:21], v[20:21], v[22:23]
    s_nop 1
    v_permlane16_swap_b32 v20, v21
    v_add_f32 v20, v20, v21
    v_mov_b32 v21, v20
    s_nop 1
    v_permlane32_swap_b32 v20, v21
    v_add_f32 v20, v20, v21
    v_mov_b32 v21, v20
    s_nop 1
    v_permlane16_swap_b32 v20, v21
    v_mul_f32 v20, 0x3a924925, v20
    v_mul_f32 v21, 0x3a924925, v21
    v_fma_f32 v21, -v20, v20, v21
    v_max_f32 v21, 0, v21
    v_add_f32 v21, 0x3727c5ac, v21
    v_rsq_f32 v21, v21
    s_nop 0
    v_mul_f32 v20, -v20, v21
    v_pk_fma_f32 v[68:69], v[68:69], v[20:21], v[20:21] op_sel:[0,1,0] op_sel_hi:[1,1,0]
    v_pk_fma_f32 v[70:71], v[70:71], v[20:21], v[20:21] op_sel:[0,1,0] op_sel_hi:[1,1,0]
    v_cvt_pk_bf16_f32 v68, v68, v69
    v_cvt_pk_bf16_f32 v69, v70, v71
    ds_write_b64 v244, v[68:69] offset:0
    v_pk_fma_f32 v[76:77], v[76:77], v[20:21], v[20:21] op_sel:[0,1,0] op_sel_hi:[1,1,0]
    v_pk_fma_f32 v[78:79], v[78:79], v[20:21], v[20:21] op_sel:[0,1,0] op_sel_hi:[1,1,0]
    v_cvt_pk_bf16_f32 v76, v76, v77
    v_cvt_pk_bf16_f32 v77, v78, v79
    ds_write_b64 v244, v[76:77] offset:512
    ds_read_b64_tr_b16 v[176:177], v245 offset:0
    ds_read_b64_tr_b16 v[178:179], v246 offset:256
    v_pk_fma_f32 v[84:85], v[84:85], v[20:21], v[20:21] op_sel:[0,1,0] op_sel_hi:[1,1,0]
    v_pk_fma_f32 v[86:87], v[86:87], v[20:21], v[20:21] op_sel:[0,1,0] op_sel_hi:[1,1,0]
    v_cvt_pk_bf16_f32 v84, v84, v85
    v_cvt_pk_bf16_f32 v85, v86, v87
    ds_write_b64 v244, v[84:85] offset:1024
    v_pk_fma_f32 v[92:93], v[92:93], v[20:21], v[20:21] op_sel:[0,1,0] op_sel_hi:[1,1,0]
    v_pk_fma_f32 v[94:95], v[94:95], v[20:21], v[20:21] op_sel:[0,1,0] op_sel_hi:[1,1,0]
    v_cvt_pk_bf16_f32 v92, v92, v93
    v_cvt_pk_bf16_f32 v93, v94, v95
    ds_write_b64 v244, v[92:93] offset:1536
    ds_read_b64_tr_b16 v[180:181], v245 offset:1024
    ds_read_b64_tr_b16 v[182:183], v246 offset:1280
    s_waitcnt lgkmcnt(4)
    s_add_u32 s80, s58, 0
    buffer_store_dwordx4 v[176:179], v247, s[8:11], s80 offen sc1
    v_pk_fma_f32 v[100:101], v[100:101], v[20:21], v[20:21] op_sel:[0,1,0] op_sel_hi:[1,1,0]
    v_pk_fma_f32 v[102:103], v[102:103], v[20:21], v[20:21] op_sel:[0,1,0] op_sel_hi:[1,1,0]
    v_cvt_pk_bf16_f32 v100, v100, v101
    v_cvt_pk_bf16_f32 v101, v102, v103
    ds_write_b64 v244, v[100:101] offset:2048
    v_pk_fma_f32 v[108:109], v[108:109], v[20:21], v[20:21] op_sel:[0,1,0] op_sel_hi:[1,1,0]
    v_pk_fma_f32 v[110:111], v[110:111], v[20:21], v[20:21] op_sel:[0,1,0] op_sel_hi:[1,1,0]
    v_cvt_pk_bf16_f32 v108, v108, v109
    v_cvt_pk_bf16_f32 v109, v110, v111
    ds_write_b64 v244, v[108:109] offset:2560
    ds_read_b64_tr_b16 v[184:185], v245 offset:2048
    ds_read_b64_tr_b16 v[186:187], v246 offset:2304
    s_waitcnt lgkmcnt(4)
    s_add_u32 s80, s58, 131072
    buffer_store_dwordx4 v[180:183], v247, s[8:11], s80 offen sc1
    v_pk_fma_f32 v[116:117], v[116:117], v[20:21], v[20:21] op_sel:[0,1,0] op_sel_hi:[1,1,0]
    v_pk_fma_f32 v[118:119], v[118:119], v[20:21], v[20:21] op_sel:[0,1,0] op_sel_hi:[1,1,0]
    v_cvt_pk_bf16_f32 v116, v116, v117
    v_cvt_pk_bf16_f32 v117, v118, v119
    ds_write_b64 v244, v[116:117] offset:3072
    ds_read_b64_tr_b16 v[188:189], v245 offset:3072
    ds_read_b64_tr_b16 v[190:191], v246 offset:3328
    s_waitcnt lgkmcnt(3)
    s_add_u32 s80, s58, 262144
    buffer_store_dwordx4 v[184:187], v247, s[8:11], s80 offen sc1
    s_waitcnt lgkmcnt(0)
    s_add_u32 s80, s58, 393216
    s_mov_b32 exec_hi, 0
    buffer_store_dwordx4 v[188:191], v247, s[8:11], s80 offen sc1
    s_mov_b32 exec_hi, -1
    s_barrier
    ds_read_b128 v[192:195], v56 offset:7168
    ds_read_b128 v[196:199], v56 offset:8192
    ds_read_b128 v[200:203], v56 offset:9216
    ds_read_b128 v[204:207], v56 offset:10240
    ds_read_b128 v[208:211], v56 offset:11264
    ds_read_b128 v[212:215], v56 offset:12288
    ds_read_b128 v[216:219], v56 offset:13312
    ds_read_b128 v[220:223], v56 offset:14336
    s_waitcnt lgkmcnt(6)
    v_mfma_f32_16x16x32_bf16 v[124:127], v[192:195], v[136:139], v[124:127]
    ds_read_b128 v[176:179], v56 offset:15360
    ds_read_b128 v[180:183], v56 offset:16384
    v_mfma_f32_16x16x32_bf16 v[132:135], v[196:199], v[136:139], v[132:135]
    ds_read_b128 v[184:187], v56 offset:17408
    s_waitcnt lgkmcnt(7)
    v_mfma_f32_16x16x32_bf16 v[140:143], v[200:203], v[136:139], v[140:143]
    ds_read_b128 v[188:191], v56 offset:18432
    buffer_load_dwordx4 v56, s[8:11], s85 offen offset:1024 sc1 lds
    v_mfma_f32_16x16x32_bf16 v[148:151], v[204:207], v[136:139], v[148:151]
    ds_read_b128 v[192:195], v56 offset:19456
    s_waitcnt lgkmcnt(7)
    v_mfma_f32_16x16x32_bf16 v[156:159], v[208:211], v[136:139], v[156:159]
    ds_read_b128 v[196:199], v56 offset:20480
    buffer_load_dwordx4 v56, s[8:11], s85 offen offset:2048 sc1 lds
    v_mfma_f32_16x16x32_bf16 v[164:167], v[212:215], v[136:139], v[164:167]
    ds_read_b128 v[200:203], v56 offset:21504
    s_waitcnt lgkmcnt(7)
    v_mfma_f32_16x16x32_bf16 v[172:175], v[216:219], v[136:139], v[172:175]
    ds_read_b128 v[204:207], v56 offset:22528
    buffer_load_dwordx4 v56, s[8:11], s85 offen offset:3072 sc1 lds
    v_mfma_f32_16x16x32_bf16 v[124:127], v[220:223], v[144:147], v[124:127]
    ds_read_b128 v[208:211], v56 offset:23552
    s_waitcnt lgkmcnt(7)
    v_mfma_f32_16x16x32_bf16 v[132:135], v[176:179], v[144:147], v[132:135]
    ds_read_b128 v[212:215], v56 offset:24576
    v_mfma_f32_16x16x32_bf16 v[140:143], v[180:183], v[144:147], v[140:143]
    ds_read_b128 v[216:219], v56 offset:25600
    s_waitcnt lgkmcnt(7)
    v_mfma_f32_16x16x32_bf16 v[148:151], v[184:187], v[144:147], v[148:151]
    ds_read_b128 v[220:223], v56 offset:26624
    s_add_u32 m0, s0, 81920
    v_mfma_f32_16x16x32_bf16 v[156:159], v[188:191], v[144:147], v[156:159]
    ds_read_b128 v[176:179], v56 offset:27648
    s_waitcnt lgkmcnt(7)
    v_mfma_f32_16x16x32_bf16 v[164:167], v[192:195], v[144:147], v[164:167]
    ds_read_b128 v[180:183], v56 offset:28672
    s_add_u32 s85, s99, 65536
    v_mfma_f32_16x16x32_bf16 v[172:175], v[196:199], v[144:147], v[172:175]
    ds_read_b128 v[184:187], v56 offset:29696
    s_waitcnt lgkmcnt(7)
    v_mfma_f32_16x16x32_bf16 v[124:127], v[200:203], v[152:155], v[124:127]
    ds_read_b128 v[188:191], v56 offset:30720
    buffer_load_dwordx4 v56, s[8:11], s85 offen offset:0 sc1 lds
    v_mfma_f32_16x16x32_bf16 v[132:135], v[204:207], v[152:155], v[132:135]
    ds_read_b128 v[192:195], v56 offset:31744
    s_waitcnt lgkmcnt(7)
    v_mfma_f32_16x16x32_bf16 v[140:143], v[208:211], v[152:155], v[140:143]
    ds_read_b128 v[196:199], v56 offset:32768
    buffer_load_dwordx4 v56, s[8:11], s85 offen offset:1024 sc1 lds
    v_mfma_f32_16x16x32_bf16 v[148:151], v[212:215], v[152:155], v[148:151]
    ds_read_b128 v[200:203], v56 offset:33792
    s_waitcnt lgkmcnt(7)
    v_mfma_f32_16x16x32_bf16 v[156:159], v[216:219], v[152:155], v[156:159]
    ds_read_b128 v[204:207], v56 offset:34816
    buffer_load_dwordx4 v56, s[8:11], s85 offen offset:2048 sc1 lds
    v_mfma_f32_16x16x32_bf16 v[164:167], v[220:223], v[152:155], v[164:167]
    ds_read_b128 v[208:211], v56 offset:35840
    s_waitcnt lgkmcnt(7)
    v_mfma_f32_16x16x32_bf16 v[172:175], v[176:179], v[152:155], v[172:175]
    ds_read_b128 v[212:215], v56 offset:36864
    buffer_load_dwordx4 v56, s[8:11], s85 offen offset:3072 sc1 lds
    v_mfma_f32_16x16x32_bf16 v[124:127], v[180:183], v[160:163], v[124:127]
    ds_read_b128 v[216:219], v56 offset:37888
    s_waitcnt lgkmcnt(7)
    v_mfma_f32_16x16x32_bf16 v[132:135], v[184:187], v[160:163], v[132:135]
    ds_read_b128 v[220:223], v56 offset:38912
    s_add_u32 m0, s0, 114688
    v_mfma_f32_16x16x32_bf16 v[140:143], v[188:191], v[160:163], v[140:143]
    ds_read_b128 v[176:179], v56 offset:39936
    s_waitcnt lgkmcnt(7)
    v_mfma_f32_16x16x32_bf16 v[148:151], v[192:195], v[160:163], v[148:151]
    ds_read_b128 v[180:183], v56 offset:40960
    s_add_u32 s85, s99, 131072
    v_mfma_f32_16x16x32_bf16 v[156:159], v[196:199], v[160:163], v[156:159]
    ds_read_b128 v[184:187], v56 offset:41984
    s_waitcnt lgkmcnt(7)
    v_mfma_f32_16x16x32_bf16 v[164:167], v[200:203], v[160:163], v[164:167]
    ds_read_b128 v[68:71], v14 offset:448
    ds_read_b128 v[76:79], v14 offset:512
    v_mfma_f32_16x16x32_bf16 v[172:175], v[204:207], v[160:163], v[172:175]
    ds_read_b128 v[84:87], v14 offset:576
    ds_read_b128 v[92:95], v14 offset:640
    s_waitcnt lgkmcnt(9)
    v_mfma_f32_16x16x32_bf16 v[124:127], v[208:211], v[168:171], v[124:127]
    ds_read_b128 v[100:103], v14 offset:704
    ds_read_b128 v[108:111], v14 offset:768
    ds_read_b128 v[116:119], v14 offset:832
    v_mfma_f32_16x16x32_bf16 v[132:135], v[212:215], v[168:171], v[132:135]
    buffer_load_dwordx4 v56, s[8:11], s85 offen offset:0 sc1 lds
    s_waitcnt lgkmcnt(10)
    v_mfma_f32_16x16x32_bf16 v[140:143], v[216:219], v[168:171], v[140:143]
    v_mfma_f32_16x16x32_bf16 v[148:151], v[220:223], v[168:171], v[148:151]
    s_waitcnt lgkmcnt(8)
    v_mfma_f32_16x16x32_bf16 v[156:159], v[176:179], v[168:171], v[156:159]
    v_mfma_f32_16x16x32_bf16 v[164:167], v[180:183], v[168:171], v[164:167]
    s_waitcnt lgkmcnt(7)
    v_mfma_f32_16x16x32_bf16 v[172:175], v[184:187], v[168:171], v[172:175]
    s_waitcnt lgkmcnt(0)
    s_lshl_b32 s84, s63, 7
    v_lshlrev_b32 v236, 10, v0
    v_bfe_u32 v237, s26, v0, 1
    v_lshl_add_u32 v236, v237, 13, v236
    v_mov_b32 v237, 1
    s_waitcnt vmcnt(8)
    s_barrier
    s_mov_b64 exec, s[46:47]
    buffer_atomic_add v237, v236, s[8:11], s84 offen sc1
    s_mov_b64 exec, -1
    buffer_load_dwordx4 v56, s[8:11], s85 offen offset:1024 sc1 lds
    v_pk_fma_f32 v[124:125], v[68:69], v[18:19], v[124:125] op_sel:[0,1,0] op_sel_hi:[1,1,1]
    v_pk_fma_f32 v[126:127], v[70:71], v[18:19], v[126:127] op_sel:[0,1,0] op_sel_hi:[1,1,1]
    v_pk_fma_f32 v[132:133], v[76:77], v[18:19], v[132:133] op_sel:[0,1,0] op_sel_hi:[1,1,1]
    v_pk_fma_f32 v[134:135], v[78:79], v[18:19], v[134:135] op_sel:[0,1,0] op_sel_hi:[1,1,1]
    buffer_load_dwordx4 v56, s[8:11], s85 offen offset:2048 sc1 lds
    v_pk_fma_f32 v[140:141], v[84:85], v[18:19], v[140:141] op_sel:[0,1,0] op_sel_hi:[1,1,1]
    v_pk_fma_f32 v[142:143], v[86:87], v[18:19], v[142:143] op_sel:[0,1,0] op_sel_hi:[1,1,1]
    v_pk_fma_f32 v[148:149], v[92:93], v[18:19], v[148:149] op_sel:[0,1,0] op_sel_hi:[1,1,1]
    v_pk_fma_f32 v[150:151], v[94:95], v[18:19], v[150:151] op_sel:[0,1,0] op_sel_hi:[1,1,1]
    buffer_load_dwordx4 v56, s[8:11], s85 offen offset:3072 sc1 lds
    v_pk_fma_f32 v[156:157], v[100:101], v[18:19], v[156:157] op_sel:[0,1,0] op_sel_hi:[1,1,1]
    v_pk_fma_f32 v[158:159], v[102:103], v[18:19], v[158:159] op_sel:[0,1,0] op_sel_hi:[1,1,1]
    v_pk_fma_f32 v[164:165], v[108:109], v[18:19], v[164:165] op_sel:[0,1,0] op_sel_hi:[1,1,1]
    v_pk_fma_f32 v[166:167], v[110:111], v[18:19], v[166:167] op_sel:[0,1,0] op_sel_hi:[1,1,1]
    s_add_u32 m0, s0, 131072
    s_add_u32 s85, s99, 163840
    buffer_load_dwordx4 v56, s[8:11], s85 offen offset:0 sc1 lds
    v_pk_fma_f32 v[172:173], v[116:117], v[18:19], v[172:173] op_sel:[0,1,0] op_sel_hi:[1,1,1]
    v_pk_fma_f32 v[174:175], v[118:119], v[18:19], v[174:175] op_sel:[0,1,0] op_sel_hi:[1,1,1]
    s_mul_i32 s76, s62, 16384
    buffer_load_dwordx4 v56, s[8:11], s85 offen offset:1024 sc1 lds
    v_add_u32 v8, s76, v56
    s_add_u32 s76, s76, 393468
    v_lshl_add_u32 v14, v0, 8, s76
    s_add_u32 s77, s62, 1
    buffer_load_dwordx4 v56, s[8:11], s85 offen offset:2048 sc1 lds
    s_and_b32 s77, s77, 3
    s_mul_i32 s77, s77, 3072
    s_add_u32 s77, s77, 0
    v_add_u32 v9, s77, v56
    buffer_load_dwordx4 v56, s[8:11], s85 offen offset:3072 sc1 lds
    s_add_u32 s77, s62, 2
    s_and_b32 s77, s77, 3
    s_mul_i32 s77, s77, 3072
    s_add_u32 s77, s77, 1024
    s_add_u32 m0, s0, 147456
    s_add_u32 s85, s99, 196608
    buffer_load_dwordx4 v56, s[8:11], s85 offen offset:0 sc1 lds
    v_add_u32 v10, s77, v56
    s_add_u32 s77, s62, 3
    s_and_b32 s77, s77, 3
    buffer_load_dwordx4 v56, s[8:11], s85 offen offset:1024 sc1 lds
    s_mul_i32 s77, s77, 3072
    s_add_u32 s77, s77, 2048
    v_add_u32 v11, s77, v56
    s_add_u32 s77, s93, 0
    buffer_load_dwordx4 v56, s[8:11], s85 offen offset:2048 sc1 lds
    v_add_u32 v12, s77, v56
    v_add_u32 v13, 106496, v56
    s_lshl_b32 s76, s67, 3
    s_add_u32 s76, s76, s63
    buffer_load_dwordx4 v56, s[8:11], s85 offen offset:3072 sc1 lds
    s_lshl_b32 s76, s76, 7
    s_add_u32 s76, s76, s27
    v_mov_b32 v238, s76
    s_min_u32 s83, s63, 6
    s_lshl_b32 s77, s83, 4
    s_set_gpr_idx_on s77, gpr_idx(SRC0)
    v_mov_b32 v176, v58
    v_mov_b32 v177, v59
    v_mov_b32 v178, v64
    v_mov_b32 v179, v65
    v_mov_b32 v180, v66
    v_mov_b32 v181, v67
    v_mov_b32 v182, v72
    v_mov_b32 v183, v73
    v_mov_b32 v184, v74
    v_mov_b32 v185, v75
    s_set_gpr_idx_off
    s_lshl_b32 s83, s83, 6
    s_sub_u32 s83, 224, s83
    s_mul_i32 s77, s62, 2560
    s_add_u32 s77, s77, 24576
    v_mul_u32_u24 v21, 160, v1
    v_add_u32 v21, s77, v21
    v_lshlrev_b32 v22, 3, v2
    v_add_u32 v23, v22, v21
    ds_write_b64 v23, v[176:177] offset:0
    ds_write_b64 v23, v[178:179] offset:32
    ds_write_b64 v23, v[180:181] offset:64
    ds_write_b64 v23, v[182:183] offset:96
    ds_write_b64 v23, v[184:185] offset:128
    s_and_b64 exec, s[46:47], 1
    buffer_load_dword v239, v238, s[8:11], 0 offen sc1
    s_mov_b64 exec, -1
    s_add_u32 m0, s0, 98304
    s_add_u32 s85, s99, 98304
    buffer_load_dwordx4 v56, s[8:11], s85 offen offset:0 sc1 lds
    buffer_load_dwordx4 v56, s[8:11], s85 offen offset:1024 sc1 lds
    buffer_load_dwordx4 v56, s[8:11], s85 offen offset:2048 sc1 lds
    buffer_load_dwordx4 v56, s[8:11], s85 offen offset:3072 sc1 lds
    s_waitcnt vmcnt(4)
    s_and_b64 exec, s[46:47], 1
    v_cmp_gt_u32 vcc, s59, v239
    s_cbranch_vccz interleave_layers__spectral_fnet__mixer_gmlp__prompt_kernel_ct_4
    s_mov_b32 s98, 0
interleave_layers__spectral_fnet__mixer_gmlp__prompt_kernel_poll_5:
    buffer_load_dword v239, v238, s[8:11], 0 offen sc1
    s_add_u32 s98, s98, 1
    s_cmp_gt_u32 s98, 1048576
    s_cbranch_scc1 interleave_layers__spectral_fnet__mixer_gmlp__prompt_kernel_poll_5_x
    s_waitcnt vmcnt(0)
    v_cmp_gt_u32 vcc, s59, v239
    s_cbranch_vccnz interleave_layers__spectral_fnet__mixer_gmlp__prompt_kernel_poll_5
interleave_layers__spectral_fnet__mixer_gmlp__prompt_kernel_poll_5_x:
interleave_layers__spectral_fnet__mixer_gmlp__prompt_kernel_ct_4:
    s_mov_b64 exec, -1
    s_add_u32 s59, s59, 32
    s_waitcnt lgkmcnt(0)
    s_barrier
mid_join:
    s_add_u32 s76, s87, 0
    buffer_load_dwordx4 v[176:179], v8, s[8:11], s76 offen offset:0 sc1
    buffer_load_dwordx4 v[180:183], v8, s[8:11], s76 offen offset:1024 sc1
    buffer_load_dwordx4 v[184:187], v8, s[8:11], s76 offen offset:2048 sc1
    buffer_load_dwordx4 v[188:191], v8, s[8:11], s76 offen offset:3072 sc1
    s_add_u32 s76, s87, 4096
    buffer_load_dwordx4 v[192:195], v8, s[8:11], s76 offen offset:0 sc1
    buffer_load_dwordx4 v[196:199], v8, s[8:11], s76 offen offset:1024 sc1
    buffer_load_dwordx4 v[200:203], v8, s[8:11], s76 offen offset:2048 sc1
    buffer_load_dwordx4 v[204:207], v8, s[8:11], s76 offen offset:3072 sc1
    s_add_u32 s76, s87, 8192
    buffer_load_dwordx4 v[208:211], v8, s[8:11], s76 offen offset:0 sc1
    buffer_load_dwordx4 v[212:215], v8, s[8:11], s76 offen offset:1024 sc1
    buffer_load_dwordx4 v[216:219], v8, s[8:11], s76 offen offset:2048 sc1
    buffer_load_dwordx4 v[220:223], v8, s[8:11], s76 offen offset:3072 sc1
    s_add_u32 s76, s87, 12288
    buffer_load_dwordx4 v[224:227], v8, s[8:11], s76 offen offset:0 sc1
    buffer_load_dwordx4 v[228:231], v8, s[8:11], s76 offen offset:1024 sc1
    buffer_load_dwordx4 v[232:235], v8, s[8:11], s76 offen offset:2048 sc1
    buffer_load_dwordx4 v[236:239], v8, s[8:11], s76 offen offset:3072 sc1
    s_waitcnt vmcnt(15)
    v_mfma_f32_16x16x32_bf16 v[76:79], v[176:179], a[192:195], 0
    v_mul_f32 v112, v124, v124
    v_mul_f32 v113, v125, v125
    v_mfma_f32_16x16x32_bf16 v[72:75], v[176:179], a[128:131], 0
    v_mul_f32 v114, v126, v126
    v_mul_f32 v115, v127, v127
    v_mfma_f32_16x16x32_bf16 v[68:71], v[176:179], a[64:67], 0
    v_fma_f32 v112, v112, v16, v17
    v_fma_f32 v113, v113, v16, v17
    v_mfma_f32_16x16x32_bf16 v[64:67], v[176:179], a[0:3], v[4:7]
    s_add_u32 s76, s87, 65536
    buffer_load_dwordx4 v[176:179], v8, s[8:11], s76 offen offset:0 sc1
    s_waitcnt vmcnt(15)
    v_mfma_f32_16x16x32_bf16 v[76:79], v[180:183], a[196:199], v[76:79]
    v_fma_f32 v114, v114, v16, v17
    v_fma_f32 v115, v115, v16, v17
    v_mfma_f32_16x16x32_bf16 v[72:75], v[180:183], a[132:135], v[72:75]
    v_mul_f32 v112, v112, v124
    v_mul_f32 v113, v113, v125
    v_mfma_f32_16x16x32_bf16 v[68:71], v[180:183], a[68:71], v[68:71]
    v_mul_f32 v114, v114, v126
    v_mul_f32 v115, v115, v127
    v_mfma_f32_16x16x32_bf16 v[64:67], v[180:183], a[4:7], v[64:67]
    buffer_load_dwordx4 v[180:183], v8, s[8:11], s76 offen offset:1024 sc1
    s_waitcnt vmcnt(15)
    v_mfma_f32_16x16x32_bf16 v[76:79], v[184:187], a[200:203], v[76:79]
    v_exp_f32 v112, v112
    v_mfma_f32_16x16x32_bf16 v[72:75], v[184:187], a[136:139], v[72:75]
    v_exp_f32 v113, v113
    v_mfma_f32_16x16x32_bf16 v[68:71], v[184:187], a[72:75], v[68:71]
    v_exp_f32 v114, v114
    v_mfma_f32_16x16x32_bf16 v[64:67], v[184:187], a[8:11], v[64:67]
    buffer_load_dwordx4 v[184:187], v8, s[8:11], s76 offen offset:2048 sc1
    s_waitcnt vmcnt(15)
    v_mfma_f32_16x16x32_bf16 v[76:79], v[188:191], a[204:207], v[76:79]
    v_exp_f32 v115, v115
    v_mfma_f32_16x16x32_bf16 v[72:75], v[188:191], a[140:143], v[72:75]
    v_fma_f32 v112, v112, v18, v18
    v_fma_f32 v113, v113, v18, v18
    v_mfma_f32_16x16x32_bf16 v[68:71], v[188:191], a[76:79], v[68:71]
    v_fma_f32 v114, v114, v18, v18
    v_fma_f32 v115, v115, v18, v18
    v_mfma_f32_16x16x32_bf16 v[64:67], v[188:191], a[12:15], v[64:67]
    buffer_load_dwordx4 v[188:191], v8, s[8:11], s76 offen offset:3072 sc1
    s_waitcnt vmcnt(15)
    v_mfma_f32_16x16x32_bf16 v[76:79], v[192:195], a[208:211], v[76:79]
    v_rcp_f32 v112, v112
    v_mfma_f32_16x16x32_bf16 v[72:75], v[192:195], a[144:147], v[72:75]
    v_rcp_f32 v113, v113
    v_mfma_f32_16x16x32_bf16 v[68:71], v[192:195], a[80:83], v[68:71]
    v_rcp_f32 v114, v114
    v_mfma_f32_16x16x32_bf16 v[64:67], v[192:195], a[16:19], v[64:67]
    s_add_u32 s76, s87, 69632
    buffer_load_dwordx4 v[192:195], v8, s[8:11], s76 offen offset:0 sc1
    s_waitcnt vmcnt(15)
    v_mfma_f32_16x16x32_bf16 v[76:79], v[196:199], a[212:215], v[76:79]
    v_rcp_f32 v115, v115
    v_mfma_f32_16x16x32_bf16 v[72:75], v[196:199], a[148:151], v[72:75]
    v_mul_f32 v124, v124, v112
    v_mul_f32 v125, v125, v113
    v_mfma_f32_16x16x32_bf16 v[68:71], v[196:199], a[84:87], v[68:71]
    v_mul_f32 v126, v126, v114
    v_mul_f32 v127, v127, v115
    v_mfma_f32_16x16x32_bf16 v[64:67], v[196:199], a[20:23], v[64:67]
    buffer_load_dwordx4 v[196:199], v8, s[8:11], s76 offen offset:1024 sc1
    s_waitcnt vmcnt(15)
    v_mfma_f32_16x16x32_bf16 v[76:79], v[200:203], a[216:219], v[76:79]
    v_lshl_add_u32 v20, v22, 1, v21
    v_xor_b32 v23, 8, v22
    v_mfma_f32_16x16x32_bf16 v[72:75], v[200:203], a[152:155], v[72:75]
    v_add_u32 v20, 30, v20
    v_lshl_add_u32 v21, v23, 1, v21
    v_mfma_f32_16x16x32_bf16 v[68:71], v[200:203], a[88:91], v[68:71]
    v_add_u32 v21, 46, v21
    v_mfma_f32_16x16x32_bf16 v[64:67], v[200:203], a[24:27], v[64:67]
    buffer_load_dwordx4 v[200:203], v8, s[8:11], s76 offen offset:2048 sc1
    s_waitcnt vmcnt(15)
    v_mfma_f32_16x16x32_bf16 v[76:79], v[204:207], a[220:223], v[76:79]
    s_sub_u32 s77, s83, 0
    v_cmp_ge_i32 vcc, s77, v22
    v_mov_b32 v240, 0
    v_mfma_f32_16x16x32_bf16 v[72:75], v[204:207], a[156:159], v[72:75]
    v_cndmask_b32 v23, v21, v20, vcc
    ds_read_u16_d16_hi v240, v23 offset:0
    v_mfma_f32_16x16x32_bf16 v[68:71], v[204:207], a[92:95], v[68:71]
    s_sub_u32 s77, s83, 32
    v_cmp_ge_i32 vcc, s77, v22
    v_mov_b32 v248, 0
    v_mfma_f32_16x16x32_bf16 v[64:67], v[204:207], a[28:31], v[64:67]
    buffer_load_dwordx4 v[204:207], v8, s[8:11], s76 offen offset:3072 sc1
    s_waitcnt vmcnt(15)
    v_mfma_f32_16x16x32_bf16 v[76:79], v[208:211], a[224:227], v[76:79]
    v_cndmask_b32 v23, v21, v20, vcc
    ds_read_u16_d16_hi v248, v23 offset:64
    v_mfma_f32_16x16x32_bf16 v[72:75], v[208:211], a[160:163], v[72:75]
    v_add_u32 v20, 2, v20
    v_add_u32 v21, -2, v21
    v_mfma_f32_16x16x32_bf16 v[68:71], v[208:211], a[96:99], v[68:71]
    s_sub_u32 s77, s83, 1
    v_cmp_ge_i32 vcc, s77, v22
    v_mov_b32 v241, 0
    v_mfma_f32_16x16x32_bf16 v[64:67], v[208:211], a[32:35], v[64:67]
    s_add_u32 s76, s87, 73728
    buffer_load_dwordx4 v[208:211], v8, s[8:11], s76 offen offset:0 sc1
    s_waitcnt vmcnt(15)
    v_mfma_f32_16x16x32_bf16 v[76:79], v[212:215], a[228:231], v[76:79]
    v_cndmask_b32 v23, v21, v20, vcc
    ds_read_u16_d16_hi v241, v23 offset:0
    v_mfma_f32_16x16x32_bf16 v[72:75], v[212:215], a[164:167], v[72:75]
    s_sub_u32 s77, s83, 33
    v_cmp_ge_i32 vcc, s77, v22
    v_mov_b32 v249, 0
    v_mfma_f32_16x16x32_bf16 v[68:71], v[212:215], a[100:103], v[68:71]
    v_cndmask_b32 v23, v21, v20, vcc
    ds_read_u16_d16_hi v249, v23 offset:64
    v_mfma_f32_16x16x32_bf16 v[64:67], v[212:215], a[36:39], v[64:67]
    buffer_load_dwordx4 v[212:215], v8, s[8:11], s76 offen offset:1024 sc1
    s_waitcnt vmcnt(15)
    v_mfma_f32_16x16x32_bf16 v[76:79], v[216:219], a[232:235], v[76:79]
    v_add_u32 v20, 2, v20
    v_add_u32 v21, -2, v21
    v_mfma_f32_16x16x32_bf16 v[72:75], v[216:219], a[168:171], v[72:75]
    s_sub_u32 s77, s83, 2
    v_cmp_ge_i32 vcc, s77, v22
    v_mov_b32 v242, 0
    v_mfma_f32_16x16x32_bf16 v[68:71], v[216:219], a[104:107], v[68:71]
    v_cndmask_b32 v23, v21, v20, vcc
    ds_read_u16_d16_hi v242, v23 offset:0
    v_mfma_f32_16x16x32_bf16 v[64:67], v[216:219], a[40:43], v[64:67]
    buffer_load_dwordx4 v[216:219], v8, s[8:11], s76 offen offset:2048 sc1
    s_waitcnt vmcnt(15)
    v_mfma_f32_16x16x32_bf16 v[76:79], v[220:223], a[236:239], v[76:79]
    s_sub_u32 s77, s83, 34
    v_cmp_ge_i32 vcc, s77, v22
    v_mov_b32 v250, 0
    v_mfma_f32_16x16x32_bf16 v[72:75], v[220:223], a[172:175], v[72:75]
    v_cndmask_b32 v23, v21, v20, vcc
    ds_read_u16_d16_hi v250, v23 offset:64
    v_mfma_f32_16x16x32_bf16 v[68:71], v[220:223], a[108:111], v[68:71]
    v_add_u32 v20, 2, v20
    v_add_u32 v21, -2, v21
    v_mfma_f32_16x16x32_bf16 v[64:67], v[220:223], a[44:47], v[64:67]
    buffer_load_dwordx4 v[220:223], v8, s[8:11], s76 offen offset:3072 sc1
    s_waitcnt vmcnt(15)
    v_mfma_f32_16x16x32_bf16 v[76:79], v[224:227], a[240:243], v[76:79]
    s_sub_u32 s77, s83, 3
    v_cmp_ge_i32 vcc, s77, v22
    v_mov_b32 v243, 0
    v_mfma_f32_16x16x32_bf16 v[72:75], v[224:227], a[176:179], v[72:75]
    v_cndmask_b32 v23, v21, v20, vcc
    ds_read_u16_d16_hi v243, v23 offset:0
    v_mfma_f32_16x16x32_bf16 v[68:71], v[224:227], a[112:115], v[68:71]
    s_sub_u32 s77, s83, 35
    v_cmp_ge_i32 vcc, s77, v22
    v_mov_b32 v251, 0
    v_mfma_f32_16x16x32_bf16 v[64:67], v[224:227], a[48:51], v[64:67]
    s_add_u32 s76, s87, 77824
    buffer_load_dwordx4 v[224:227], v8, s[8:11], s76 offen offset:0 sc1
    s_waitcnt vmcnt(15)
    v_mfma_f32_16x16x32_bf16 v[76:79], v[228:231], a[244:247], v[76:79]
    v_cndmask_b32 v23, v21, v20, vcc
    ds_read_u16_d16_hi v251, v23 offset:64
    v_mfma_f32_16x16x32_bf16 v[72:75], v[228:231], a[180:183], v[72:75]
    v_add_u32 v20, 2, v20
    v_add_u32 v21, -2, v21
    v_mfma_f32_16x16x32_bf16 v[68:71], v[228:231], a[116:119], v[68:71]
    s_sub_u32 s77, s83, 4
    v_cmp_ge_i32 vcc, s77, v22
    v_mov_b32 v244, 0
    v_mfma_f32_16x16x32_bf16 v[64:67], v[228:231], a[52:55], v[64:67]
    buffer_load_dwordx4 v[228:231], v8, s[8:11], s76 offen offset:1024 sc1
    s_waitcnt vmcnt(15)
    v_mfma_f32_16x16x32_bf16 v[76:79], v[232:235], a[248:251], v[76:79]
    v_cndmask_b32 v23, v21, v20, vcc
    ds_read_u16_d16_hi v244, v23 offset:0
    v_mfma_f32_16x16x32_bf16 v[72:75], v[232:235], a[184:187], v[72:75]
    s_sub_u32 s77, s83, 36
    v_cmp_ge_i32 vcc, s77, v22
    v_mov_b32 v252, 0
    v_mfma_f32_16x16x32_bf16 v[68:71], v[232:235], a[120:123], v[68:71]
    v_cndmask_b32 v23, v21, v20, vcc
    ds_read_u16_d16_hi v252, v23 offset:64
    v_mfma_f32_16x16x32_bf16 v[64:67], v[232:235], a[56:59], v[64:67]
    buffer_load_dwordx4 v[232:235], v8, s[8:11], s76 offen offset:2048 sc1
    s_waitcnt vmcnt(15)
    v_mfma_f32_16x16x32_bf16 v[76:79], v[236:239], a[252:255], v[76:79]
    v_add_u32 v20, 2, v20
    v_add_u32 v21, -2, v21
    v_mfma_f32_16x16x32_bf16 v[72:75], v[236:239], a[188:191], v[72:75]
    s_sub_u32 s77, s83, 5
    v_cmp_ge_i32 vcc, s77, v22
    v_mov_b32 v245, 0
    v_mfma_f32_16x16x32_bf16 v[68:71], v[236:239], a[124:127], v[68:71]
    v_cndmask_b32 v23, v21, v20, vcc
    ds_read_u16_d16_hi v245, v23 offset:0
    v_mfma_f32_16x16x32_bf16 v[64:67], v[236:239], a[60:63], v[64:67]
    buffer_load_dwordx4 v[236:239], v8, s[8:11], s76 offen offset:3072 sc1
    s_waitcnt vmcnt(15)
    v_mfma_f32_16x16x32_bf16 v[92:95], v[176:179], a[192:195], 0
    v_mul_f32 v112, v132, v132
    v_mul_f32 v113, v133, v133
    v_mfma_f32_16x16x32_bf16 v[88:91], v[176:179], a[128:131], 0
    v_mul_f32 v114, v134, v134
    v_mul_f32 v115, v135, v135
    v_mfma_f32_16x16x32_bf16 v[84:87], v[176:179], a[64:67], 0
    v_fma_f32 v112, v112, v16, v17
    v_fma_f32 v113, v113, v16, v17
    v_mfma_f32_16x16x32_bf16 v[80:83], v[176:179], a[0:3], v[4:7]
    s_add_u32 s76, s87, 131072
    buffer_load_dwordx4 v[176:179], v8, s[8:11], s76 offen offset:0 sc1
    s_waitcnt vmcnt(15)
    v_mfma_f32_16x16x32_bf16 v[92:95], v[180:183], a[196:199], v[92:95]
    v_fma_f32 v114, v114, v16, v17
    v_fma_f32 v115, v115, v16, v17
    v_mfma_f32_16x16x32_bf16 v[88:91], v[180:183], a[132:135], v[88:91]
    ds_write_b128 v11, v[76:79] offset:0
    v_mfma_f32_16x16x32_bf16 v[84:87], v[180:183], a[68:71], v[84:87]
    ds_write_b128 v10, v[72:75] offset:0
    v_mfma_f32_16x16x32_bf16 v[80:83], v[180:183], a[4:7], v[80:83]
    buffer_load_dwordx4 v[180:183], v8, s[8:11], s76 offen offset:1024 sc1
    s_waitcnt vmcnt(15)
    v_mfma_f32_16x16x32_bf16 v[92:95], v[184:187], a[200:203], v[92:95]
    ds_write_b128 v9, v[68:71] offset:0
    v_mfma_f32_16x16x32_bf16 v[88:91], v[184:187], a[136:139], v[88:91]
    v_mul_f32 v112, v112, v132
    v_mul_f32 v113, v113, v133
    v_mfma_f32_16x16x32_bf16 v[84:87], v[184:187], a[72:75], v[84:87]
    v_mul_f32 v114, v114, v134
    v_mul_f32 v115, v115, v135
    v_mfma_f32_16x16x32_bf16 v[80:83], v[184:187], a[8:11], v[80:83]
    buffer_load_dwordx4 v[184:187], v8, s[8:11], s76 offen offset:2048 sc1
    s_waitcnt vmcnt(15)
    v_mfma_f32_16x16x32_bf16 v[92:95], v[188:191], a[204:207], v[92:95]
    v_exp_f32 v112, v112
    v_mfma_f32_16x16x32_bf16 v[88:91], v[188:191], a[140:143], v[88:91]
    v_exp_f32 v113, v113
    v_mfma_f32_16x16x32_bf16 v[84:87], v[188:191], a[76:79], v[84:87]
    v_exp_f32 v114, v114
    v_mfma_f32_16x16x32_bf16 v[80:83], v[188:191], a[12:15], v[80:83]
    buffer_load_dwordx4 v[188:191], v8, s[8:11], s76 offen offset:3072 sc1
    s_waitcnt vmcnt(15)
    v_mfma_f32_16x16x32_bf16 v[92:95], v[192:195], a[208:211], v[92:95]
    v_exp_f32 v115, v115
    v_mfma_f32_16x16x32_bf16 v[88:91], v[192:195], a[144:147], v[88:91]
    v_fma_f32 v112, v112, v18, v18
    v_fma_f32 v113, v113, v18, v18
    v_mfma_f32_16x16x32_bf16 v[84:87], v[192:195], a[80:83], v[84:87]
    s_waitcnt lgkmcnt(0)
    s_barrier
    ds_read_b128 v[96:99], v12 offset:0
    v_mfma_f32_16x16x32_bf16 v[80:83], v[192:195], a[16:19], v[80:83]
    s_add_u32 s76, s87, 135168
    buffer_load_dwordx4 v[192:195], v8, s[8:11], s76 offen offset:0 sc1
    s_waitcnt vmcnt(15)
    v_mfma_f32_16x16x32_bf16 v[92:95], v[196:199], a[212:215], v[92:95]
    ds_read_b128 v[100:103], v12 offset:1024
    v_mfma_f32_16x16x32_bf16 v[88:91], v[196:199], a[148:151], v[88:91]
    ds_read_b128 v[104:107], v12 offset:2048
    v_mfma_f32_16x16x32_bf16 v[84:87], v[196:199], a[84:87], v[84:87]
    v_fma_f32 v114, v114, v18, v18
    v_fma_f32 v115, v115, v18, v18
    v_mfma_f32_16x16x32_bf16 v[80:83], v[196:199], a[20:23], v[80:83]
    buffer_load_dwordx4 v[196:199], v8, s[8:11], s76 offen offset:1024 sc1
    s_waitcnt vmcnt(15)
    v_mfma_f32_16x16x32_bf16 v[92:95], v[200:203], a[216:219], v[92:95]
    v_rcp_f32 v112, v112
    v_mfma_f32_16x16x32_bf16 v[88:91], v[200:203], a[152:155], v[88:91]
    v_rcp_f32 v113, v113
    v_mfma_f32_16x16x32_bf16 v[84:87], v[200:203], a[88:91], v[84:87]
    v_rcp_f32 v114, v114
    v_mfma_f32_16x16x32_bf16 v[80:83], v[200:203], a[24:27], v[80:83]
    buffer_load_dwordx4 v[200:203], v8, s[8:11], s76 offen offset:2048 sc1
    s_waitcnt vmcnt(15)
    v_mfma_f32_16x16x32_bf16 v[92:95], v[204:207], a[220:223], v[92:95]
    v_rcp_f32 v115, v115
    v_mfma_f32_16x16x32_bf16 v[88:91], v[204:207], a[156:159], v[88:91]
    v_mul_f32 v132, v132, v112
    v_mul_f32 v133, v133, v113
    v_mfma_f32_16x16x32_bf16 v[84:87], v[204:207], a[92:95], v[84:87]
    v_mul_f32 v134, v134, v114
    v_mul_f32 v135, v135, v115
    v_mfma_f32_16x16x32_bf16 v[80:83], v[204:207], a[28:31], v[80:83]
    buffer_load_dwordx4 v[204:207], v8, s[8:11], s76 offen offset:3072 sc1
    s_waitcnt vmcnt(15)
    v_mfma_f32_16x16x32_bf16 v[92:95], v[208:211], a[224:227], v[92:95]
    s_waitcnt lgkmcnt(0)
    v_add_f32 v96, v96, v100
    v_add_f32 v104, v104, v64
    v_mfma_f32_16x16x32_bf16 v[88:91], v[208:211], a[160:163], v[88:91]
    v_add_f32 v97, v97, v101
    v_add_f32 v105, v105, v65
    v_mfma_f32_16x16x32_bf16 v[84:87], v[208:211], a[96:99], v[84:87]
    v_add_f32 v98, v98, v102
    v_add_f32 v106, v106, v66
    v_mfma_f32_16x16x32_bf16 v[80:83], v[208:211], a[32:35], v[80:83]
    s_add_u32 s76, s87, 139264
    buffer_load_dwordx4 v[208:211], v8, s[8:11], s76 offen offset:0 sc1
    s_waitcnt vmcnt(15)
    v_mfma_f32_16x16x32_bf16 v[92:95], v[212:215], a[228:231], v[92:95]
    v_add_f32 v99, v99, v103
    v_add_f32 v107, v107, v67
    v_mfma_f32_16x16x32_bf16 v[88:91], v[212:215], a[164:167], v[88:91]
    v_add_f32 v96, v96, v104
    v_add_f32 v97, v97, v105
    v_mfma_f32_16x16x32_bf16 v[84:87], v[212:215], a[100:103], v[84:87]
    v_add_f32 v98, v98, v106
    v_add_f32 v99, v99, v107
    v_mfma_f32_16x16x32_bf16 v[80:83], v[212:215], a[36:39], v[80:83]
    buffer_load_dwordx4 v[212:215], v8, s[8:11], s76 offen offset:1024 sc1
    s_waitcnt vmcnt(15)
    v_mfma_f32_16x16x32_bf16 v[92:95], v[216:219], a[232:235], v[92:95]
    v_mul_f32 v96, v96, v124
    v_mul_f32 v97, v97, v125
    v_mfma_f32_16x16x32_bf16 v[88:91], v[216:219], a[168:171], v[88:91]
    v_mul_f32 v98, v98, v126
    v_mul_f32 v99, v99, v127
    v_mfma_f32_16x16x32_bf16 v[84:87], v[216:219], a[104:107], v[84:87]
    v_cvt_pk_bf16_f32 v108, v96, v97
    v_cvt_pk_bf16_f32 v109, v98, v99
    v_mfma_f32_16x16x32_bf16 v[80:83], v[216:219], a[40:43], v[80:83]
    buffer_load_dwordx4 v[216:219], v8, s[8:11], s76 offen offset:2048 sc1
    s_waitcnt vmcnt(15)
    v_mfma_f32_16x16x32_bf16 v[92:95], v[220:223], a[236:239], v[92:95]
    s_sub_u32 s77, s83, 37
    v_cmp_ge_i32 vcc, s77, v22
    v_mov_b32 v253, 0
    v_mfma_f32_16x16x32_bf16 v[88:91], v[220:223], a[172:175], v[88:91]
    v_cndmask_b32 v23, v21, v20, vcc
    ds_read_u16_d16_hi v253, v23 offset:64
    v_mfma_f32_16x16x32_bf16 v[84:87], v[220:223], a[108:111], v[84:87]
    v_add_u32 v20, 2, v20
    v_add_u32 v21, -2, v21
    v_mfma_f32_16x16x32_bf16 v[80:83], v[220:223], a[44:47], v[80:83]
    buffer_load_dwordx4 v[220:223], v8, s[8:11], s76 offen offset:3072 sc1
    s_waitcnt vmcnt(15)
    v_mfma_f32_16x16x32_bf16 v[92:95], v[224:227], a[240:243], v[92:95]
    s_sub_u32 s77, s83, 6
    v_cmp_ge_i32 vcc, s77, v22
    v_mov_b32 v246, 0
    v_mfma_f32_16x16x32_bf16 v[88:91], v[224:227], a[176:179], v[88:91]
    v_cndmask_b32 v23, v21, v20, vcc
    ds_read_u16_d16_hi v246, v23 offset:0
    v_mfma_f32_16x16x32_bf16 v[84:87], v[224:227], a[112:115], v[84:87]
    s_sub_u32 s77, s83, 38
    v_cmp_ge_i32 vcc, s77, v22
    v_mov_b32 v254, 0
    v_mfma_f32_16x16x32_bf16 v[80:83], v[224:227], a[48:51], v[80:83]
    s_add_u32 s76, s87, 143360
    buffer_load_dwordx4 v[224:227], v8, s[8:11], s76 offen offset:0 sc1
    s_waitcnt vmcnt(15)
    v_mfma_f32_16x16x32_bf16 v[92:95], v[228:231], a[244:247], v[92:95]
    v_cndmask_b32 v23, v21, v20, vcc
    ds_read_u16_d16_hi v254, v23 offset:64
    v_mfma_f32_16x16x32_bf16 v[88:91], v[228:231], a[180:183], v[88:91]
    v_add_u32 v20, 2, v20
    v_add_u32 v21, -2, v21
    v_mfma_f32_16x16x32_bf16 v[84:87], v[228:231], a[116:119], v[84:87]
    s_sub_u32 s77, s83, 7
    v_cmp_ge_i32 vcc, s77, v22
    v_mov_b32 v247, 0
    v_mfma_f32_16x16x32_bf16 v[80:83], v[228:231], a[52:55], v[80:83]
    buffer_load_dwordx4 v[228:231], v8, s[8:11], s76 offen offset:1024 sc1
    s_waitcnt vmcnt(15)
    v_mfma_f32_16x16x32_bf16 v[92:95], v[232:235], a[248:251], v[92:95]
    v_cndmask_b32 v23, v21, v20, vcc
    ds_read_u16_d16_hi v247, v23 offset:0
    v_mfma_f32_16x16x32_bf16 v[88:91], v[232:235], a[184:187], v[88:91]
    s_sub_u32 s77, s83, 39
    v_cmp_ge_i32 vcc, s77, v22
    v_mov_b32 v255, 0
    v_mfma_f32_16x16x32_bf16 v[84:87], v[232:235], a[120:123], v[84:87]
    v_cndmask_b32 v23, v21, v20, vcc
    ds_read_u16_d16_hi v255, v23 offset:64
    v_mfma_f32_16x16x32_bf16 v[80:83], v[232:235], a[56:59], v[80:83]
    buffer_load_dwordx4 v[232:235], v8, s[8:11], s76 offen offset:2048 sc1
    s_waitcnt vmcnt(15)
    v_mfma_f32_16x16x32_bf16 v[92:95], v[236:239], a[252:255], v[92:95]
    v_mfma_f32_16x16x32_bf16 v[88:91], v[236:239], a[188:191], v[88:91]
    v_mfma_f32_16x16x32_bf16 v[84:87], v[236:239], a[124:127], v[84:87]
    v_mfma_f32_16x16x32_bf16 v[80:83], v[236:239], a[60:63], v[80:83]
    buffer_load_dwordx4 v[236:239], v8, s[8:11], s76 offen offset:3072 sc1
    s_waitcnt vmcnt(15)
    v_mfma_f32_16x16x32_bf16 v[76:79], v[176:179], a[192:195], 0
    v_mul_f32 v112, v140, v140
    v_mul_f32 v113, v141, v141
    v_mfma_f32_16x16x32_bf16 v[72:75], v[176:179], a[128:131], 0
    v_mul_f32 v114, v142, v142
    v_mul_f32 v115, v143, v143
    v_mfma_f32_16x16x32_bf16 v[68:71], v[176:179], a[64:67], 0
    v_fma_f32 v112, v112, v16, v17
    v_fma_f32 v113, v113, v16, v17
    v_mfma_f32_16x16x32_bf16 v[64:67], v[176:179], a[0:3], v[4:7]
    s_add_u32 s76, s87, 196608
    buffer_load_dwordx4 v[176:179], v8, s[8:11], s76 offen offset:0 sc1
    s_waitcnt vmcnt(15)
    v_mfma_f32_16x16x32_bf16 v[76:79], v[180:183], a[196:199], v[76:79]
    v_fma_f32 v114, v114, v16, v17
    v_fma_f32 v115, v115, v16, v17
    v_mfma_f32_16x16x32_bf16 v[72:75], v[180:183], a[132:135], v[72:75]
    ds_write_b128 v11, v[92:95] offset:12288
    v_mfma_f32_16x16x32_bf16 v[68:71], v[180:183], a[68:71], v[68:71]
    ds_write_b128 v10, v[88:91] offset:12288
    v_mfma_f32_16x16x32_bf16 v[64:67], v[180:183], a[4:7], v[64:67]
    buffer_load_dwordx4 v[180:183], v8, s[8:11], s76 offen offset:1024 sc1
    s_waitcnt vmcnt(15)
    v_mfma_f32_16x16x32_bf16 v[76:79], v[184:187], a[200:203], v[76:79]
    ds_write_b128 v9, v[84:87] offset:12288
    v_mfma_f32_16x16x32_bf16 v[72:75], v[184:187], a[136:139], v[72:75]
    v_mul_f32 v112, v112, v140
    v_mul_f32 v113, v113, v141
    v_mfma_f32_16x16x32_bf16 v[68:71], v[184:187], a[72:75], v[68:71]
    v_mul_f32 v114, v114, v142
    v_mul_f32 v115, v115, v143
    v_mfma_f32_16x16x32_bf16 v[64:67], v[184:187], a[8:11], v[64:67]
    buffer_load_dwordx4 v[184:187], v8, s[8:11], s76 offen offset:2048 sc1
    s_waitcnt vmcnt(15)
    v_mfma_f32_16x16x32_bf16 v[76:79], v[188:191], a[204:207], v[76:79]
    v_exp_f32 v112, v112
    v_mfma_f32_16x16x32_bf16 v[72:75], v[188:191], a[140:143], v[72:75]
    v_exp_f32 v113, v113
    v_mfma_f32_16x16x32_bf16 v[68:71], v[188:191], a[76:79], v[68:71]
    v_exp_f32 v114, v114
    v_mfma_f32_16x16x32_bf16 v[64:67], v[188:191], a[12:15], v[64:67]
    buffer_load_dwordx4 v[188:191], v8, s[8:11], s76 offen offset:3072 sc1
    s_waitcnt vmcnt(15)
    v_mfma_f32_16x16x32_bf16 v[76:79], v[192:195], a[208:211], v[76:79]
    v_exp_f32 v115, v115
    v_mfma_f32_16x16x32_bf16 v[72:75], v[192:195], a[144:147], v[72:75]
    v_fma_f32 v112, v112, v18, v18
    v_fma_f32 v113, v113, v18, v18
    v_mfma_f32_16x16x32_bf16 v[68:71], v[192:195], a[80:83], v[68:71]
    s_waitcnt lgkmcnt(0)
    s_barrier
    ds_read_b128 v[96:99], v12 offset:12288
    v_mfma_f32_16x16x32_bf16 v[64:67], v[192:195], a[16:19], v[64:67]
    s_add_u32 s76, s87, 200704
    buffer_load_dwordx4 v[192:195], v8, s[8:11], s76 offen offset:0 sc1
    s_waitcnt vmcnt(15)
    v_mfma_f32_16x16x32_bf16 v[76:79], v[196:199], a[212:215], v[76:79]
    ds_read_b128 v[100:103], v12 offset:13312
    v_mfma_f32_16x16x32_bf16 v[72:75], v[196:199], a[148:151], v[72:75]
    ds_read_b128 v[104:107], v12 offset:14336
    v_mfma_f32_16x16x32_bf16 v[68:71], v[196:199], a[84:87], v[68:71]
    v_fma_f32 v114, v114, v18, v18
    v_fma_f32 v115, v115, v18, v18
    v_mfma_f32_16x16x32_bf16 v[64:67], v[196:199], a[20:23], v[64:67]
    buffer_load_dwordx4 v[196:199], v8, s[8:11], s76 offen offset:1024 sc1
    s_waitcnt vmcnt(15)
    v_mfma_f32_16x16x32_bf16 v[76:79], v[200:203], a[216:219], v[76:79]
    v_rcp_f32 v112, v112
    v_mfma_f32_16x16x32_bf16 v[72:75], v[200:203], a[152:155], v[72:75]
    v_rcp_f32 v113, v113
    v_mfma_f32_16x16x32_bf16 v[68:71], v[200:203], a[88:91], v[68:71]
    v_rcp_f32 v114, v114
    v_mfma_f32_16x16x32_bf16 v[64:67], v[200:203], a[24:27], v[64:67]
    buffer_load_dwordx4 v[200:203], v8, s[8:11], s76 offen offset:2048 sc1
    s_waitcnt vmcnt(15)
    v_mfma_f32_16x16x32_bf16 v[76:79], v[204:207], a[220:223], v[76:79]
    v_rcp_f32 v115, v115
    v_mfma_f32_16x16x32_bf16 v[72:75], v[204:207], a[156:159], v[72:75]
    v_mul_f32 v140, v140, v112
    v_mul_f32 v141, v141, v113
    v_mfma_f32_16x16x32_bf16 v[68:71], v[204:207], a[92:95], v[68:71]
    v_mul_f32 v142, v142, v114
    v_mul_f32 v143, v143, v115
    v_mfma_f32_16x16x32_bf16 v[64:67], v[204:207], a[28:31], v[64:67]
    buffer_load_dwordx4 v[204:207], v8, s[8:11], s76 offen offset:3072 sc1
    s_waitcnt vmcnt(15)
    v_mfma_f32_16x16x32_bf16 v[76:79], v[208:211], a[224:227], v[76:79]
    s_waitcnt lgkmcnt(0)
    v_add_f32 v96, v96, v100
    v_add_f32 v104, v104, v80
    v_mfma_f32_16x16x32_bf16 v[72:75], v[208:211], a[160:163], v[72:75]
    v_add_f32 v97, v97, v101
    v_add_f32 v105, v105, v81
    v_mfma_f32_16x16x32_bf16 v[68:71], v[208:211], a[96:99], v[68:71]
    v_add_f32 v98, v98, v102
    v_add_f32 v106, v106, v82
    v_mfma_f32_16x16x32_bf16 v[64:67], v[208:211], a[32:35], v[64:67]
    s_add_u32 s76, s87, 204800
    buffer_load_dwordx4 v[208:211], v8, s[8:11], s76 offen offset:0 sc1
    s_waitcnt vmcnt(15)
    v_mfma_f32_16x16x32_bf16 v[76:79], v[212:215], a[228:231], v[76:79]
    v_add_f32 v99, v99, v103
    v_add_f32 v107, v107, v83
    v_mfma_f32_16x16x32_bf16 v[72:75], v[212:215], a[164:167], v[72:75]
    v_add_f32 v96, v96, v104
    v_add_f32 v97, v97, v105
    v_mfma_f32_16x16x32_bf16 v[68:71], v[212:215], a[100:103], v[68:71]
    v_add_f32 v98, v98, v106
    v_add_f32 v99, v99, v107
    v_mfma_f32_16x16x32_bf16 v[64:67], v[212:215], a[36:39], v[64:67]
    buffer_load_dwordx4 v[212:215], v8, s[8:11], s76 offen offset:1024 sc1
    s_waitcnt vmcnt(15)
    v_mfma_f32_16x16x32_bf16 v[76:79], v[216:219], a[232:235], v[76:79]
    v_mul_f32 v96, v96, v132
    v_mul_f32 v97, v97, v133
    v_mfma_f32_16x16x32_bf16 v[72:75], v[216:219], a[168:171], v[72:75]
    v_mul_f32 v98, v98, v134
    v_mul_f32 v99, v99, v135
    v_mfma_f32_16x16x32_bf16 v[68:71], v[216:219], a[104:107], v[68:71]
    v_cvt_pk_bf16_f32 v110, v96, v97
    v_cvt_pk_bf16_f32 v111, v98, v99
    v_mfma_f32_16x16x32_bf16 v[64:67], v[216:219], a[40:43], v[64:67]
    buffer_load_dwordx4 v[216:219], v8, s[8:11], s76 offen offset:2048 sc1
    s_waitcnt vmcnt(15)
    v_mfma_f32_16x16x32_bf16 v[76:79], v[220:223], a[236:239], v[76:79]
    s_add_u32 s77, s96, 0
    buffer_store_dwordx4 v[108:111], v56, s[8:11], s77 offen sc1
    v_mfma_f32_16x16x32_bf16 v[72:75], v[220:223], a[172:175], v[72:75]
    v_mfma_f32_16x16x32_bf16 v[68:71], v[220:223], a[108:111], v[68:71]
    v_mfma_f32_16x16x32_bf16 v[64:67], v[220:223], a[44:47], v[64:67]
    buffer_load_dwordx4 v[220:223], v8, s[8:11], s76 offen offset:3072 sc1
    s_waitcnt vmcnt(16)
    v_mfma_f32_16x16x32_bf16 v[76:79], v[224:227], a[240:243], v[76:79]
    v_mfma_f32_16x16x32_bf16 v[72:75], v[224:227], a[176:179], v[72:75]
    v_mfma_f32_16x16x32_bf16 v[68:71], v[224:227], a[112:115], v[68:71]
    v_mfma_f32_16x16x32_bf16 v[64:67], v[224:227], a[48:51], v[64:67]
    s_add_u32 s76, s87, 208896
    buffer_load_dwordx4 v[224:227], v8, s[8:11], s76 offen offset:0 sc1
    s_waitcnt vmcnt(16)
    v_mfma_f32_16x16x32_bf16 v[76:79], v[228:231], a[244:247], v[76:79]
    v_mfma_f32_16x16x32_bf16 v[72:75], v[228:231], a[180:183], v[72:75]
    v_mfma_f32_16x16x32_bf16 v[68:71], v[228:231], a[116:119], v[68:71]
    v_mfma_f32_16x16x32_bf16 v[64:67], v[228:231], a[52:55], v[64:67]
    buffer_load_dwordx4 v[228:231], v8, s[8:11], s76 offen offset:1024 sc1
    s_waitcnt vmcnt(16)
    v_mfma_f32_16x16x32_bf16 v[76:79], v[232:235], a[248:251], v[76:79]
    v_mfma_f32_16x16x32_bf16 v[72:75], v[232:235], a[184:187], v[72:75]
    v_mfma_f32_16x16x32_bf16 v[68:71], v[232:235], a[120:123], v[68:71]
    v_mfma_f32_16x16x32_bf16 v[64:67], v[232:235], a[56:59], v[64:67]
    buffer_load_dwordx4 v[232:235], v8, s[8:11], s76 offen offset:2048 sc1
    s_waitcnt vmcnt(16)
    v_mfma_f32_16x16x32_bf16 v[76:79], v[236:239], a[252:255], v[76:79]
    v_mfma_f32_16x16x32_bf16 v[72:75], v[236:239], a[188:191], v[72:75]
    v_mfma_f32_16x16x32_bf16 v[68:71], v[236:239], a[124:127], v[68:71]
    v_mfma_f32_16x16x32_bf16 v[64:67], v[236:239], a[60:63], v[64:67]
    buffer_load_dwordx4 v[236:239], v8, s[8:11], s76 offen offset:3072 sc1
    s_waitcnt vmcnt(16)
    v_mfma_f32_16x16x32_bf16 v[92:95], v[176:179], a[192:195], 0
    v_mul_f32 v112, v148, v148
    v_mul_f32 v113, v149, v149
    v_mfma_f32_16x16x32_bf16 v[88:91], v[176:179], a[128:131], 0
    v_mul_f32 v114, v150, v150
    v_mul_f32 v115, v151, v151
    v_mfma_f32_16x16x32_bf16 v[84:87], v[176:179], a[64:67], 0
    v_fma_f32 v112, v112, v16, v17
    v_fma_f32 v113, v113, v16, v17
    v_mfma_f32_16x16x32_bf16 v[80:83], v[176:179], a[0:3], v[4:7]
    s_add_u32 s76, s87, 262144
    buffer_load_dwordx4 v[176:179], v8, s[8:11], s76 offen offset:0 sc1
    s_waitcnt vmcnt(16)
    v_mfma_f32_16x16x32_bf16 v[92:95], v[180:183], a[196:199], v[92:95]
    v_fma_f32 v114, v114, v16, v17
    v_fma_f32 v115, v115, v16, v17
    v_mfma_f32_16x16x32_bf16 v[88:91], v[180:183], a[132:135], v[88:91]
    ds_write_b128 v11, v[76:79] offset:0
    v_mfma_f32_16x16x32_bf16 v[84:87], v[180:183], a[68:71], v[84:87]
    ds_write_b128 v10, v[72:75] offset:0
    v_mfma_f32_16x16x32_bf16 v[80:83], v[180:183], a[4:7], v[80:83]
    buffer_load_dwordx4 v[180:183], v8, s[8:11], s76 offen offset:1024 sc1
    s_waitcnt vmcnt(16)
    v_mfma_f32_16x16x32_bf16 v[92:95], v[184:187], a[200:203], v[92:95]
    ds_write_b128 v9, v[68:71] offset:0
    v_mfma_f32_16x16x32_bf16 v[88:91], v[184:187], a[136:139], v[88:91]
    v_mul_f32 v112, v112, v148
    v_mul_f32 v113, v113, v149
    v_mfma_f32_16x16x32_bf16 v[84:87], v[184:187], a[72:75], v[84:87]
    v_mul_f32 v114, v114, v150
    v_mul_f32 v115, v115, v151
    v_mfma_f32_16x16x32_bf16 v[80:83], v[184:187], a[8:11], v[80:83]
    buffer_load_dwordx4 v[184:187], v8, s[8:11], s76 offen offset:2048 sc1
    s_waitcnt vmcnt(16)
    v_mfma_f32_16x16x32_bf16 v[92:95], v[188:191], a[204:207], v[92:95]
    v_exp_f32 v112, v112
    v_mfma_f32_16x16x32_bf16 v[88:91], v[188:191], a[140:143], v[88:91]
    v_exp_f32 v113, v113
    v_mfma_f32_16x16x32_bf16 v[84:87], v[188:191], a[76:79], v[84:87]
    v_exp_f32 v114, v114
    v_mfma_f32_16x16x32_bf16 v[80:83], v[188:191], a[12:15], v[80:83]
    buffer_load_dwordx4 v[188:191], v8, s[8:11], s76 offen offset:3072 sc1
    s_waitcnt vmcnt(16)
    v_mfma_f32_16x16x32_bf16 v[92:95], v[192:195], a[208:211], v[92:95]
    v_exp_f32 v115, v115
    v_mfma_f32_16x16x32_bf16 v[88:91], v[192:195], a[144:147], v[88:91]
    v_fma_f32 v112, v112, v18, v18
    v_fma_f32 v113, v113, v18, v18
    v_mfma_f32_16x16x32_bf16 v[84:87], v[192:195], a[80:83], v[84:87]
    s_waitcnt lgkmcnt(0)
    s_barrier
    ds_read_b128 v[96:99], v12 offset:0
    v_mfma_f32_16x16x32_bf16 v[80:83], v[192:195], a[16:19], v[80:83]
    s_add_u32 s76, s87, 266240
    buffer_load_dwordx4 v[192:195], v8, s[8:11], s76 offen offset:0 sc1
    s_waitcnt vmcnt(16)
    v_mfma_f32_16x16x32_bf16 v[92:95], v[196:199], a[212:215], v[92:95]
    ds_read_b128 v[100:103], v12 offset:1024
    v_mfma_f32_16x16x32_bf16 v[88:91], v[196:199], a[148:151], v[88:91]
    ds_read_b128 v[104:107], v12 offset:2048
    v_mfma_f32_16x16x32_bf16 v[84:87], v[196:199], a[84:87], v[84:87]
    v_fma_f32 v114, v114, v18, v18
    v_fma_f32 v115, v115, v18, v18
    v_mfma_f32_16x16x32_bf16 v[80:83], v[196:199], a[20:23], v[80:83]
    buffer_load_dwordx4 v[196:199], v8, s[8:11], s76 offen offset:1024 sc1
    s_waitcnt vmcnt(16)
    v_mfma_f32_16x16x32_bf16 v[92:95], v[200:203], a[216:219], v[92:95]
    v_rcp_f32 v112, v112
    v_mfma_f32_16x16x32_bf16 v[88:91], v[200:203], a[152:155], v[88:91]
    v_rcp_f32 v113, v113
    v_mfma_f32_16x16x32_bf16 v[84:87], v[200:203], a[88:91], v[84:87]
    v_rcp_f32 v114, v114
    v_mfma_f32_16x16x32_bf16 v[80:83], v[200:203], a[24:27], v[80:83]
    buffer_load_dwordx4 v[200:203], v8, s[8:11], s76 offen offset:2048 sc1
    s_waitcnt vmcnt(16)
    v_mfma_f32_16x16x32_bf16 v[92:95], v[204:207], a[220:223], v[92:95]
    v_rcp_f32 v115, v115
    v_mfma_f32_16x16x32_bf16 v[88:91], v[204:207], a[156:159], v[88:91]
    v_mul_f32 v148, v148, v112
    v_mul_f32 v149, v149, v113
    v_mfma_f32_16x16x32_bf16 v[84:87], v[204:207], a[92:95], v[84:87]
    v_mul_f32 v150, v150, v114
    v_mul_f32 v151, v151, v115
    v_mfma_f32_16x16x32_bf16 v[80:83], v[204:207], a[28:31], v[80:83]
    buffer_load_dwordx4 v[204:207], v8, s[8:11], s76 offen offset:3072 sc1
    s_waitcnt vmcnt(16)
    v_mfma_f32_16x16x32_bf16 v[92:95], v[208:211], a[224:227], v[92:95]
    s_waitcnt lgkmcnt(0)
    v_add_f32 v96, v96, v100
    v_add_f32 v104, v104, v64
    v_mfma_f32_16x16x32_bf16 v[88:91], v[208:211], a[160:163], v[88:91]
    v_add_f32 v97, v97, v101
    v_add_f32 v105, v105, v65
    v_mfma_f32_16x16x32_bf16 v[84:87], v[208:211], a[96:99], v[84:87]
    v_add_f32 v98, v98, v102
    v_add_f32 v106, v106, v66
    v_mfma_f32_16x16x32_bf16 v[80:83], v[208:211], a[32:35], v[80:83]
    s_add_u32 s76, s87, 270336
    buffer_load_dwordx4 v[208:211], v8, s[8:11], s76 offen offset:0 sc1
    s_waitcnt vmcnt(16)
    v_mfma_f32_16x16x32_bf16 v[92:95], v[212:215], a[228:231], v[92:95]
    v_add_f32 v99, v99, v103
    v_add_f32 v107, v107, v67
    v_mfma_f32_16x16x32_bf16 v[88:91], v[212:215], a[164:167], v[88:91]
    v_add_f32 v96, v96, v104
    v_add_f32 v97, v97, v105
    v_mfma_f32_16x16x32_bf16 v[84:87], v[212:215], a[100:103], v[84:87]
    v_add_f32 v98, v98, v106
    v_add_f32 v99, v99, v107
    v_mfma_f32_16x16x32_bf16 v[80:83], v[212:215], a[36:39], v[80:83]
    buffer_load_dwordx4 v[212:215], v8, s[8:11], s76 offen offset:1024 sc1
    s_waitcnt vmcnt(16)
    v_mfma_f32_16x16x32_bf16 v[92:95], v[216:219], a[232:235], v[92:95]
    v_mul_f32 v96, v96, v140
    v_mul_f32 v97, v97, v141
    v_mfma_f32_16x16x32_bf16 v[88:91], v[216:219], a[168:171], v[88:91]
    v_mul_f32 v98, v98, v142
    v_mul_f32 v99, v99, v143
    v_mfma_f32_16x16x32_bf16 v[84:87], v[216:219], a[104:107], v[84:87]
    v_cvt_pk_bf16_f32 v108, v96, v97
    v_cvt_pk_bf16_f32 v109, v98, v99
    v_mfma_f32_16x16x32_bf16 v[80:83], v[216:219], a[40:43], v[80:83]
    buffer_load_dwordx4 v[216:219], v8, s[8:11], s76 offen offset:2048 sc1
    s_waitcnt vmcnt(15)
    v_mfma_f32_16x16x32_bf16 v[92:95], v[220:223], a[236:239], v[92:95]
    v_xor_b32 v22, v0, v2
    v_and_b32 v22, 7, v22
    v_mfma_f32_16x16x32_bf16 v[88:91], v[220:223], a[172:175], v[88:91]
    v_lshlrev_b32 v22, 4, v22
    v_xor_b32 v23, 64, v22
    v_mfma_f32_16x16x32_bf16 v[84:87], v[220:223], a[108:111], v[84:87]
    s_and_b32 s79, s62, 1
    s_lshl_b32 s80, s63, 2
    v_mfma_f32_16x16x32_bf16 v[80:83], v[220:223], a[44:47], v[80:83]
    buffer_load_dwordx4 v[220:223], v8, s[8:11], s76 offen offset:3072 sc1
    s_waitcnt vmcnt(15)
    v_mfma_f32_16x16x32_bf16 v[92:95], v[224:227], a[240:243], v[92:95]
    s_add_u32 s79, s79, s80
    s_lshl_b32 s79, s79, 3
    v_mfma_f32_16x16x32_bf16 v[88:91], v[224:227], a[176:179], v[88:91]
    s_add_u32 s79, s79, 1
    v_lshrrev_b32 v118, 5, v0
    v_mfma_f32_16x16x32_bf16 v[84:87], v[224:227], a[112:115], v[84:87]
    v_lshl_add_u32 v118, v118, 4, s79
    v_bfe_u32 v119, v0, 3, 2
    v_mfma_f32_16x16x32_bf16 v[80:83], v[224:227], a[48:51], v[80:83]
    s_add_u32 s76, s87, 274432
    buffer_load_dwordx4 v[224:227], v8, s[8:11], s76 offen offset:0 sc1
    s_waitcnt vmcnt(15)
    v_mfma_f32_16x16x32_bf16 v[92:95], v[228:231], a[244:247], v[92:95]
    v_add_u32 v118, v118, v119
    v_mul_u32_u24 v118, 896, v118
    v_mfma_f32_16x16x32_bf16 v[88:91], v[228:231], a[180:183], v[88:91]
    v_add_u32 v22, v22, v118
    v_add_u32 v23, v23, v118
    v_mfma_f32_16x16x32_bf16 v[84:87], v[228:231], a[116:119], v[84:87]
    v_mfma_f32_16x16x32_bf16 v[80:83], v[228:231], a[52:55], v[80:83]
    buffer_load_dwordx4 v[228:231], v8, s[8:11], s76 offen offset:1024 sc1
    s_waitcnt vmcnt(15)
    v_mfma_f32_16x16x32_bf16 v[92:95], v[232:235], a[248:251], v[92:95]
    v_mfma_f32_16x16x32_bf16 v[88:91], v[232:235], a[184:187], v[88:91]
    v_mfma_f32_16x16x32_bf16 v[84:87], v[232:235], a[120:123], v[84:87]
    v_mfma_f32_16x16x32_bf16 v[80:83], v[232:235], a[56:59], v[80:83]
    buffer_load_dwordx4 v[232:235], v8, s[8:11], s76 offen offset:2048 sc1
    s_waitcnt vmcnt(15)
    v_mfma_f32_16x16x32_bf16 v[92:95], v[236:239], a[252:255], v[92:95]
    v_mfma_f32_16x16x32_bf16 v[88:91], v[236:239], a[188:191], v[88:91]
    v_mfma_f32_16x16x32_bf16 v[84:87], v[236:239], a[124:127], v[84:87]
    v_mfma_f32_16x16x32_bf16 v[80:83], v[236:239], a[60:63], v[80:83]
    buffer_load_dwordx4 v[236:239], v8, s[8:11], s76 offen offset:3072 sc1
    s_waitcnt vmcnt(15)
    v_mfma_f32_16x16x32_bf16 v[76:79], v[176:179], a[192:195], 0
    v_mul_f32 v112, v156, v156
    v_mul_f32 v113, v157, v157
    v_mfma_f32_16x16x32_bf16 v[72:75], v[176:179], a[128:131], 0
    v_mul_f32 v114, v158, v158
    v_mul_f32 v115, v159, v159
    v_mfma_f32_16x16x32_bf16 v[68:71], v[176:179], a[64:67], 0
    v_fma_f32 v112, v112, v16, v17
    v_fma_f32 v113, v113, v16, v17
    v_mfma_f32_16x16x32_bf16 v[64:67], v[176:179], a[0:3], v[4:7]
    s_add_u32 s76, s87, 327680
    buffer_load_dwordx4 v[176:179], v8, s[8:11], s76 offen offset:0 sc1
    s_waitcnt vmcnt(15)
    v_mfma_f32_16x16x32_bf16 v[76:79], v[180:183], a[196:199], v[76:79]
    v_fma_f32 v114, v114, v16, v17
    v_fma_f32 v115, v115, v16, v17
    v_mfma_f32_16x16x32_bf16 v[72:75], v[180:183], a[132:135], v[72:75]
    ds_write_b128 v11, v[92:95] offset:12288
    v_mfma_f32_16x16x32_bf16 v[68:71], v[180:183], a[68:71], v[68:71]
    ds_write_b128 v10, v[88:91] offset:12288
    v_mfma_f32_16x16x32_bf16 v[64:67], v[180:183], a[4:7], v[64:67]
    buffer_load_dwordx4 v[180:183], v8, s[8:11], s76 offen offset:1024 sc1
    s_waitcnt vmcnt(15)
    v_mfma_f32_16x16x32_bf16 v[76:79], v[184:187], a[200:203], v[76:79]
    ds_write_b128 v9, v[84:87] offset:12288
    v_mfma_f32_16x16x32_bf16 v[72:75], v[184:187], a[136:139], v[72:75]
    v_mul_f32 v112, v112, v156
    v_mul_f32 v113, v113, v157
    v_mfma_f32_16x16x32_bf16 v[68:71], v[184:187], a[72:75], v[68:71]
    v_mul_f32 v114, v114, v158
    v_mul_f32 v115, v115, v159
    v_mfma_f32_16x16x32_bf16 v[64:67], v[184:187], a[8:11], v[64:67]
    buffer_load_dwordx4 v[184:187], v8, s[8:11], s76 offen offset:2048 sc1
    s_waitcnt vmcnt(15)
    v_mfma_f32_16x16x32_bf16 v[76:79], v[188:191], a[204:207], v[76:79]
    v_exp_f32 v112, v112
    v_mfma_f32_16x16x32_bf16 v[72:75], v[188:191], a[140:143], v[72:75]
    v_exp_f32 v113, v113
    v_mfma_f32_16x16x32_bf16 v[68:71], v[188:191], a[76:79], v[68:71]
    v_exp_f32 v114, v114
    v_mfma_f32_16x16x32_bf16 v[64:67], v[188:191], a[12:15], v[64:67]
    buffer_load_dwordx4 v[188:191], v8, s[8:11], s76 offen offset:3072 sc1
    s_waitcnt vmcnt(15)
    v_mfma_f32_16x16x32_bf16 v[76:79], v[192:195], a[208:211], v[76:79]
    v_exp_f32 v115, v115
    v_mfma_f32_16x16x32_bf16 v[72:75], v[192:195], a[144:147], v[72:75]
    v_fma_f32 v112, v112, v18, v18
    v_fma_f32 v113, v113, v18, v18
    v_mfma_f32_16x16x32_bf16 v[68:71], v[192:195], a[80:83], v[68:71]
    s_waitcnt lgkmcnt(0)
    s_barrier
    ds_read_b128 v[96:99], v12 offset:12288
    v_mfma_f32_16x16x32_bf16 v[64:67], v[192:195], a[16:19], v[64:67]
    s_add_u32 s76, s87, 331776
    buffer_load_dwordx4 v[192:195], v8, s[8:11], s76 offen offset:0 sc1
    s_waitcnt vmcnt(15)
    v_mfma_f32_16x16x32_bf16 v[76:79], v[196:199], a[212:215], v[76:79]
    ds_read_b128 v[100:103], v12 offset:13312
    v_mfma_f32_16x16x32_bf16 v[72:75], v[196:199], a[148:151], v[72:75]
    ds_read_b128 v[104:107], v12 offset:14336
    v_mfma_f32_16x16x32_bf16 v[68:71], v[196:199], a[84:87], v[68:71]
    v_fma_f32 v114, v114, v18, v18
    v_fma_f32 v115, v115, v18, v18
    v_mfma_f32_16x16x32_bf16 v[64:67], v[196:199], a[20:23], v[64:67]
    buffer_load_dwordx4 v[196:199], v8, s[8:11], s76 offen offset:1024 sc1
    s_waitcnt vmcnt(15)
    v_mfma_f32_16x16x32_bf16 v[76:79], v[200:203], a[216:219], v[76:79]
    v_rcp_f32 v112, v112
    v_mfma_f32_16x16x32_bf16 v[72:75], v[200:203], a[152:155], v[72:75]
    v_rcp_f32 v113, v113
    v_mfma_f32_16x16x32_bf16 v[68:71], v[200:203], a[88:91], v[68:71]
    v_rcp_f32 v114, v114
    v_mfma_f32_16x16x32_bf16 v[64:67], v[200:203], a[24:27], v[64:67]
    buffer_load_dwordx4 v[200:203], v8, s[8:11], s76 offen offset:2048 sc1
    s_waitcnt vmcnt(15)
    v_mfma_f32_16x16x32_bf16 v[76:79], v[204:207], a[220:223], v[76:79]
    v_rcp_f32 v115, v115
    v_mfma_f32_16x16x32_bf16 v[72:75], v[204:207], a[156:159], v[72:75]
    v_mul_f32 v156, v156, v112
    v_mul_f32 v157, v157, v113
    v_mfma_f32_16x16x32_bf16 v[68:71], v[204:207], a[92:95], v[68:71]
    v_mul_f32 v158, v158, v114
    v_mul_f32 v159, v159, v115
    v_mfma_f32_16x16x32_bf16 v[64:67], v[204:207], a[28:31], v[64:67]
    buffer_load_dwordx4 v[204:207], v8, s[8:11], s76 offen offset:3072 sc1
    s_waitcnt vmcnt(15)
    v_mfma_f32_16x16x32_bf16 v[76:79], v[208:211], a[224:227], v[76:79]
    s_waitcnt lgkmcnt(0)
    v_add_f32 v96, v96, v100
    v_add_f32 v104, v104, v80
    v_mfma_f32_16x16x32_bf16 v[72:75], v[208:211], a[160:163], v[72:75]
    v_add_f32 v97, v97, v101
    v_add_f32 v105, v105, v81
    v_mfma_f32_16x16x32_bf16 v[68:71], v[208:211], a[96:99], v[68:71]
    v_add_f32 v98, v98, v102
    v_add_f32 v106, v106, v82
    v_mfma_f32_16x16x32_bf16 v[64:67], v[208:211], a[32:35], v[64:67]
    s_add_u32 s76, s87, 335872
    buffer_load_dwordx4 v[208:211], v8, s[8:11], s76 offen offset:0 sc1
    s_waitcnt vmcnt(15)
    v_mfma_f32_16x16x32_bf16 v[76:79], v[212:215], a[228:231], v[76:79]
    v_add_f32 v99, v99, v103
    v_add_f32 v107, v107, v83
    v_mfma_f32_16x16x32_bf16 v[72:75], v[212:215], a[164:167], v[72:75]
    v_add_f32 v96, v96, v104
    v_add_f32 v97, v97, v105
    v_mfma_f32_16x16x32_bf16 v[68:71], v[212:215], a[100:103], v[68:71]
    v_add_f32 v98, v98, v106
    v_add_f32 v99, v99, v107
    v_mfma_f32_16x16x32_bf16 v[64:67], v[212:215], a[36:39], v[64:67]
    buffer_load_dwordx4 v[212:215], v8, s[8:11], s76 offen offset:1024 sc1
    s_waitcnt vmcnt(15)
    v_mfma_f32_16x16x32_bf16 v[76:79], v[216:219], a[232:235], v[76:79]
    v_mul_f32 v96, v96, v148
    v_mul_f32 v97, v97, v149
    v_mfma_f32_16x16x32_bf16 v[72:75], v[216:219], a[168:171], v[72:75]
    v_mul_f32 v98, v98, v150
    v_mul_f32 v99, v99, v151
    v_mfma_f32_16x16x32_bf16 v[68:71], v[216:219], a[104:107], v[68:71]
    v_cvt_pk_bf16_f32 v110, v96, v97
    v_cvt_pk_bf16_f32 v111, v98, v99
    v_mfma_f32_16x16x32_bf16 v[64:67], v[216:219], a[40:43], v[64:67]
    buffer_load_dwordx4 v[216:219], v8, s[8:11], s76 offen offset:2048 sc1
    s_waitcnt vmcnt(15)
    v_mfma_f32_16x16x32_bf16 v[76:79], v[220:223], a[236:239], v[76:79]
    s_add_u32 s77, s96, 16384
    buffer_store_dwordx4 v[108:111], v56, s[8:11], s77 offen sc1
    v_mfma_f32_16x16x32_bf16 v[72:75], v[220:223], a[172:175], v[72:75]
    v_add_u32 v23, 3584, v23
    v_mfma_f32_16x16x32_bf16 v[68:71], v[220:223], a[108:111], v[68:71]
    v_mfma_f32_16x16x32_bf16 v[64:67], v[220:223], a[44:47], v[64:67]
    buffer_load_dwordx4 v[220:223], v8, s[8:11], s76 offen offset:3072 sc1
    s_waitcnt vmcnt(16)
    v_mfma_f32_16x16x32_bf16 v[76:79], v[224:227], a[240:243], v[76:79]
    v_mfma_f32_16x16x32_bf16 v[72:75], v[224:227], a[176:179], v[72:75]
    v_mfma_f32_16x16x32_bf16 v[68:71], v[224:227], a[112:115], v[68:71]
    v_mfma_f32_16x16x32_bf16 v[64:67], v[224:227], a[48:51], v[64:67]
    s_add_u32 s76, s87, 339968
    buffer_load_dwordx4 v[224:227], v8, s[8:11], s76 offen offset:0 sc1
    s_waitcnt vmcnt(16)
    v_mfma_f32_16x16x32_bf16 v[76:79], v[228:231], a[244:247], v[76:79]
    v_mfma_f32_16x16x32_bf16 v[72:75], v[228:231], a[180:183], v[72:75]
    v_mfma_f32_16x16x32_bf16 v[68:71], v[228:231], a[116:119], v[68:71]
    v_mfma_f32_16x16x32_bf16 v[64:67], v[228:231], a[52:55], v[64:67]
    buffer_load_dwordx4 v[228:231], v8, s[8:11], s76 offen offset:1024 sc1
    s_waitcnt vmcnt(16)
    v_mfma_f32_16x16x32_bf16 v[76:79], v[232:235], a[248:251], v[76:79]
    v_mfma_f32_16x16x32_bf16 v[72:75], v[232:235], a[184:187], v[72:75]
    v_mfma_f32_16x16x32_bf16 v[68:71], v[232:235], a[120:123], v[68:71]
    v_mfma_f32_16x16x32_bf16 v[64:67], v[232:235], a[56:59], v[64:67]
    buffer_load_dwordx4 v[232:235], v8, s[8:11], s76 offen offset:2048 sc1
    s_waitcnt vmcnt(16)
    v_mfma_f32_16x16x32_bf16 v[76:79], v[236:239], a[252:255], v[76:79]
    v_mfma_f32_16x16x32_bf16 v[72:75], v[236:239], a[188:191], v[72:75]
    v_mfma_f32_16x16x32_bf16 v[68:71], v[236:239], a[124:127], v[68:71]
    v_mfma_f32_16x16x32_bf16 v[64:67], v[236:239], a[60:63], v[64:67]
    buffer_load_dwordx4 v[236:239], v8, s[8:11], s76 offen offset:3072 sc1
    s_waitcnt vmcnt(16)
    v_mfma_f32_16x16x32_bf16 v[92:95], v[176:179], a[192:195], 0
    v_mul_f32 v112, v164, v164
    v_mul_f32 v113, v165, v165
    v_mfma_f32_16x16x32_bf16 v[88:91], v[176:179], a[128:131], 0
    v_mul_f32 v114, v166, v166
    v_mul_f32 v115, v167, v167
    v_mfma_f32_16x16x32_bf16 v[84:87], v[176:179], a[64:67], 0
    v_fma_f32 v112, v112, v16, v17
    v_fma_f32 v113, v113, v16, v17
    v_mfma_f32_16x16x32_bf16 v[80:83], v[176:179], a[0:3], v[4:7]
    s_add_u32 s76, s87, 393216
    buffer_load_dwordx4 v[176:179], v8, s[8:11], s76 offen offset:0 sc1
    s_waitcnt vmcnt(16)
    v_mfma_f32_16x16x32_bf16 v[92:95], v[180:183], a[196:199], v[92:95]
    v_fma_f32 v114, v114, v16, v17
    v_fma_f32 v115, v115, v16, v17
    v_mfma_f32_16x16x32_bf16 v[88:91], v[180:183], a[132:135], v[88:91]
    ds_write_b128 v11, v[76:79] offset:0
    v_mfma_f32_16x16x32_bf16 v[84:87], v[180:183], a[68:71], v[84:87]
    ds_write_b128 v10, v[72:75] offset:0
    v_mfma_f32_16x16x32_bf16 v[80:83], v[180:183], a[4:7], v[80:83]
    buffer_load_dwordx4 v[180:183], v8, s[8:11], s76 offen offset:1024 sc1
    s_waitcnt vmcnt(16)
    v_mfma_f32_16x16x32_bf16 v[92:95], v[184:187], a[200:203], v[92:95]
    ds_write_b128 v9, v[68:71] offset:0
    v_mfma_f32_16x16x32_bf16 v[88:91], v[184:187], a[136:139], v[88:91]
    v_mul_f32 v112, v112, v164
    v_mul_f32 v113, v113, v165
    v_mfma_f32_16x16x32_bf16 v[84:87], v[184:187], a[72:75], v[84:87]
    v_mul_f32 v114, v114, v166
    v_mul_f32 v115, v115, v167
    v_mfma_f32_16x16x32_bf16 v[80:83], v[184:187], a[8:11], v[80:83]
    buffer_load_dwordx4 v[184:187], v8, s[8:11], s76 offen offset:2048 sc1
    s_waitcnt vmcnt(16)
    v_mfma_f32_16x16x32_bf16 v[92:95], v[188:191], a[204:207], v[92:95]
    v_exp_f32 v112, v112
    v_mfma_f32_16x16x32_bf16 v[88:91], v[188:191], a[140:143], v[88:91]
    v_exp_f32 v113, v113
    v_mfma_f32_16x16x32_bf16 v[84:87], v[188:191], a[76:79], v[84:87]
    v_exp_f32 v114, v114
    v_mfma_f32_16x16x32_bf16 v[80:83], v[188:191], a[12:15], v[80:83]
    buffer_load_dwordx4 v[188:191], v8, s[8:11], s76 offen offset:3072 sc1
    s_waitcnt vmcnt(16)
    v_mfma_f32_16x16x32_bf16 v[92:95], v[192:195], a[208:211], v[92:95]
    v_exp_f32 v115, v115
    v_mfma_f32_16x16x32_bf16 v[88:91], v[192:195], a[144:147], v[88:91]
    v_fma_f32 v112, v112, v18, v18
    v_fma_f32 v113, v113, v18, v18
    v_mfma_f32_16x16x32_bf16 v[84:87], v[192:195], a[80:83], v[84:87]
    s_waitcnt lgkmcnt(0)
    s_barrier
    ds_read_b128 v[96:99], v12 offset:0
    v_mfma_f32_16x16x32_bf16 v[80:83], v[192:195], a[16:19], v[80:83]
    s_add_u32 s76, s87, 397312
    buffer_load_dwordx4 v[192:195], v8, s[8:11], s76 offen offset:0 sc1
    s_waitcnt vmcnt(16)
    v_mfma_f32_16x16x32_bf16 v[92:95], v[196:199], a[212:215], v[92:95]
    ds_read_b128 v[100:103], v12 offset:1024
    v_mfma_f32_16x16x32_bf16 v[88:91], v[196:199], a[148:151], v[88:91]
    ds_read_b128 v[104:107], v12 offset:2048
    v_mfma_f32_16x16x32_bf16 v[84:87], v[196:199], a[84:87], v[84:87]
    v_fma_f32 v114, v114, v18, v18
    v_fma_f32 v115, v115, v18, v18
    v_mfma_f32_16x16x32_bf16 v[80:83], v[196:199], a[20:23], v[80:83]
    buffer_load_dwordx4 v[196:199], v8, s[8:11], s76 offen offset:1024 sc1
    s_waitcnt vmcnt(16)
    v_mfma_f32_16x16x32_bf16 v[92:95], v[200:203], a[216:219], v[92:95]
    v_rcp_f32 v112, v112
    v_mfma_f32_16x16x32_bf16 v[88:91], v[200:203], a[152:155], v[88:91]
    v_rcp_f32 v113, v113
    v_mfma_f32_16x16x32_bf16 v[84:87], v[200:203], a[88:91], v[84:87]
    v_rcp_f32 v114, v114
    v_mfma_f32_16x16x32_bf16 v[80:83], v[200:203], a[24:27], v[80:83]
    buffer_load_dwordx4 v[200:203], v8, s[8:11], s76 offen offset:2048 sc1
    s_waitcnt vmcnt(16)
    v_mfma_f32_16x16x32_bf16 v[92:95], v[204:207], a[220:223], v[92:95]
    v_rcp_f32 v115, v115
    v_mfma_f32_16x16x32_bf16 v[88:91], v[204:207], a[156:159], v[88:91]
    v_mul_f32 v164, v164, v112
    v_mul_f32 v165, v165, v113
    v_mfma_f32_16x16x32_bf16 v[84:87], v[204:207], a[92:95], v[84:87]
    v_mul_f32 v166, v166, v114
    v_mul_f32 v167, v167, v115
    v_mfma_f32_16x16x32_bf16 v[80:83], v[204:207], a[28:31], v[80:83]
    buffer_load_dwordx4 v[204:207], v8, s[8:11], s76 offen offset:3072 sc1
    s_waitcnt vmcnt(16)
    v_mfma_f32_16x16x32_bf16 v[92:95], v[208:211], a[224:227], v[92:95]
    s_waitcnt lgkmcnt(0)
    v_add_f32 v96, v96, v100
    v_add_f32 v104, v104, v64
    v_mfma_f32_16x16x32_bf16 v[88:91], v[208:211], a[160:163], v[88:91]
    v_add_f32 v97, v97, v101
    v_add_f32 v105, v105, v65
    v_mfma_f32_16x16x32_bf16 v[84:87], v[208:211], a[96:99], v[84:87]
    v_add_f32 v98, v98, v102
    v_add_f32 v106, v106, v66
    v_mfma_f32_16x16x32_bf16 v[80:83], v[208:211], a[32:35], v[80:83]
    s_add_u32 s76, s87, 401408
    buffer_load_dwordx4 v[208:211], v8, s[8:11], s76 offen offset:0 sc1
    s_waitcnt vmcnt(16)
    v_mfma_f32_16x16x32_bf16 v[92:95], v[212:215], a[228:231], v[92:95]
    v_add_f32 v99, v99, v103
    v_add_f32 v107, v107, v67
    v_mfma_f32_16x16x32_bf16 v[88:91], v[212:215], a[164:167], v[88:91]
    v_add_f32 v96, v96, v104
    v_add_f32 v97, v97, v105
    v_mfma_f32_16x16x32_bf16 v[84:87], v[212:215], a[100:103], v[84:87]
    v_add_f32 v98, v98, v106
    v_add_f32 v99, v99, v107
    v_mfma_f32_16x16x32_bf16 v[80:83], v[212:215], a[36:39], v[80:83]
    buffer_load_dwordx4 v[212:215], v8, s[8:11], s76 offen offset:1024 sc1
    s_waitcnt vmcnt(16)
    v_mfma_f32_16x16x32_bf16 v[92:95], v[216:219], a[232:235], v[92:95]
    v_mul_f32 v96, v96, v156
    v_mul_f32 v97, v97, v157
    v_mfma_f32_16x16x32_bf16 v[88:91], v[216:219], a[168:171], v[88:91]
    v_mul_f32 v98, v98, v158
    v_mul_f32 v99, v99, v159
    v_mfma_f32_16x16x32_bf16 v[84:87], v[216:219], a[104:107], v[84:87]
    v_cvt_pk_bf16_f32 v108, v96, v97
    v_cvt_pk_bf16_f32 v109, v98, v99
    v_mfma_f32_16x16x32_bf16 v[80:83], v[216:219], a[40:43], v[80:83]
    buffer_load_dwordx4 v[216:219], v8, s[8:11], s76 offen offset:2048 sc1
    s_waitcnt vmcnt(15)
    v_mfma_f32_16x16x32_bf16 v[92:95], v[220:223], a[236:239], v[92:95]
    v_mfma_f32_16x16x32_bf16 v[88:91], v[220:223], a[172:175], v[88:91]
    v_mfma_f32_16x16x32_bf16 v[84:87], v[220:223], a[108:111], v[84:87]
    v_mfma_f32_16x16x32_bf16 v[80:83], v[220:223], a[44:47], v[80:83]
    buffer_load_dwordx4 v[220:223], v8, s[8:11], s76 offen offset:3072 sc1
    s_waitcnt vmcnt(15)
    v_mfma_f32_16x16x32_bf16 v[92:95], v[224:227], a[240:243], v[92:95]
    v_mfma_f32_16x16x32_bf16 v[88:91], v[224:227], a[176:179], v[88:91]
    v_mfma_f32_16x16x32_bf16 v[84:87], v[224:227], a[112:115], v[84:87]
    v_mfma_f32_16x16x32_bf16 v[80:83], v[224:227], a[48:51], v[80:83]
    s_add_u32 s76, s87, 405504
    buffer_load_dwordx4 v[224:227], v8, s[8:11], s76 offen offset:0 sc1
    s_waitcnt vmcnt(15)
    v_mfma_f32_16x16x32_bf16 v[92:95], v[228:231], a[244:247], v[92:95]
    v_mfma_f32_16x16x32_bf16 v[88:91], v[228:231], a[180:183], v[88:91]
    v_mfma_f32_16x16x32_bf16 v[84:87], v[228:231], a[116:119], v[84:87]
    v_mfma_f32_16x16x32_bf16 v[80:83], v[228:231], a[52:55], v[80:83]
    buffer_load_dwordx4 v[228:231], v8, s[8:11], s76 offen offset:1024 sc1
    s_waitcnt vmcnt(15)
    v_mfma_f32_16x16x32_bf16 v[92:95], v[232:235], a[248:251], v[92:95]
    v_mfma_f32_16x16x32_bf16 v[88:91], v[232:235], a[184:187], v[88:91]
    v_mfma_f32_16x16x32_bf16 v[84:87], v[232:235], a[120:123], v[84:87]
    v_mfma_f32_16x16x32_bf16 v[80:83], v[232:235], a[56:59], v[80:83]
    buffer_load_dwordx4 v[232:235], v8, s[8:11], s76 offen offset:2048 sc1
    s_waitcnt vmcnt(15)
    v_mfma_f32_16x16x32_bf16 v[92:95], v[236:239], a[252:255], v[92:95]
    v_mfma_f32_16x16x32_bf16 v[88:91], v[236:239], a[188:191], v[88:91]
    v_mfma_f32_16x16x32_bf16 v[84:87], v[236:239], a[124:127], v[84:87]
    v_mfma_f32_16x16x32_bf16 v[80:83], v[236:239], a[60:63], v[80:83]
    buffer_load_dwordx4 v[236:239], v8, s[8:11], s76 offen offset:3072 sc1
    s_waitcnt vmcnt(15)
    v_mfma_f32_16x16x32_bf16 v[76:79], v[176:179], a[192:195], 0
    v_mul_f32 v112, v172, v172
    v_mul_f32 v113, v173, v173
    v_mfma_f32_16x16x32_bf16 v[72:75], v[176:179], a[128:131], 0
    v_mul_f32 v114, v174, v174
    v_mul_f32 v115, v175, v175
    v_mfma_f32_16x16x32_bf16 v[68:71], v[176:179], a[64:67], 0
    v_fma_f32 v112, v112, v16, v17
    v_fma_f32 v113, v113, v16, v17
    v_mfma_f32_16x16x32_bf16 v[64:67], v[176:179], a[0:3], v[4:7]
    s_waitcnt vmcnt(14)
    v_mfma_f32_16x16x32_bf16 v[76:79], v[180:183], a[196:199], v[76:79]
    v_fma_f32 v114, v114, v16, v17
    v_fma_f32 v115, v115, v16, v17
    v_mfma_f32_16x16x32_bf16 v[72:75], v[180:183], a[132:135], v[72:75]
    ds_write_b128 v11, v[92:95] offset:12288
    v_mfma_f32_16x16x32_bf16 v[68:71], v[180:183], a[68:71], v[68:71]
    ds_write_b128 v10, v[88:91] offset:12288
    v_mfma_f32_16x16x32_bf16 v[64:67], v[180:183], a[4:7], v[64:67]
    s_waitcnt vmcnt(13)
    v_mfma_f32_16x16x32_bf16 v[76:79], v[184:187], a[200:203], v[76:79]
    ds_write_b128 v9, v[84:87] offset:12288
    v_mfma_f32_16x16x32_bf16 v[72:75], v[184:187], a[136:139], v[72:75]
    v_mul_f32 v112, v112, v172
    v_mul_f32 v113, v113, v173
    v_mfma_f32_16x16x32_bf16 v[68:71], v[184:187], a[72:75], v[68:71]
    v_mul_f32 v114, v114, v174
    v_mul_f32 v115, v115, v175
    v_mfma_f32_16x16x32_bf16 v[64:67], v[184:187], a[8:11], v[64:67]
    s_waitcnt vmcnt(12)
    v_mfma_f32_16x16x32_bf16 v[76:79], v[188:191], a[204:207], v[76:79]
    v_exp_f32 v112, v112
    v_mfma_f32_16x16x32_bf16 v[72:75], v[188:191], a[140:143], v[72:75]
    v_exp_f32 v113, v113
    v_mfma_f32_16x16x32_bf16 v[68:71], v[188:191], a[76:79], v[68:71]
    v_exp_f32 v114, v114
    v_mfma_f32_16x16x32_bf16 v[64:67], v[188:191], a[12:15], v[64:67]
    s_waitcnt vmcnt(11)
    v_mfma_f32_16x16x32_bf16 v[76:79], v[192:195], a[208:211], v[76:79]
    v_exp_f32 v115, v115
    v_mfma_f32_16x16x32_bf16 v[72:75], v[192:195], a[144:147], v[72:75]
    v_fma_f32 v112, v112, v18, v18
    v_fma_f32 v113, v113, v18, v18
    v_mfma_f32_16x16x32_bf16 v[68:71], v[192:195], a[80:83], v[68:71]
    s_waitcnt lgkmcnt(0)
    s_barrier
    ds_read_b128 v[96:99], v12 offset:12288
    v_mfma_f32_16x16x32_bf16 v[64:67], v[192:195], a[16:19], v[64:67]
    s_add_u32 s78, s88, 0
    buffer_load_dwordx4 v[176:179], v56, s[8:11], s78 offen offset:0 sc1
    s_waitcnt vmcnt(11)
    v_mfma_f32_16x16x32_bf16 v[76:79], v[196:199], a[212:215], v[76:79]
    ds_read_b128 v[100:103], v12 offset:13312
    v_mfma_f32_16x16x32_bf16 v[72:75], v[196:199], a[148:151], v[72:75]
    ds_read_b128 v[104:107], v12 offset:14336
    v_mfma_f32_16x16x32_bf16 v[68:71], v[196:199], a[84:87], v[68:71]
    v_fma_f32 v114, v114, v18, v18
    v_fma_f32 v115, v115, v18, v18
    v_mfma_f32_16x16x32_bf16 v[64:67], v[196:199], a[20:23], v[64:67]
    buffer_load_dwordx4 v[180:183], v56, s[8:11], s78 offen offset:1024 sc1
    s_waitcnt vmcnt(11)
    v_mfma_f32_16x16x32_bf16 v[76:79], v[200:203], a[216:219], v[76:79]
    v_rcp_f32 v112, v112
    v_mfma_f32_16x16x32_bf16 v[72:75], v[200:203], a[152:155], v[72:75]
    v_rcp_f32 v113, v113
    v_mfma_f32_16x16x32_bf16 v[68:71], v[200:203], a[88:91], v[68:71]
    v_rcp_f32 v114, v114
    v_mfma_f32_16x16x32_bf16 v[64:67], v[200:203], a[24:27], v[64:67]
    buffer_load_dwordx4 v[184:187], v56, s[8:11], s78 offen offset:2048 sc1
    s_waitcnt vmcnt(11)
    v_mfma_f32_16x16x32_bf16 v[76:79], v[204:207], a[220:223], v[76:79]
    v_rcp_f32 v115, v115
    v_mfma_f32_16x16x32_bf16 v[72:75], v[204:207], a[156:159], v[72:75]
    v_mul_f32 v172, v172, v112
    v_mul_f32 v173, v173, v113
    v_mfma_f32_16x16x32_bf16 v[68:71], v[204:207], a[92:95], v[68:71]
    v_mul_f32 v174, v174, v114
    v_mul_f32 v175, v175, v115
    v_mfma_f32_16x16x32_bf16 v[64:67], v[204:207], a[28:31], v[64:67]
    buffer_load_dwordx4 v[188:191], v56, s[8:11], s78 offen offset:3072 sc1
    s_waitcnt vmcnt(11)
    v_mfma_f32_16x16x32_bf16 v[76:79], v[208:211], a[224:227], v[76:79]
    s_waitcnt lgkmcnt(0)
    v_add_f32 v96, v96, v100
    v_add_f32 v104, v104, v80
    v_mfma_f32_16x16x32_bf16 v[72:75], v[208:211], a[160:163], v[72:75]
    v_add_f32 v97, v97, v101
    v_add_f32 v105, v105, v81
    v_mfma_f32_16x16x32_bf16 v[68:71], v[208:211], a[96:99], v[68:71]
    v_add_f32 v98, v98, v102
    v_add_f32 v106, v106, v82
    v_mfma_f32_16x16x32_bf16 v[64:67], v[208:211], a[32:35], v[64:67]
    s_add_u32 s78, s88, 4096
    buffer_load_dwordx4 v[192:195], v56, s[8:11], s78 offen offset:0 sc1
    s_waitcnt vmcnt(11)
    v_mfma_f32_16x16x32_bf16 v[76:79], v[212:215], a[228:231], v[76:79]
    v_add_f32 v99, v99, v103
    v_add_f32 v107, v107, v83
    v_mfma_f32_16x16x32_bf16 v[72:75], v[212:215], a[164:167], v[72:75]
    v_add_f32 v96, v96, v104
    v_add_f32 v97, v97, v105
    v_mfma_f32_16x16x32_bf16 v[68:71], v[212:215], a[100:103], v[68:71]
    v_add_f32 v98, v98, v106
    v_add_f32 v99, v99, v107
    v_mfma_f32_16x16x32_bf16 v[64:67], v[212:215], a[36:39], v[64:67]
    buffer_load_dwordx4 v[196:199], v56, s[8:11], s78 offen offset:1024 sc1
    s_waitcnt vmcnt(11)
    v_mfma_f32_16x16x32_bf16 v[76:79], v[216:219], a[232:235], v[76:79]
    v_mul_f32 v96, v96, v164
    v_mul_f32 v97, v97, v165
    v_mfma_f32_16x16x32_bf16 v[72:75], v[216:219], a[168:171], v[72:75]
    v_mul_f32 v98, v98, v166
    v_mul_f32 v99, v99, v167
    v_mfma_f32_16x16x32_bf16 v[68:71], v[216:219], a[104:107], v[68:71]
    v_cvt_pk_bf16_f32 v110, v96, v97
    v_cvt_pk_bf16_f32 v111, v98, v99
    v_mfma_f32_16x16x32_bf16 v[64:67], v[216:219], a[40:43], v[64:67]
    buffer_load_dwordx4 v[200:203], v56, s[8:11], s78 offen offset:2048 sc1
    s_waitcnt vmcnt(11)
    v_mfma_f32_16x16x32_bf16 v[76:79], v[220:223], a[236:239], v[76:79]
    s_add_u32 s77, s96, 32768
    buffer_store_dwordx4 v[108:111], v56, s[8:11], s77 offen sc1
    v_mfma_f32_16x16x32_bf16 v[72:75], v[220:223], a[172:175], v[72:75]
    v_mfma_f32_16x16x32_bf16 v[68:71], v[220:223], a[108:111], v[68:71]
    v_mfma_f32_16x16x32_bf16 v[64:67], v[220:223], a[44:47], v[64:67]
    buffer_load_dwordx4 v[204:207], v56, s[8:11], s78 offen offset:3072 sc1
    s_waitcnt vmcnt(12)
    v_mfma_f32_16x16x32_bf16 v[76:79], v[224:227], a[240:243], v[76:79]
    v_mfma_f32_16x16x32_bf16 v[72:75], v[224:227], a[176:179], v[72:75]
    v_mfma_f32_16x16x32_bf16 v[68:71], v[224:227], a[112:115], v[68:71]
    v_mfma_f32_16x16x32_bf16 v[64:67], v[224:227], a[48:51], v[64:67]
    s_add_u32 s78, s88, 16384
    buffer_load_dwordx4 v[208:211], v56, s[8:11], s78 offen offset:0 sc1
    s_waitcnt vmcnt(12)
    v_mfma_f32_16x16x32_bf16 v[76:79], v[228:231], a[244:247], v[76:79]
    v_mfma_f32_16x16x32_bf16 v[72:75], v[228:231], a[180:183], v[72:75]
    v_mfma_f32_16x16x32_bf16 v[68:71], v[228:231], a[116:119], v[68:71]
    v_mfma_f32_16x16x32_bf16 v[64:67], v[228:231], a[52:55], v[64:67]
    buffer_load_dwordx4 v[212:215], v56, s[8:11], s78 offen offset:1024 sc1
    s_waitcnt vmcnt(12)
    v_mfma_f32_16x16x32_bf16 v[76:79], v[232:235], a[248:251], v[76:79]
    v_mfma_f32_16x16x32_bf16 v[72:75], v[232:235], a[184:187], v[72:75]
    v_mfma_f32_16x16x32_bf16 v[68:71], v[232:235], a[120:123], v[68:71]
    v_mfma_f32_16x16x32_bf16 v[64:67], v[232:235], a[56:59], v[64:67]
    buffer_load_dwordx4 v[216:219], v56, s[8:11], s78 offen offset:2048 sc1
    s_waitcnt vmcnt(12)
    v_mfma_f32_16x16x32_bf16 v[76:79], v[236:239], a[252:255], v[76:79]
    v_mfma_f32_16x16x32_bf16 v[72:75], v[236:239], a[188:191], v[72:75]
    v_mfma_f32_16x16x32_bf16 v[68:71], v[236:239], a[124:127], v[68:71]
    v_mfma_f32_16x16x32_bf16 v[64:67], v[236:239], a[60:63], v[64:67]
    buffer_load_dwordx4 v[220:223], v56, s[8:11], s78 offen offset:3072 sc1
    s_mov_b32 s98, 0
    v_add_u32 v14, 49152, v56
    s_nop 1
    ds_write_b128 v11, v[76:79] offset:0
    ds_write_b128 v10, v[72:75] offset:0
    ds_write_b128 v9, v[68:71] offset:0
    s_waitcnt lgkmcnt(0)
    s_barrier
    ds_read_b128 v[96:99], v12 offset:0
    ds_read_b128 v[100:103], v12 offset:1024
    ds_read_b128 v[104:107], v12 offset:2048
    ds_read_b128 v[112:115], v14 offset:0
    ds_read_b128 v[116:119], v14 offset:1024
    ds_read_b128 v[120:123], v14 offset:2048
    ds_read_b128 v[124:127], v14 offset:3072
    ds_read_b128 v[128:131], v14 offset:4096
    ds_read_b128 v[132:135], v14 offset:5120
    ds_read_b128 v[136:139], v14 offset:6144
    ds_read_b128 v[140:143], v14 offset:7168
    ds_read_b128 v[144:147], v14 offset:8192
    s_waitcnt lgkmcnt(9)
    v_add_f32 v96, v96, v100
    v_add_f32 v104, v104, v64
    v_add_f32 v97, v97, v101
    v_add_f32 v105, v105, v65
    v_add_f32 v98, v98, v102
    v_add_f32 v106, v106, v66
    v_add_f32 v99, v99, v103
    v_add_f32 v107, v107, v67
    v_add_f32 v96, v96, v104
    v_add_f32 v97, v97, v105
    v_add_f32 v98, v98, v106
    v_add_f32 v99, v99, v107
    v_mul_f32 v96, v96, v172
    v_mul_f32 v97, v97, v173
    v_mul_f32 v98, v98, v174
    v_mul_f32 v99, v99, v175
    v_cvt_pk_bf16_f32 v108, v96, v97
    v_cvt_pk_bf16_f32 v109, v98, v99
    buffer_store_dwordx2 v[108:109], v58, s[8:11], s97 offen sc1
    s_cmp_eq_u32 s63, 7
    s_cbranch_scc1 k4_join
    s_waitcnt vmcnt(10)
    v_max3_u32 v15, v176, v178, v180
    v_max3_u32 v15, v15, v182, v184
    v_max3_u32 v15, v15, v186, v188
    v_max_u32 v15, v15, v190
    v_cmp_eq_u32 vcc, -1, v15
    s_cbranch_vccnz k4_retry0
k4_back0:
    s_waitcnt lgkmcnt(5)
    v_mfma_f32_16x16x32_bf16 v[240:243], v[112:115], v[176:179], v[240:243]
    ds_read_b128 v[148:151], v14 offset:9216
    ds_read_b128 v[112:115], v14 offset:10240
    s_add_u32 s78, s88, 20480
    v_mfma_f32_16x16x32_bf16 v[244:247], v[116:119], v[176:179], v[244:247]
    ds_read_b128 v[116:119], v14 offset:11264
    buffer_load_dwordx4 v[224:227], v56, s[8:11], s78 offen offset:0 sc1
    v_mfma_f32_16x16x32_bf16 v[248:251], v[120:123], v[176:179], v[248:251]
    ds_read_b128 v[120:123], v14 offset:12288
    buffer_load_dwordx4 v[228:231], v56, s[8:11], s78 offen offset:1024 sc1
    v_mfma_f32_16x16x32_bf16 v[252:255], v[124:127], v[176:179], v[252:255]
    ds_read_b128 v[124:127], v14 offset:13312
    buffer_load_dwordx4 v[232:235], v56, s[8:11], s78 offen offset:2048 sc1
    s_waitcnt lgkmcnt(6)
    v_mfma_f32_16x16x32_bf16 v[240:243], v[128:131], v[180:183], v[240:243]
    ds_read_b128 v[128:131], v14 offset:14336
    v_mfma_f32_16x16x32_bf16 v[244:247], v[132:135], v[180:183], v[244:247]
    ds_read_b128 v[132:135], v14 offset:15360
    buffer_load_dwordx4 v[236:239], v56, s[8:11], s78 offen offset:3072 sc1
    v_mfma_f32_16x16x32_bf16 v[248:251], v[136:139], v[180:183], v[248:251]
    ds_read_b128 v[136:139], v14 offset:16384
    v_mfma_f32_16x16x32_bf16 v[252:255], v[140:143], v[180:183], v[252:255]
    ds_read_b128 v[140:143], v14 offset:17408
    s_add_u32 s78, s88, 32768
    s_waitcnt lgkmcnt(7)
    v_mfma_f32_16x16x32_bf16 v[240:243], v[144:147], v[184:187], v[240:243]
    ds_read_b128 v[144:147], v14 offset:18432
    buffer_load_dwordx4 v[80:83], v56, s[8:11], s78 offen offset:0 sc1
    v_mfma_f32_16x16x32_bf16 v[244:247], v[148:151], v[184:187], v[244:247]
    ds_read_b128 v[148:151], v14 offset:19456
    s_waitcnt vmcnt(13)
    v_max3_u32 v15, v192, v194, v196
    v_mfma_f32_16x16x32_bf16 v[248:251], v[112:115], v[184:187], v[248:251]
    ds_read_b128 v[112:115], v14 offset:20480
    buffer_load_dwordx4 v[84:87], v56, s[8:11], s78 offen offset:1024 sc1
    s_waitcnt lgkmcnt(7)
    v_mfma_f32_16x16x32_bf16 v[252:255], v[116:119], v[184:187], v[252:255]
    ds_read_b128 v[116:119], v14 offset:21504
    s_waitcnt vmcnt(11)
    v_max3_u32 v15, v15, v198, v200
    v_mfma_f32_16x16x32_bf16 v[240:243], v[120:123], v[188:191], v[240:243]
    ds_read_b128 v[120:123], v14 offset:22528
    v_max3_u32 v15, v15, v202, v204
    v_mfma_f32_16x16x32_bf16 v[244:247], v[124:127], v[188:191], v[244:247]
    ds_read_b128 v[124:127], v14 offset:23552
    buffer_load_dwordx4 v[88:91], v56, s[8:11], s78 offen offset:2048 sc1
    s_waitcnt lgkmcnt(7)
    v_mfma_f32_16x16x32_bf16 v[248:251], v[128:131], v[188:191], v[248:251]
    ds_read_b128 v[128:131], v14 offset:24576
    v_max_u32 v15, v15, v206
    v_mfma_f32_16x16x32_bf16 v[252:255], v[132:135], v[188:191], v[252:255]
    ds_read_b128 v[132:135], v14 offset:25600
    v_cmp_eq_u32 vcc, -1, v15
    s_cbranch_vccnz k4_retry1
k4_back1:
    v_mfma_f32_16x16x32_bf16 v[240:243], v[136:139], v[192:195], v[240:243]
    ds_read_b128 v[136:139], v14 offset:26624
    buffer_load_dwordx4 v[92:95], v56, s[8:11], s78 offen offset:3072 sc1
    s_waitcnt lgkmcnt(7)
    v_mfma_f32_16x16x32_bf16 v[244:247], v[140:143], v[192:195], v[244:247]
    ds_read_b128 v[140:143], v14 offset:27648
    s_add_u32 s78, s88, 36864
    v_mfma_f32_16x16x32_bf16 v[248:251], v[144:147], v[192:195], v[248:251]
    ds_read_b128 v[144:147], v14 offset:28672
    buffer_load_dwordx4 v[152:155], v56, s[8:11], s78 offen offset:0 sc1
    v_mfma_f32_16x16x32_bf16 v[252:255], v[148:151], v[192:195], v[252:255]
    ds_read_b128 v[148:151], v14 offset:29696
    buffer_load_dwordx4 v[156:159], v56, s[8:11], s78 offen offset:1024 sc1
    s_waitcnt lgkmcnt(7)
    v_mfma_f32_16x16x32_bf16 v[240:243], v[112:115], v[196:199], v[240:243]
    ds_read_b128 v[112:115], v14 offset:30720
    buffer_load_dwordx4 v[160:163], v56, s[8:11], s78 offen offset:2048 sc1
    v_mfma_f32_16x16x32_bf16 v[244:247], v[116:119], v[196:199], v[244:247]
    ds_read_b128 v[116:119], v14 offset:31744
    buffer_load_dwordx4 v[164:167], v56, s[8:11], s78 offen offset:3072 sc1
    v_mfma_f32_16x16x32_bf16 v[248:251], v[120:123], v[196:199], v[248:251]
    ds_read_b128 v[120:123], v14 offset:32768
    s_waitcnt lgkmcnt(7)
    v_mfma_f32_16x16x32_bf16 v[252:255], v[124:127], v[196:199], v[252:255]
    ds_read_b128 v[124:127], v14 offset:33792
    v_mfma_f32_16x16x32_bf16 v[240:243], v[128:131], v[200:203], v[240:243]
    ds_read_b128 v[128:131], v14 offset:34816
    s_waitcnt vmcnt(15)
    v_max3_u32 v15, v208, v210, v212
    v_mfma_f32_16x16x32_bf16 v[244:247], v[132:135], v[200:203], v[244:247]
    ds_read_b128 v[132:135], v14 offset:35840
    s_waitcnt vmcnt(13)
    v_max3_u32 v15, v15, v214, v216
    s_waitcnt lgkmcnt(7)
    v_mfma_f32_16x16x32_bf16 v[248:251], v[136:139], v[200:203], v[248:251]
    ds_read_b128 v[136:139], v14 offset:36864
    v_max3_u32 v15, v15, v218, v220
    v_mfma_f32_16x16x32_bf16 v[252:255], v[140:143], v[200:203], v[252:255]
    ds_read_b128 v[140:143], v14 offset:37888
    v_max_u32 v15, v15, v222
    v_mfma_f32_16x16x32_bf16 v[240:243], v[144:147], v[204:207], v[240:243]
    ds_read_b128 v[144:147], v14 offset:38912
    v_cmp_eq_u32 vcc, -1, v15
    s_waitcnt lgkmcnt(7)
    v_mfma_f32_16x16x32_bf16 v[244:247], v[148:151], v[204:207], v[244:247]
    ds_read_b128 v[148:151], v14 offset:39936
    v_mfma_f32_16x16x32_bf16 v[248:251], v[112:115], v[204:207], v[248:251]
    ds_read_b128 v[112:115], v14 offset:40960
    v_mfma_f32_16x16x32_bf16 v[252:255], v[116:119], v[204:207], v[252:255]
    ds_read_b128 v[116:119], v14 offset:41984
    s_cbranch_vccnz k4_retry2
k4_back2:
    s_waitcnt lgkmcnt(7)
    v_mfma_f32_16x16x32_bf16 v[240:243], v[120:123], v[208:211], v[240:243]
    ds_read_b128 v[120:123], v14 offset:43008
    v_mfma_f32_16x16x32_bf16 v[244:247], v[124:127], v[208:211], v[244:247]
    ds_read_b128 v[124:127], v14 offset:44032
    v_mfma_f32_16x16x32_bf16 v[248:251], v[128:131], v[208:211], v[248:251]
    ds_read_b128 v[128:131], v14 offset:45056
    s_waitcnt lgkmcnt(7)
    v_mfma_f32_16x16x32_bf16 v[252:255], v[132:135], v[208:211], v[252:255]
    ds_read_b128 v[132:135], v14 offset:46080
    v_mfma_f32_16x16x32_bf16 v[240:243], v[136:139], v[212:215], v[240:243]
    ds_read_b128 v[136:139], v14 offset:47104
    v_mfma_f32_16x16x32_bf16 v[244:247], v[140:143], v[212:215], v[244:247]
    ds_read_b128 v[140:143], v14 offset:48128
    s_waitcnt lgkmcnt(7)
    v_mfma_f32_16x16x32_bf16 v[248:251], v[144:147], v[212:215], v[248:251]
    ds_read_b128 v[144:147], v14 offset:49152
    v_mfma_f32_16x16x32_bf16 v[252:255], v[148:151], v[212:215], v[252:255]
    ds_read_b128 v[148:151], v14 offset:50176
    v_mfma_f32_16x16x32_bf16 v[240:243], v[112:115], v[216:219], v[240:243]
    ds_read_b128 v[112:115], v14 offset:51200
    s_waitcnt vmcnt(10)
    v_max3_u32 v15, v224, v226, v228
    s_waitcnt lgkmcnt(7)
    v_mfma_f32_16x16x32_bf16 v[244:247], v[116:119], v[216:219], v[244:247]
    ds_read_b128 v[116:119], v14 offset:52224
    s_waitcnt vmcnt(8)
    v_max3_u32 v15, v15, v230, v232
    v_mfma_f32_16x16x32_bf16 v[248:251], v[120:123], v[216:219], v[248:251]
    ds_read_b128 v[120:123], v14 offset:53248
    v_max3_u32 v15, v15, v234, v236
    v_mfma_f32_16x16x32_bf16 v[252:255], v[124:127], v[216:219], v[252:255]
    ds_read_b128 v[124:127], v14 offset:54272
    v_max_u32 v15, v15, v238
    s_waitcnt lgkmcnt(7)
    v_mfma_f32_16x16x32_bf16 v[240:243], v[128:131], v[220:223], v[240:243]
    ds_read_b128 v[128:131], v14 offset:55296
    v_cmp_eq_u32 vcc, -1, v15
    v_mfma_f32_16x16x32_bf16 v[244:247], v[132:135], v[220:223], v[244:247]
    ds_read_b128 v[132:135], v14 offset:56320
    v_mfma_f32_16x16x32_bf16 v[248:251], v[136:139], v[220:223], v[248:251]
    ds_read_b128 v[136:139], v13 offset:0
    s_waitcnt lgkmcnt(7)
    v_mfma_f32_16x16x32_bf16 v[252:255], v[140:143], v[220:223], v[252:255]
    ds_read_b128 v[140:143], v13 offset:1024
    s_cbranch_vccnz k4_retry3
k4_back3:
    v_mfma_f32_16x16x32_bf16 v[240:243], v[144:147], v[224:227], v[240:243]
    ds_read_b128 v[144:147], v13 offset:2048
    v_mfma_f32_16x16x32_bf16 v[244:247], v[148:151], v[224:227], v[244:247]
    ds_read_b128 v[148:151], v13 offset:3072
    s_waitcnt lgkmcnt(7)
    v_mfma_f32_16x16x32_bf16 v[248:251], v[112:115], v[224:227], v[248:251]
    ds_read_b128 v[112:115], v13 offset:4096
    v_mfma_f32_16x16x32_bf16 v[252:255], v[116:119], v[224:227], v[252:255]
    ds_read_b128 v[116:119], v13 offset:5120
    v_mfma_f32_16x16x32_bf16 v[240:243], v[120:123], v[228:231], v[240:243]
    ds_read_b128 v[120:123], v13 offset:6144
    s_waitcnt lgkmcnt(7)
    v_mfma_f32_16x16x32_bf16 v[244:247], v[124:127], v[228:231], v[244:247]
    ds_read_b128 v[124:127], v13 offset:7168
    v_mfma_f32_16x16x32_bf16 v[248:251], v[128:131], v[228:231], v[248:251]
    ds_read_b128 v[128:131], v13 offset:8192
    v_mfma_f32_16x16x32_bf16 v[252:255], v[132:135], v[228:231], v[252:255]
    ds_read_b128 v[132:135], v13 offset:9216
    s_waitcnt lgkmcnt(7)
    v_mfma_f32_16x16x32_bf16 v[240:243], v[136:139], v[232:235], v[240:243]
    ds_read_b128 v[136:139], v13 offset:10240
    s_waitcnt vmcnt(6)
    v_max3_u32 v15, v80, v82, v84
    v_mfma_f32_16x16x32_bf16 v[244:247], v[140:143], v[232:235], v[244:247]
    ds_read_b128 v[140:143], v13 offset:11264
    s_waitcnt vmcnt(4)
    v_max3_u32 v15, v15, v86, v88
    v_mfma_f32_16x16x32_bf16 v[248:251], v[144:147], v[232:235], v[248:251]
    ds_read_b128 v[144:147], v13 offset:12288
    s_add_u32 s78, s88, 49152
    s_waitcnt lgkmcnt(7)
    v_mfma_f32_16x16x32_bf16 v[252:255], v[148:151], v[232:235], v[252:255]
    ds_read_b128 v[148:151], v13 offset:13312
    buffer_load_dwordx2 v[64:65], v58, s[8:11], s78 offen offset:0 sc1
    v_mfma_f32_16x16x32_bf16 v[240:243], v[112:115], v[236:239], v[240:243]
    ds_read_b128 v[112:115], v13 offset:14336
    buffer_load_dwordx2 v[66:67], v58, s[8:11], s78 offen offset:512 sc1
    v_mfma_f32_16x16x32_bf16 v[244:247], v[116:119], v[236:239], v[244:247]
    ds_read_b128 v[116:119], v13 offset:15360
    v_max3_u32 v15, v15, v90, v92
    s_waitcnt lgkmcnt(7)
    v_mfma_f32_16x16x32_bf16 v[248:251], v[120:123], v[236:239], v[248:251]
    ds_read_b128 v[120:123], v13 offset:16384
    v_max_u32 v15, v15, v94
    v_mfma_f32_16x16x32_bf16 v[252:255], v[124:127], v[236:239], v[252:255]
    ds_read_b128 v[124:127], v13 offset:17408
    v_cmp_eq_u32 vcc, -1, v15
    s_cbranch_vccnz k4_retry4
k4_back4:
    v_mfma_f32_16x16x32_bf16 v[240:243], v[128:131], v[80:83], v[240:243]
    ds_read_b128 v[128:131], v13 offset:18432
    buffer_load_dwordx2 v[68:69], v58, s[8:11], s78 offen offset:1024 sc1
    s_waitcnt lgkmcnt(7)
    v_mfma_f32_16x16x32_bf16 v[244:247], v[132:135], v[80:83], v[244:247]
    ds_read_b128 v[132:135], v13 offset:19456
    buffer_load_dwordx2 v[70:71], v58, s[8:11], s78 offen offset:1536 sc1
    v_mfma_f32_16x16x32_bf16 v[248:251], v[136:139], v[80:83], v[248:251]
    ds_read_b128 v[136:139], v13 offset:20480
    buffer_load_dwordx2 v[72:73], v58, s[8:11], s78 offen offset:2048 sc1
    v_mfma_f32_16x16x32_bf16 v[252:255], v[140:143], v[80:83], v[252:255]
    ds_read_b128 v[140:143], v13 offset:21504
    buffer_load_dwordx2 v[74:75], v58, s[8:11], s78 offen offset:2560 sc1
    s_waitcnt lgkmcnt(7)
    v_mfma_f32_16x16x32_bf16 v[240:243], v[144:147], v[84:87], v[240:243]
    ds_read_b128 v[144:147], v13 offset:22528
    buffer_load_dwordx2 v[76:77], v58, s[8:11], s78 offen offset:3072 sc1
    v_mfma_f32_16x16x32_bf16 v[244:247], v[148:151], v[84:87], v[244:247]
    ds_read_b128 v[148:151], v13 offset:23552
    buffer_load_dwordx2 v[78:79], v58, s[8:11], s78 offen offset:3584 sc1
    v_mfma_f32_16x16x32_bf16 v[248:251], v[112:115], v[84:87], v[248:251]
    ds_read_b128 v[112:115], v13 offset:24576
    s_waitcnt lgkmcnt(7)
    v_mfma_f32_16x16x32_bf16 v[252:255], v[116:119], v[84:87], v[252:255]
    ds_read_b128 v[116:119], v13 offset:25600
    v_mfma_f32_16x16x32_bf16 v[240:243], v[120:123], v[88:91], v[240:243]
    ds_read_b128 v[120:123], v13 offset:26624
    s_waitcnt vmcnt(10)
    v_max3_u32 v15, v152, v154, v156
    v_mfma_f32_16x16x32_bf16 v[244:247], v[124:127], v[88:91], v[244:247]
    ds_read_b128 v[124:127], v13 offset:27648
    s_getpc_b64 s[32:33]
tc_here:
    s_mov_b32 s34, codeend-tc_here
    s_lshl_b32 s77, s63, 2
    s_add_u32 s77, s77, s62
    s_lshl_b32 s77, s77, 10
    s_add_u32 s77, s77, once_begin-tc_here
    v_lshlrev_b32 v171, 7, v0
    s_and_b64 exec, s[36:37], 0xff
    buffer_load_dword v171, v171, s[32:35], s77 offen
    s_mov_b64 exec, -1
    s_waitcnt lgkmcnt(7)
    v_mfma_f32_16x16x32_bf16 v[248:251], v[128:131], v[88:91], v[248:251]
    ds_read_b128 v[128:131], v13 offset:28672
    s_waitcnt vmcnt(9)
    v_max3_u32 v15, v15, v158, v160
    v_mfma_f32_16x16x32_bf16 v[252:255], v[132:135], v[88:91], v[252:255]
    ds_read_b128 v[132:135], v13 offset:29696
    v_max3_u32 v15, v15, v162, v164
    v_mfma_f32_16x16x32_bf16 v[240:243], v[136:139], v[92:95], v[240:243]
    ds_read_b128 v[136:139], v13 offset:30720
    v_max_u32 v15, v15, v166
    s_waitcnt lgkmcnt(7)
    v_mfma_f32_16x16x32_bf16 v[244:247], v[140:143], v[92:95], v[244:247]
    ds_read_b128 v[140:143], v13 offset:31744
    v_cmp_eq_u32 vcc, -1, v15
    v_mfma_f32_16x16x32_bf16 v[248:251], v[144:147], v[92:95], v[248:251]
    ds_read_b128 v[144:147], v13 offset:32768
    v_mfma_f32_16x16x32_bf16 v[252:255], v[148:151], v[92:95], v[252:255]
    ds_read_b128 v[148:151], v13 offset:33792
    s_cbranch_vccnz k4_retry5
k4_back5:
    s_waitcnt lgkmcnt(7)
    v_mfma_f32_16x16x32_bf16 v[240:243], v[112:115], v[152:155], v[240:243]
    ds_read_b128 v[112:115], v13 offset:34816
    v_mfma_f32_16x16x32_bf16 v[244:247], v[116:119], v[152:155], v[244:247]
    ds_read_b128 v[116:119], v13 offset:35840
    v_mfma_f32_16x16x32_bf16 v[248:251], v[120:123], v[152:155], v[248:251]
    ds_read_b128 v[120:123], v13 offset:36864
    s_waitcnt lgkmcnt(7)
    v_mfma_f32_16x16x32_bf16 v[252:255], v[124:127], v[152:155], v[252:255]
    ds_read_b128 v[124:127], v13 offset:37888
    v_mfma_f32_16x16x32_bf16 v[240:243], v[128:131], v[156:159], v[240:243]
    ds_read_b128 v[128:131], v13 offset:38912
    v_mfma_f32_16x16x32_bf16 v[244:247], v[132:135], v[156:159], v[244:247]
    ds_read_b128 v[132:135], v13 offset:39936
    s_waitcnt lgkmcnt(7)
    v_mfma_f32_16x16x32_bf16 v[248:251], v[136:139], v[156:159], v[248:251]
    ds_read_b128 v[136:139], v13 offset:40960
    v_mfma_f32_16x16x32_bf16 v[252:255], v[140:143], v[156:159], v[252:255]
    ds_read_b128 v[140:143], v13 offset:41984
    v_mfma_f32_16x16x32_bf16 v[240:243], v[144:147], v[160:163], v[240:243]
    ds_read_b128 v[144:147], v13 offset:43008
    s_waitcnt vmcnt(5)
    v_max3_u32 v15, v64, v66, v68
    s_waitcnt lgkmcnt(7)
    v_mfma_f32_16x16x32_bf16 v[244:247], v[148:151], v[160:163], v[244:247]
    ds_read_b128 v[148:151], v13 offset:44032
    s_waitcnt vmcnt(1)
    v_max3_u32 v15, v15, v70, v72
    v_mfma_f32_16x16x32_bf16 v[248:251], v[112:115], v[160:163], v[248:251]
    ds_read_b128 v[112:115], v13 offset:45056
    v_max3_u32 v15, v15, v74, v76
    v_mfma_f32_16x16x32_bf16 v[252:255], v[116:119], v[160:163], v[252:255]
    ds_read_b128 v[116:119], v13 offset:46080
    v_max_u32 v15, v15, v78
    s_waitcnt lgkmcnt(7)
    v_mfma_f32_16x16x32_bf16 v[240:243], v[120:123], v[164:167], v[240:243]
    ds_read_b128 v[120:123], v13 offset:47104
    v_cmp_eq_u32 vcc, -1, v15
    v_mfma_f32_16x16x32_bf16 v[244:247], v[124:127], v[164:167], v[244:247]
    ds_read_b128 v[124:127], v13 offset:48128
    v_mfma_f32_16x16x32_bf16 v[248:251], v[128:131], v[164:167], v[248:251]
    ds_read_b128 v[128:131], v13 offset:49152
    s_waitcnt lgkmcnt(7)
    v_mfma_f32_16x16x32_bf16 v[252:255], v[132:135], v[164:167], v[252:255]
    ds_read_b128 v[132:135], v13 offset:50176
    s_cbranch_vccnz k4_retry6
k4_back6:
    v_mfma_f32_16x16x32_bf16 v[240:243], v[136:139], v[64:67], v[240:243]
    ds_read_b128 v[136:139], v13 offset:51200
    v_mfma_f32_16x16x32_bf16 v[244:247], v[140:143], v[64:67], v[244:247]
    ds_read_b128 v[140:143], v13 offset:52224
    s_waitcnt lgkmcnt(7)
    v_mfma_f32_16x16x32_bf16 v[248:251], v[144:147], v[64:67], v[248:251]
    ds_read_b128 v[144:147], v13 offset:53248
    v_mfma_f32_16x16x32_bf16 v[252:255], v[148:151], v[64:67], v[252:255]
    ds_read_b128 v[148:151], v13 offset:54272
    v_mfma_f32_16x16x32_bf16 v[240:243], v[112:115], v[68:71], v[240:243]
    ds_read_b128 v[112:115], v13 offset:55296
    s_waitcnt lgkmcnt(7)
    v_mfma_f32_16x16x32_bf16 v[244:247], v[116:119], v[68:71], v[244:247]
    ds_read_b128 v[116:119], v13 offset:56320
    v_mfma_f32_16x16x32_bf16 v[248:251], v[120:123], v[68:71], v[248:251]
    v_mfma_f32_16x16x32_bf16 v[252:255], v[124:127], v[68:71], v[252:255]
    s_waitcnt lgkmcnt(5)
    v_mfma_f32_16x16x32_bf16 v[240:243], v[128:131], v[72:75], v[240:243]
    v_mfma_f32_16x16x32_bf16 v[244:247], v[132:135], v[72:75], v[244:247]
    v_mfma_f32_16x16x32_bf16 v[248:251], v[136:139], v[72:75], v[248:251]
    s_waitcnt lgkmcnt(2)
    v_mfma_f32_16x16x32_bf16 v[252:255], v[140:143], v[72:75], v[252:255]
    v_mfma_f32_16x16x32_bf16 v[240:243], v[144:147], v[76:79], v[240:243]
    v_mfma_f32_16x16x32_bf16 v[244:247], v[148:151], v[76:79], v[244:247]
    s_waitcnt lgkmcnt(0)
    v_mfma_f32_16x16x32_bf16 v[248:251], v[112:115], v[76:79], v[248:251]
    v_mfma_f32_16x16x32_bf16 v[252:255], v[116:119], v[76:79], v[252:255]
    s_cmp_lg_u32 s65, 0
    s_cbranch_scc1 k4_out
    s_nop 1
    v_cvt_pk_bf16_f32 v112, v240, v241
    v_cvt_pk_bf16_f32 v113, v242, v243
    v_cvt_pk_bf16_f32 v114, v244, v245
    v_cvt_pk_bf16_f32 v115, v246, v247
    buffer_store_dwordx4 v[112:115], v56, s[8:11], s25 offen offset:0 sc1
    v_cvt_pk_bf16_f32 v116, v248, v249
    v_cvt_pk_bf16_f32 v117, v250, v251
    v_cvt_pk_bf16_f32 v118, v252, v253
    v_cvt_pk_bf16_f32 v119, v254, v255
    buffer_store_dwordx4 v[116:119], v56, s[8:11], s25 offen offset:1024 sc1
    s_branch k4_join
k4_out:
    s_nop 4
    v_cvt_pk_bf16_f32 v112, v240, v241
    v_cvt_pk_bf16_f32 v113, v242, v243
    v_cvt_pk_bf16_f32 v114, v244, v245
    v_cvt_pk_bf16_f32 v115, v246, v247
    buffer_store_dwordx4 v[112:115], v57, s[28:31], 0 offen offset:0 sc1
    v_cvt_pk_bf16_f32 v116, v248, v249
    v_cvt_pk_bf16_f32 v117, v250, v251
    v_cvt_pk_bf16_f32 v118, v252, v253
    v_cvt_pk_bf16_f32 v119, v254, v255
    buffer_store_dwordx4 v[116:119], v57, s[28:31], 0 offen offset:64 sc1
k4_join:
    s_cmp_lg_u32 s65, 0
    s_cbranch_scc1 finish
once_begin:
    s_waitcnt lgkmcnt(0)
    s_barrier
    s_mov_b32 s65, 1
    s_cmp_eq_u32 s63, 7
    s_cbranch_scc1 x_idle
    s_add_u32 m0, s92, 106496
    s_nop 0
    buffer_load_dwordx4 v22, s[12:15], 0 offen offset:0 lds
    s_add_u32 m0, s92, 107520
    s_nop 0
    buffer_load_dwordx4 v23, s[12:15], 0 offen offset:0 lds
    s_add_u32 m0, s92, 114560
    s_nop 0
    buffer_load_dwordx4 v22, s[12:15], 0 offen offset:128 lds
    s_add_u32 m0, s92, 115584
    s_nop 0
    buffer_load_dwordx4 v23, s[12:15], 0 offen offset:128 lds
    s_add_u32 m0, s92, 122624
    s_nop 0
    buffer_load_dwordx4 v22, s[12:15], 0 offen offset:256 lds
    s_add_u32 m0, s92, 123648
    s_nop 0
    buffer_load_dwordx4 v23, s[12:15], 0 offen offset:256 lds
    s_add_u32 m0, s92, 130688
    s_nop 0
    buffer_load_dwordx4 v22, s[12:15], 0 offen offset:384 lds
    s_add_u32 m0, s92, 131712
    s_nop 0
    buffer_load_dwordx4 v23, s[12:15], 0 offen offset:384 lds
    s_mov_b64 s[36:37], 0
    s_add_u32 s87, s87, 12582912
    s_add_u32 s58, s58, 12582912
    s_add_u32 s88, s88, 8388608
    s_add_u32 s96, s96, 8388608
    s_add_u32 s97, s97, 8388608
    s_add_u32 s89, s89, 8388608
    s_add_u32 s51, s51, 8388608
    s_add_u32 s49, s49, 4194304
    s_xor_b32 s49, s49, s27
    s_add_u32 m0, s92, 138752
    s_nop 0
    buffer_load_dwordx4 v22, s[12:15], 0 offen offset:512 lds
    v_lshrrev_b32 v10, 1, v1
    v_xor_b32 v10, v10, v2
    v_lshlrev_b32 v10, 4, v10
    v_lshl_add_u32 v10, v1, 7, v10
    v_add_u32 v8, s94, v10
    v_xor_b32 v9, 64, v8
    v_add_u32 v10, 106496, v10
    v_xor_b32 v11, 64, v10
    v_bfe_u32 v12, v1, 1, 2
    v_lshrrev_b32 v16, 3, v1
    v_lshlrev_b32 v16, 1, v16
    v_xor_b32 v12, v12, v16
    v_xor_b32 v12, v12, v2
    v_lshlrev_b32 v12, 4, v12
    v_lshl_add_u32 v12, v1, 6, v12
    s_add_u32 s76, s91, 98304
    v_add_u32 v12, s76, v12
    v_bfe_u32 v16, v0, 1, 1
    v_bfe_u32 v17, v0, 3, 1
    v_xor_b32 v16, v16, v17
    v_and_b32 v17, 1, v2
    v_lshl_add_u32 v16, v17, 1, v16
    v_and_b32 v17, 1, v0
    v_lshl_add_u32 v16, v16, 1, v17
    v_lshlrev_b32 v16, 3, v16
    v_bfe_u32 v17, v0, 2, 2
    v_lshl_add_u32 v17, v2, 3, v17
    v_lshl_add_u32 v13, v17, 6, v16
    v_add_u32 v13, 98304, v13
    v_xor_b32 v14, 32, v13
    s_lshr_b32 s76, s64, 1
    s_and_b32 s76, s76, 2
    v_xor_b32 v15, s76, v2
    v_and_b32 v16, 1, v1
    v_lshl_add_u32 v15, v16, 2, v15
    v_lshlrev_b32 v15, 4, v15
    v_lshrrev_b32 v16, 1, v1
    v_lshl_add_u32 v15, v16, 16, v15
    s_lshl_b32 s76, s62, 3
    v_add_u32 v16, s76, v16
    v_sub_u32 v17, 32, v16
    v_min_u32 v16, v16, v17
    v_bfe_u32 v16, v16, 1, 3
    v_bfe_u32 v16, s26, v16, 1
    v_lshl_add_u32 v15, v16, 13, v15
    v_lshlrev_b32 v167, 3, v2
    v_sub_u32 v168, v1, v167
    v_add_u32 v167, v1, v167
    v_mov_b32 v169, 0x3f80
    v_add_u32 v164, 1, v168
    v_lshlrev_b32 v165, 4, v164
    s_add_u32 m0, s92, 139776
    s_nop 0
    buffer_load_dwordx4 v23, s[12:15], 0 offen offset:512 lds
    v_lshlrev_b32 v165, v165, v169
    v_ashrrev_i32 v164, 1, v164
    v_cmp_eq_u32 s[76:77], 0, v164
    v_cmp_eq_u32 s[78:79], 1, v164
    v_cmp_eq_u32 s[80:81], 2, v164
    v_cmp_eq_u32 s[82:83], 3, v164
    v_cndmask_b32 v232, 0, v165, s[76:77]
    v_cndmask_b32 v233, 0, v165, s[78:79]
    v_cndmask_b32 v234, 0, v165, s[80:81]
    v_cndmask_b32 v235, 0, v165, s[82:83]
    v_add_u32 v164, 17, v168
    v_ashrrev_i32 v164, 1, v164
    v_cmp_eq_u32 s[76:77], 0, v164
    v_cmp_eq_u32 s[78:79], 1, v164
    v_cmp_eq_u32 s[80:81], 2, v164
    v_cmp_eq_u32 s[82:83], 3, v164
    v_cndmask_b32 v236, 0, v165, s[76:77]
    v_cndmask_b32 v237, 0, v165, s[78:79]
    v_cndmask_b32 v238, 0, v165, s[80:81]
    v_cndmask_b32 v239, 0, v165, s[82:83]
    v_add_u32 v164, -15, v168
    v_ashrrev_i32 v164, 1, v164
    v_cmp_eq_u32 s[76:77], 0, v164
    v_cmp_eq_u32 s[78:79], 1, v164
    v_cmp_eq_u32 s[80:81], 2, v164
    v_cmp_eq_u32 s[82:83], 3, v164
    v_cndmask_b32 v240, 0, v165, s[76:77]
    v_cndmask_b32 v241, 0, v165, s[78:79]
    v_cndmask_b32 v242, 0, v165, s[80:81]
    v_cndmask_b32 v243, 0, v165, s[82:83]
    v_sub_u32 v164, 15, v167
    v_ashrrev_i32 v164, 1, v164
    v_cmp_eq_u32 s[76:77], 0, v164
    v_cmp_eq_u32 s[78:79], 1, v164
    v_cmp_eq_u32 s[80:81], 2, v164
    v_cmp_eq_u32 s[82:83], 3, v164
    v_cndmask_b32 v244, 0, v165, s[76:77]
    v_cndmask_b32 v245, 0, v165, s[78:79]
    v_cndmask_b32 v246, 0, v165, s[80:81]
    v_cndmask_b32 v247, 0, v165, s[82:83]
    v_sub_u32 v164, 31, v167
    v_ashrrev_i32 v164, 1, v164
    v_cmp_eq_u32 s[76:77], 0, v164
    v_cmp_eq_u32 s[78:79], 1, v164
    v_cmp_eq_u32 s[80:81], 2, v164
    v_cmp_eq_u32 s[82:83], 3, v164
    v_cndmask_b32 v248, 0, v165, s[76:77]
    v_cndmask_b32 v249, 0, v165, s[78:79]
    v_cndmask_b32 v250, 0, v165, s[80:81]
    v_cndmask_b32 v251, 0, v165, s[82:83]
    s_add_u32 s84, s24, 0
    buffer_load_dwordx4 v[176:179], v56, s[8:11], s84 offen offset:0 sc1
    buffer_load_dwordx4 v[180:183], v56, s[8:11], s84 offen offset:1024 sc1
    buffer_load_dwordx4 v[184:187], v56, s[8:11], s84 offen offset:2048 sc1
    buffer_load_dwordx4 v[188:191], v56, s[8:11], s84 offen offset:3072 sc1
    s_add_u32 s84, s24, 4096
    buffer_load_dwordx4 v[192:195], v56, s[8:11], s84 offen offset:0 sc1
    buffer_load_dwordx4 v[196:199], v56, s[8:11], s84 offen offset:1024 sc1
    buffer_load_dwordx4 v[200:203], v56, s[8:11], s84 offen offset:2048 sc1
    buffer_load_dwordx4 v[204:207], v56, s[8:11], s84 offen offset:3072 sc1
    s_waitcnt vmcnt(8)
    s_barrier
    s_mov_b32 s98, 0
    ds_read_b128 v[64:67], v10 offset:0
    ds_read_b128 v[68:71], v10 offset:2048
    ds_read_b128 v[72:75], v10 offset:4096
    ds_read_b128 v[76:79], v10 offset:6144
    ds_read_b128 v[80:83], v11 offset:0
    ds_read_b128 v[84:87], v11 offset:2048
    ds_read_b128 v[88:91], v11 offset:4096
    ds_read_b128 v[92:95], v11 offset:6144
    ds_read_b128 v[96:99], v10 offset:8192
    ds_read_b128 v[100:103], v10 offset:10240
    s_waitcnt vmcnt(6)
    v_max3_u32 v17, v176, v178, v180
    v_max_u32 v17, v17, v182
    v_cmp_eq_u32 vcc, -1, v17
    s_cbranch_vccnz x_retry0
x_back0:
    v_mfma_f32_16x16x32_bf16 v[128:131], v[60:63], v[176:179], 0
    s_add_u32 s84, s24, 16384
    buffer_load_dwordx4 v[208:211], v56, s[8:11], s84 offen offset:0 sc1
    v_mfma_f32_16x16x32_bf16 v[132:135], v[176:179], v[176:179], 0
    v_mfma_f32_16x16x32_bf16 v[128:131], v[60:63], v[180:183], v[128:131]
    buffer_load_dwordx4 v[212:215], v56, s[8:11], s84 offen offset:1024 sc1
    v_mfma_f32_16x16x32_bf16 v[132:135], v[180:183], v[180:183], v[132:135]
    s_waitcnt lgkmcnt(8)
    v_mfma_f32_16x16x32_bf16 v[112:115], v[64:67], v[176:179], 0
    buffer_load_dwordx4 v[216:219], v56, s[8:11], s84 offen offset:2048 sc1
    v_mfma_f32_16x16x32_bf16 v[116:119], v[68:71], v[176:179], 0
    ds_read_b128 v[104:107], v10 offset:12288
    s_waitcnt lgkmcnt(7)
    v_mfma_f32_16x16x32_bf16 v[120:123], v[72:75], v[176:179], 0
    ds_read_b128 v[108:111], v10 offset:14336
    buffer_load_dwordx4 v[220:223], v56, s[8:11], s84 offen offset:3072 sc1
    v_mfma_f32_16x16x32_bf16 v[124:127], v[76:79], v[176:179], 0
    ds_read_b128 v[64:67], v11 offset:8192
    s_waitcnt lgkmcnt(7)
    v_mfma_f32_16x16x32_bf16 v[112:115], v[80:83], v[180:183], v[112:115]
    ds_read_b128 v[68:71], v11 offset:10240
    s_add_u32 s84, s24, 20480
    buffer_load_dwordx4 v[224:227], v56, s[8:11], s84 offen offset:0 sc1
    v_mfma_f32_16x16x32_bf16 v[116:119], v[84:87], v[180:183], v[116:119]
    ds_read_b128 v[72:75], v11 offset:12288
    s_waitcnt lgkmcnt(7)
    v_mfma_f32_16x16x32_bf16 v[120:123], v[88:91], v[180:183], v[120:123]
    ds_read_b128 v[76:79], v11 offset:14336
    buffer_load_dwordx4 v[228:231], v56, s[8:11], s84 offen offset:1024 sc1
    v_mfma_f32_16x16x32_bf16 v[124:127], v[92:95], v[180:183], v[124:127]
    s_waitcnt vmcnt(10)
    v_max3_u32 v17, v184, v186, v188
    v_max_u32 v17, v17, v190
    v_cmp_eq_u32 vcc, -1, v17
    s_cbranch_vccnz x_retry1
x_back1:
    v_mfma_f32_16x16x32_bf16 v[128:131], v[60:63], v[184:187], v[128:131]
    s_add_u32 m0, s92, 146816
    s_nop 0
    buffer_load_dwordx4 v22, s[12:15], 0 offen offset:640 lds
    v_mfma_f32_16x16x32_bf16 v[132:135], v[184:187], v[184:187], v[132:135]
    v_mfma_f32_16x16x32_bf16 v[128:131], v[60:63], v[188:191], v[128:131]
    s_add_u32 m0, s92, 147840
    s_nop 0
    buffer_load_dwordx4 v23, s[12:15], 0 offen offset:640 lds
    v_mfma_f32_16x16x32_bf16 v[132:135], v[188:191], v[188:191], v[132:135]
    s_waitcnt lgkmcnt(6)
    v_mfma_f32_16x16x32_bf16 v[112:115], v[96:99], v[184:187], v[112:115]
    s_add_u32 m0, s92, 154880
    s_nop 0
    buffer_load_dwordx4 v22, s[12:15], 0 offen offset:768 lds
    v_mfma_f32_16x16x32_bf16 v[116:119], v[100:103], v[184:187], v[116:119]
    s_waitcnt lgkmcnt(4)
    v_mfma_f32_16x16x32_bf16 v[120:123], v[104:107], v[184:187], v[120:123]
    s_add_u32 m0, s92, 155904
    s_nop 0
    buffer_load_dwordx4 v23, s[12:15], 0 offen offset:768 lds
    v_mfma_f32_16x16x32_bf16 v[124:127], v[108:111], v[184:187], v[124:127]
    ds_read_b128 v[80:83], v10 offset:16384
    s_waitcnt lgkmcnt(3)
    v_mfma_f32_16x16x32_bf16 v[112:115], v[64:67], v[188:191], v[112:115]
    ds_read_b128 v[84:87], v10 offset:18432
    v_mfma_f32_16x16x32_bf16 v[116:119], v[68:71], v[188:191], v[116:119]
    ds_read_b128 v[88:91], v10 offset:20480
    s_waitcnt lgkmcnt(3)
    v_mfma_f32_16x16x32_bf16 v[120:123], v[72:75], v[188:191], v[120:123]
    ds_read_b128 v[92:95], v10 offset:22528
    v_mfma_f32_16x16x32_bf16 v[124:127], v[76:79], v[188:191], v[124:127]
    ds_read_b128 v[96:99], v11 offset:16384
    s_waitcnt vmcnt(12)
    v_max3_u32 v17, v192, v194, v196
    v_max_u32 v17, v17, v198
    v_cmp_eq_u32 vcc, -1, v17
    s_cbranch_vccnz x_retry2
x_back2:
    v_mfma_f32_16x16x32_bf16 v[128:131], v[60:63], v[192:195], v[128:131]
    ds_read_b128 v[100:103], v11 offset:18432
    v_mfma_f32_16x16x32_bf16 v[132:135], v[192:195], v[192:195], v[132:135]
    ds_read_b128 v[104:107], v11 offset:20480
    v_mfma_f32_16x16x32_bf16 v[128:131], v[60:63], v[196:199], v[128:131]
    ds_read_b128 v[108:111], v11 offset:22528
    v_mfma_f32_16x16x32_bf16 v[132:135], v[196:199], v[196:199], v[132:135]
    s_waitcnt vmcnt(10)
    v_max3_u32 v17, v200, v202, v204
    v_max_u32 v17, v17, v206
    v_cmp_eq_u32 vcc, -1, v17
    s_cbranch_vccnz x_retry3
x_back3:
    v_mfma_f32_16x16x32_bf16 v[128:131], v[60:63], v[200:203], v[128:131]
    v_mfma_f32_16x16x32_bf16 v[132:135], v[200:203], v[200:203], v[132:135]
    v_mfma_f32_16x16x32_bf16 v[128:131], v[60:63], v[204:207], v[128:131]
    v_mfma_f32_16x16x32_bf16 v[132:135], v[204:207], v[204:207], v[132:135]
    ds_read_b128 v[64:67], v10 offset:24576
    s_waitcnt lgkmcnt(7)
    v_mfma_f32_16x16x32_bf16 v[112:115], v[80:83], v[192:195], v[112:115]
    ds_read_b128 v[68:71], v10 offset:26624
    v_mfma_f32_16x16x32_bf16 v[116:119], v[84:87], v[192:195], v[116:119]
    ds_read_b128 v[72:75], v10 offset:28672
    s_waitcnt lgkmcnt(7)
    v_mfma_f32_16x16x32_bf16 v[120:123], v[88:91], v[192:195], v[120:123]
    ds_read_b128 v[76:79], v10 offset:30720
    v_mfma_f32_16x16x32_bf16 v[124:127], v[92:95], v[192:195], v[124:127]
    ds_read_b128 v[80:83], v11 offset:24576
    s_waitcnt lgkmcnt(7)
    v_mfma_f32_16x16x32_bf16 v[112:115], v[96:99], v[196:199], v[112:115]
    ds_read_b128 v[84:87], v11 offset:26624
    v_mfma_f32_16x16x32_bf16 v[116:119], v[100:103], v[196:199], v[116:119]
    ds_read_b128 v[88:91], v11 offset:28672
    s_waitcnt lgkmcnt(7)
    v_mfma_f32_16x16x32_bf16 v[120:123], v[104:107], v[196:199], v[120:123]
    ds_read_b128 v[92:95], v11 offset:30720
    v_mfma_f32_16x16x32_bf16 v[124:127], v[108:111], v[196:199], v[124:127]
    s_waitcnt vmcnt(8)
    v_max3_u32 v17, v208, v210, v212
    v_max_u32 v17, v17, v214
    v_cmp_eq_u32 vcc, -1, v17
    s_cbranch_vccnz x_retry4
x_back4:
    v_mfma_f32_16x16x32_bf16 v[128:131], v[60:63], v[208:211], v[128:131]
    v_mfma_f32_16x16x32_bf16 v[132:135], v[208:211], v[208:211], v[132:135]
    v_mfma_f32_16x16x32_bf16 v[128:131], v[60:63], v[212:215], v[128:131]
    v_mfma_f32_16x16x32_bf16 v[132:135], v[212:215], v[212:215], v[132:135]
    s_waitcnt lgkmcnt(6)
    v_mfma_f32_16x16x32_bf16 v[112:115], v[64:67], v[200:203], v[112:115]
    v_mfma_f32_16x16x32_bf16 v[116:119], v[68:71], v[200:203], v[116:119]
    s_waitcnt lgkmcnt(4)
    v_mfma_f32_16x16x32_bf16 v[120:123], v[72:75], v[200:203], v[120:123]
    v_mfma_f32_16x16x32_bf16 v[124:127], v[76:79], v[200:203], v[124:127]
    ds_read_b128 v[96:99], v10 offset:32768
    s_waitcnt lgkmcnt(3)
    v_mfma_f32_16x16x32_bf16 v[112:115], v[80:83], v[204:207], v[112:115]
    ds_read_b128 v[100:103], v10 offset:34816
    v_mfma_f32_16x16x32_bf16 v[116:119], v[84:87], v[204:207], v[116:119]
    ds_read_b128 v[104:107], v10 offset:36864
    s_waitcnt lgkmcnt(3)
    v_mfma_f32_16x16x32_bf16 v[120:123], v[88:91], v[204:207], v[120:123]
    ds_read_b128 v[108:111], v10 offset:38912
    s_add_u32 m0, s0, 0
    v_mfma_f32_16x16x32_bf16 v[124:127], v[92:95], v[204:207], v[124:127]
    ds_read_b128 v[64:67], v11 offset:32768
    s_add_u32 s85, s86, 0
    s_waitcnt vmcnt(6)
    v_max3_u32 v17, v216, v218, v220
    v_max_u32 v17, v17, v222
    v_cmp_eq_u32 vcc, -1, v17
    s_cbranch_vccnz x_retry5
x_back5:
    v_mfma_f32_16x16x32_bf16 v[128:131], v[60:63], v[216:219], v[128:131]
    ds_read_b128 v[68:71], v11 offset:34816
    buffer_load_dwordx4 v56, s[8:11], s85 offen offset:0 sc1 lds
    v_mfma_f32_16x16x32_bf16 v[132:135], v[216:219], v[216:219], v[132:135]
    ds_read_b128 v[72:75], v11 offset:36864
    v_mfma_f32_16x16x32_bf16 v[128:131], v[60:63], v[220:223], v[128:131]
    ds_read_b128 v[76:79], v11 offset:38912
    buffer_load_dwordx4 v56, s[8:11], s85 offen offset:1024 sc1 lds
    v_mfma_f32_16x16x32_bf16 v[132:135], v[220:223], v[220:223], v[132:135]
    s_waitcnt vmcnt(2)
    s_barrier
    ds_read_b128 v[80:83], v10 offset:40960
    v_max3_u32 v17, v224, v226, v228
    v_max_u32 v17, v17, v230
    v_cmp_eq_u32 vcc, -1, v17
    s_cbranch_vccnz x_retry6
x_back6:
    v_mfma_f32_16x16x32_bf16 v[128:131], v[60:63], v[224:227], v[128:131]
    ds_read_b128 v[84:87], v10 offset:43008
    v_mfma_f32_16x16x32_bf16 v[132:135], v[224:227], v[224:227], v[132:135]
    ds_read_b128 v[88:91], v10 offset:45056
    v_mfma_f32_16x16x32_bf16 v[128:131], v[60:63], v[228:231], v[128:131]
    ds_read_b128 v[92:95], v10 offset:47104
    buffer_load_dwordx4 v56, s[8:11], s85 offen offset:2048 sc1 lds
    v_mfma_f32_16x16x32_bf16 v[132:135], v[228:231], v[228:231], v[132:135]
    s_waitcnt lgkmcnt(10)
    v_mfma_f32_16x16x32_bf16 v[112:115], v[96:99], v[208:211], v[112:115]
    ds_read_b128 v[96:99], v11 offset:40960
    v_mfma_f32_16x16x32_bf16 v[116:119], v[100:103], v[208:211], v[116:119]
    ds_read_b128 v[100:103], v11 offset:43008
    s_waitcnt lgkmcnt(10)
    v_mfma_f32_16x16x32_bf16 v[120:123], v[104:107], v[208:211], v[120:123]
    ds_read_b128 v[104:107], v11 offset:45056
    buffer_load_dwordx4 v56, s[8:11], s85 offen offset:3072 sc1 lds
    v_mfma_f32_16x16x32_bf16 v[124:127], v[108:111], v[208:211], v[124:127]
    ds_read_b128 v[108:111], v11 offset:47104
    v_cndmask_b32 v18, 0, v132, s[38:39]
    s_waitcnt lgkmcnt(10)
    v_mfma_f32_16x16x32_bf16 v[112:115], v[64:67], v[212:215], v[112:115]
    ds_read_b128 v[64:67], v10 offset:49152
    v_cndmask_b32 v18, v18, v133, s[40:41]
    v_mfma_f32_16x16x32_bf16 v[116:119], v[68:71], v[212:215], v[116:119]
    ds_read_b128 v[68:71], v10 offset:51200
    v_cndmask_b32 v18, v18, v134, s[42:43]
    s_waitcnt lgkmcnt(10)
    v_mfma_f32_16x16x32_bf16 v[120:123], v[72:75], v[212:215], v[120:123]
    ds_read_b128 v[72:75], v10 offset:53248
    v_cndmask_b32 v18, v18, v135, s[44:45]
    v_mfma_f32_16x16x32_bf16 v[124:127], v[76:79], v[212:215], v[124:127]
    ds_read_b128 v[76:79], v10 offset:55296
    s_add_u32 m0, s0, 16384
    s_waitcnt lgkmcnt(10)
    v_mfma_f32_16x16x32_bf16 v[112:115], v[80:83], v[216:219], v[112:115]
    ds_read_b128 v[80:83], v11 offset:49152
    s_add_u32 s85, s86, 16384
    v_mfma_f32_16x16x32_bf16 v[116:119], v[84:87], v[216:219], v[116:119]
    ds_read_b128 v[84:87], v11 offset:51200
    buffer_load_dwordx4 v56, s[8:11], s85 offen offset:0 sc1 lds
    s_waitcnt lgkmcnt(10)
    v_mfma_f32_16x16x32_bf16 v[120:123], v[88:91], v[216:219], v[120:123]
    ds_read_b128 v[88:91], v11 offset:53248
    v_mov_b32 v17, v18
    v_mfma_f32_16x16x32_bf16 v[124:127], v[92:95], v[216:219], v[124:127]
    ds_read_b128 v[92:95], v11 offset:55296
    v_permlane16_swap_b32 v18, v17
    s_waitcnt lgkmcnt(10)
    v_mfma_f32_16x16x32_bf16 v[112:115], v[96:99], v[220:223], v[112:115]
    v_add_f32 v18, v18, v17
    v_mov_b32 v17, v18
    v_mfma_f32_16x16x32_bf16 v[116:119], v[100:103], v[220:223], v[116:119]
    buffer_load_dwordx4 v56, s[8:11], s85 offen offset:1024 sc1 lds
    s_waitcnt lgkmcnt(8)
    v_mfma_f32_16x16x32_bf16 v[120:123], v[104:107], v[220:223], v[120:123]
    v_permlane32_swap_b32 v18, v17
    v_add_f32 v18, v18, v17
    v_mfma_f32_16x16x32_bf16 v[124:127], v[108:111], v[220:223], v[124:127]
    v_mul_f32 v16, 0x3b124925, v128
    s_waitcnt lgkmcnt(6)
    v_mfma_f32_16x16x32_bf16 v[112:115], v[64:67], v[224:227], v[112:115]
    v_mul_f32 v18, 0x3b124925, v18
    buffer_load_dwordx4 v56, s[8:11], s85 offen offset:2048 sc1 lds
    v_mfma_f32_16x16x32_bf16 v[116:119], v[68:71], v[224:227], v[116:119]
    v_fma_f32 v18, -v16, v16, v18
    s_waitcnt lgkmcnt(4)
    v_mfma_f32_16x16x32_bf16 v[120:123], v[72:75], v[224:227], v[120:123]
    v_max_f32 v18, 0, v18
    v_add_f32 v18, 0x3727c5ac, v18
    v_mfma_f32_16x16x32_bf16 v[124:127], v[76:79], v[224:227], v[124:127]
    v_rsq_f32 v18, v18
    s_waitcnt lgkmcnt(2)
    v_mfma_f32_16x16x32_bf16 v[112:115], v[80:83], v[228:231], v[112:115]
    buffer_load_dwordx4 v56, s[8:11], s85 offen offset:3072 sc1 lds
    v_mfma_f32_16x16x32_bf16 v[116:119], v[84:87], v[228:231], v[116:119]
    s_waitcnt lgkmcnt(0)
    v_mfma_f32_16x16x32_bf16 v[120:123], v[88:91], v[228:231], v[120:123]
    v_mfma_f32_16x16x32_bf16 v[124:127], v[92:95], v[228:231], v[124:127]
    s_branch layer
mid1:
    v_mfma_f32_16x16x32_bf16 v[16:19], v[240:243], v[176:179], 0
    s_add_u32 m0, s0, 32768
    s_add_u32 s85, s86, 32768
    v_mfma_f32_16x16x32_bf16 v[64:67], v[232:235], v[176:179], 0
    buffer_load_dwordx4 v56, s[8:11], s85 offen offset:0 sc1 lds
    v_mfma_f32_16x16x32_bf16 v[68:71], v[236:239], v[176:179], 0
    buffer_load_dwordx4 v56, s[8:11], s85 offen offset:1024 sc1 lds
    v_mfma_f32_16x16x32_bf16 v[72:75], v[232:235], v[180:183], 0
    s_nop 0
    v_mov_b32 v59, v19
    v_mfma_f32_16x16x32_bf16 v[76:79], v[236:239], v[180:183], 0
    buffer_load_dwordx4 v56, s[8:11], s85 offen offset:2048 sc1 lds
    v_mfma_f32_16x16x32_bf16 v[80:83], v[232:235], v[184:187], 0
    v_and_b32 v12, 3, v0
    v_mfma_f32_16x16x32_bf16 v[84:87], v[236:239], v[184:187], 0
    buffer_load_dwordx4 v56, s[8:11], s85 offen offset:3072 sc1 lds
    v_and_b32 v13, 1, v2
    v_mfma_f32_16x16x32_bf16 v[88:91], v[232:235], v[188:191], 0
    v_lshl_add_u32 v12, v13, 2, v12
    v_mfma_f32_16x16x32_bf16 v[92:95], v[236:239], v[188:191], 0
    s_add_u32 m0, s0, 49152
    s_add_u32 s85, s86, 49152
    v_mfma_f32_16x16x32_bf16 v[96:99], v[232:235], v[192:195], 0
    buffer_load_dwordx4 v56, s[8:11], s85 offen offset:0 sc1 lds
    v_lshlrev_b32 v12, 3, v12
    v_mfma_f32_16x16x32_bf16 v[100:103], v[236:239], v[192:195], 0
    v_bfe_u32 v13, v0, 2, 2
    buffer_load_dwordx4 v56, s[8:11], s85 offen offset:1024 sc1 lds
    v_mfma_f32_16x16x32_bf16 v[104:107], v[232:235], v[196:199], 0
    v_lshl_add_u32 v13, v2, 3, v13
    v_lshl_add_u32 v12, v13, 6, v12
    v_mfma_f32_16x16x32_bf16 v[108:111], v[236:239], v[196:199], 0
    buffer_load_dwordx4 v56, s[8:11], s85 offen offset:2048 sc1 lds
    s_cmp_ge_u32 s62, 2
    s_cselect_b32 s78, 28672, 0
    s_cselect_b32 s79, 0, 28672
    v_mfma_f32_16x16x32_bf16 v[112:115], v[232:235], v[200:203], 0
    v_add_u32 v12, 106496, v12
    v_mfma_f32_16x16x32_bf16 v[116:119], v[236:239], v[200:203], 0
    buffer_load_dwordx4 v56, s[8:11], s85 offen offset:3072 sc1 lds
    v_add_u32 v8, s78, v12
    v_mfma_f32_16x16x32_bf16 v[120:123], v[244:247], v[204:207], 0
    v_xor_b32 v9, 32, v8
    v_mfma_f32_16x16x32_bf16 v[124:127], v[248:251], v[204:207], 0
    v_add_u32 v10, s79, v12
    v_mfma_f32_16x16x32_bf16 v[128:131], v[244:247], v[208:211], 0
    v_xor_b32 v11, 32, v10
    v_mfma_f32_16x16x32_bf16 v[132:135], v[248:251], v[208:211], 0
    v_add_u32 v12, 50176, v56
    v_mfma_f32_16x16x32_bf16 v[136:139], v[244:247], v[212:215], 0
    v_add_u32 v13, 106496, v56
    v_mfma_f32_16x16x32_bf16 v[140:143], v[248:251], v[212:215], 0
    v_lshlrev_b32 v14, 4, v2
    v_mfma_f32_16x16x32_bf16 v[144:147], v[244:247], v[216:219], 0
    v_add_u32 v14, 100352, v14
    v_mfma_f32_16x16x32_bf16 v[148:151], v[248:251], v[216:219], 0
    v_add_u32 v15, s48, v56
    v_mfma_f32_16x16x32_bf16 v[152:155], v[244:247], v[220:223], 0
    s_lshl_b32 s81, s64, 5
    v_mfma_f32_16x16x32_bf16 v[156:159], v[248:251], v[220:223], 0
    s_lshl_b32 s80, s63, 2
    v_mfma_f32_16x16x32_bf16 v[160:163], v[244:247], v[224:227], 0
    s_add_u32 s81, s81, s80
    v_mfma_f32_16x16x32_bf16 v[164:167], v[248:251], v[224:227], 0
    s_add_u32 s81, s81, s62
    v_mfma_f32_16x16x32_bf16 v[168:171], v[244:247], v[228:231], 0
    s_mul_i32 s81, s81, 896
    v_mfma_f32_16x16x32_bf16 v[172:175], v[248:251], v[228:231], 0
    s_mul_i32 s80, s65, 4194304
    v_mfma_f32_16x16x32_bf16 v[68:71], v[240:243], v[180:183], v[68:71]
    s_add_u32 s81, s81, s80
    v_mfma_f32_16x16x32_bf16 v[76:79], v[240:243], v[184:187], v[76:79]
    s_add_u32 s81, s81, 41943040
    v_mfma_f32_16x16x32_bf16 v[84:87], v[240:243], v[188:191], v[84:87]
    v_mfma_f32_16x16x32_bf16 v[92:95], v[240:243], v[192:195], v[92:95]
    v_mfma_f32_16x16x32_bf16 v[100:103], v[240:243], v[196:199], v[100:103]
    v_mfma_f32_16x16x32_bf16 v[108:111], v[240:243], v[200:203], v[108:111]
    v_mfma_f32_16x16x32_bf16 v[116:119], v[240:243], v[204:207], v[116:119]
    s_mov_b32 s98, 0
    s_add_u32 m0, s48, 0
    s_add_u32 s85, s49, 0
    buffer_load_dwordx4 v56, s[8:11], s85 offen sc1 lds
    buffer_load_dwordx4 v56, s[8:11], s85 offen offset:1024 sc1 lds
    s_add_u32 m0, s48, 4096
    s_add_u32 s85, s49, 4096
    buffer_load_dwordx4 v56, s[8:11], s85 offen sc1 lds
    buffer_load_dwordx4 v56, s[8:11], s85 offen offset:1024 sc1 lds
    s_add_u32 m0, s48, 8192
    s_add_u32 s85, s49, 16384
    buffer_load_dwordx4 v56, s[8:11], s85 offen sc1 lds
    buffer_load_dwordx4 v56, s[8:11], s85 offen offset:1024 sc1 lds
    s_add_u32 m0, s48, 12288
    s_add_u32 s85, s49, 20480
    buffer_load_dwordx4 v56, s[8:11], s85 offen sc1 lds
    buffer_load_dwordx4 v56, s[8:11], s85 offen offset:1024 sc1 lds
    s_add_u32 m0, s48, 16384
    s_add_u32 s85, s49, 32768
    buffer_load_dwordx4 v56, s[8:11], s85 offen sc1 lds
    s_add_u32 s76, s0, 147456
    v_lshlrev_b32 v249, 3, v1
    v_lshl_add_u32 v248, v2, 2, v249
    v_lshl_add_u32 v249, v2, 8, v249
    v_lshrrev_b32 v16, 2, v1
    buffer_load_dwordx4 v56, s[8:11], s85 offen offset:1024 sc1 lds
    v_xor_b32 v244, v16, v2
    v_lshl_add_u32 v244, v244, 3, s76
    v_and_b32 v17, 3, v1
    v_lshl_add_u32 v244, v17, 5, v244
    s_add_u32 m0, s48, 20480
    s_add_u32 s85, s49, 36864
    buffer_load_dwordx4 v56, s[8:11], s85 offen sc1 lds
    v_bfe_u32 v18, v1, 2, 1
    v_lshl_add_u32 v244, v18, 8, v244
    v_bfe_u32 v18, v1, 3, 1
    v_lshl_add_u32 v244, v18, 7, v244
    buffer_load_dwordx4 v56, s[8:11], s85 offen offset:1024 sc1 lds
    v_and_b32 v18, 1, v2
    v_lshlrev_b32 v19, 1, v18
    v_xor_b32 v245, v17, v19
    v_lshl_add_u32 v245, v245, 3, s76
    v_lshl_add_u32 v245, v16, 5, v245
    s_add_u32 m0, s48, 24576
    s_add_u32 s85, s49, 49152
    buffer_load_dwordx4 v56, s[8:11], s85 offen sc1 lds
    v_lshl_add_u32 v245, v18, 7, v245
    v_lshrrev_b32 v19, 1, v2
    v_lshl_add_u32 v245, v19, 9, v245
    v_xor_b32 v246, 8, v245
    buffer_load_dwordx4 v56, s[8:11], s85 offen offset:1024 sc1 lds
    v_lshlrev_b32 v247, 4, v1
    v_lshl_add_u32 v18, v19, 2, v18
    v_mul_u32_u24 v18, 16384, v18
    v_add_u32 v247, v247, v18
    v_mov_b32 v240, -1
    v_mov_b32 v241, -1
    v_mov_b32 v242, -1
    v_mov_b32 v243, -1
    s_mov_b32 s78, 0
    s_mov_b32 s79, 0xffff0000
    s_waitcnt vmcnt(12)
    ds_read_b128 v[232:235], v15 offset:0
    ds_read_b128 v[236:239], v15 offset:1024
    s_waitcnt lgkmcnt(0)
    v_max3_u32 v252, v232, v234, v236
    v_max_u32 v252, v252, v238
    v_cmp_eq_u32 vcc, -1, v252
    s_cbranch_vccnz p_retry0
p_back0:
    s_barrier
    ds_read_b64_tr_b16 v[176:177], v8 offset:0
    ds_read_b64_tr_b16 v[178:179], v8 offset:256
    ds_read_b64_tr_b16 v[180:181], v9 offset:0
    ds_read_b64_tr_b16 v[182:183], v9 offset:256
    ds_read_b64_tr_b16 v[184:185], v8 offset:2048
    ds_read_b64_tr_b16 v[186:187], v8 offset:2304
    ds_read_b64_tr_b16 v[188:189], v9 offset:2048
    ds_read_b64_tr_b16 v[190:191], v9 offset:2304
    s_waitcnt lgkmcnt(4)
    v_mfma_f32_16x16x32_bf16 v[64:67], v[176:179], v[40:43], v[64:67]
    s_waitcnt vmcnt(8)
    ds_read_b128 v[232:235], v15 offset:4096
    ds_read_b128 v[236:239], v15 offset:5120
    ds_read_b128 v[16:19], v15 offset:8192
    v_mfma_f32_16x16x32_bf16 v[68:71], v[180:183], v[40:43], v[68:71]
    ds_read_b128 v[20:23], v15 offset:9216
    ds_read_b64_tr_b16 v[192:193], v10 offset:0
    ds_read_b64_tr_b16 v[194:195], v10 offset:256
    s_waitcnt lgkmcnt(6)
    v_mfma_f32_16x16x32_bf16 v[64:67], v[184:187], v[44:47], v[64:67]
    ds_read_b64_tr_b16 v[196:197], v11 offset:0
    ds_read_b64_tr_b16 v[198:199], v11 offset:256
    ds_read_b64_tr_b16 v[200:201], v10 offset:2048
    v_mfma_f32_16x16x32_bf16 v[68:71], v[188:191], v[44:47], v[68:71]
    ds_read_b64_tr_b16 v[202:203], v10 offset:2304
    ds_read_b64_tr_b16 v[204:205], v11 offset:2048
    ds_read_b64_tr_b16 v[206:207], v11 offset:2304
    s_waitcnt lgkmcnt(6)
    v_mfma_f32_16x16x32_bf16 v[172:175], v[192:195], v[48:51], v[172:175]
    v_max3_u32 v252, v232, v234, v236
    v_max3_u32 v252, v252, v238, v16
    v_max3_u32 v252, v252, v18, v20
    v_max_u32 v252, v252, v22
    v_cmp_eq_u32 vcc, -1, v252
    s_cbranch_vccnz p_retry1
p_back1:
    s_barrier
    ds_read_b64_tr_b16 v[208:209], v8 offset:4096
    ds_read_b64_tr_b16 v[210:211], v8 offset:4352
    ds_read_b64_tr_b16 v[212:213], v9 offset:4096
    s_waitcnt lgkmcnt(7)
    v_mfma_f32_16x16x32_bf16 v[168:171], v[196:199], v[48:51], v[168:171]
    ds_read_b64_tr_b16 v[214:215], v9 offset:4352
    ds_read_b64_tr_b16 v[216:217], v8 offset:6144
    ds_read_b64_tr_b16 v[218:219], v8 offset:6400
    v_cvt_pk_bf16_f32 v64, v64, v65
    s_waitcnt lgkmcnt(8)
    v_mfma_f32_16x16x32_bf16 v[172:175], v[200:203], v[52:55], v[172:175]
    ds_read_b64_tr_b16 v[220:221], v9 offset:6144
    ds_read_b64_tr_b16 v[222:223], v9 offset:6400
    ds_read_b64_tr_b16 v[176:177], v10 offset:4096
    v_cvt_pk_bf16_f32 v65, v66, v67
    s_waitcnt lgkmcnt(9)
    v_mfma_f32_16x16x32_bf16 v[168:171], v[204:207], v[52:55], v[168:171]
    ds_read_b64_tr_b16 v[178:179], v10 offset:4352
    ds_read_b64_tr_b16 v[180:181], v11 offset:4096
    ds_read_b64_tr_b16 v[182:183], v11 offset:4352
    v_cvt_pk_bf16_f32 v66, v68, v69
    s_waitcnt lgkmcnt(10)
    v_mfma_f32_16x16x32_bf16 v[72:75], v[208:211], v[40:43], v[72:75]
    ds_read_b64_tr_b16 v[184:185], v10 offset:6144
    ds_read_b64_tr_b16 v[186:187], v10 offset:6400
    v_cvt_pk_bf16_f32 v67, v70, v71
    s_waitcnt lgkmcnt(10)
    v_mfma_f32_16x16x32_bf16 v[76:79], v[212:215], v[40:43], v[76:79]
    ds_read_b64_tr_b16 v[188:189], v11 offset:6144
    ds_read_b64_tr_b16 v[190:191], v11 offset:6400
    v_cvt_pk_bf16_f32 v168, v168, v169
    v_mfma_f32_16x16x32_bf16 v[224:227], v[60:63], v[64:67], 0
    ds_read_b64_tr_b16 v[192:193], v8 offset:8192
    ds_read_b64_tr_b16 v[194:195], v8 offset:8448
    v_cvt_pk_bf16_f32 v169, v170, v171
    s_waitcnt lgkmcnt(10)
    v_mfma_f32_16x16x32_bf16 v[72:75], v[216:219], v[44:47], v[72:75]
    ds_read_b64_tr_b16 v[196:197], v9 offset:8192
    ds_read_b64_tr_b16 v[198:199], v9 offset:8448
    v_cvt_pk_bf16_f32 v170, v172, v173
    v_mfma_f32_16x16x32_bf16 v[76:79], v[220:223], v[44:47], v[76:79]
    ds_read_b64_tr_b16 v[200:201], v8 offset:10240
    v_cvt_pk_bf16_f32 v171, v174, v175
    v_mfma_f32_16x16x32_bf16 v[228:231], v[64:67], v[64:67], 0
    ds_read_b64_tr_b16 v[202:203], v8 offset:10496
    s_waitcnt lgkmcnt(10)
    v_mfma_f32_16x16x32_bf16 v[164:167], v[176:179], v[48:51], v[164:167]
    ds_read_b64_tr_b16 v[204:205], v9 offset:10240
    ds_read_b64_tr_b16 v[206:207], v9 offset:10496
    v_mfma_f32_16x16x32_bf16 v[160:163], v[180:183], v[48:51], v[160:163]
    s_waitcnt vmcnt(4)
    ds_read_b128 v[232:235], v15 offset:12288
    v_cvt_pk_bf16_f32 v72, v72, v73
    v_mfma_f32_16x16x32_bf16 v[224:227], v[60:63], v[168:171], v[224:227]
    ds_read_b128 v[236:239], v15 offset:13312
    v_cvt_pk_bf16_f32 v73, v74, v75
    s_waitcnt lgkmcnt(10)
    v_mfma_f32_16x16x32_bf16 v[164:167], v[184:187], v[52:55], v[164:167]
    ds_read_b128 v[16:19], v15 offset:16384
    ds_read_b128 v[20:23], v15 offset:17408
    v_cvt_pk_bf16_f32 v74, v76, v77
    v_mfma_f32_16x16x32_bf16 v[160:163], v[188:191], v[52:55], v[160:163]
    ds_read_b64_tr_b16 v[208:209], v10 offset:8192
    ds_read_b64_tr_b16 v[210:211], v10 offset:8448
    v_cvt_pk_bf16_f32 v75, v78, v79
    v_mfma_f32_16x16x32_bf16 v[228:231], v[168:171], v[168:171], v[228:231]
    s_waitcnt lgkmcnt(10)
    v_mfma_f32_16x16x32_bf16 v[80:83], v[192:195], v[40:43], v[80:83]
    ds_read_b64_tr_b16 v[212:213], v11 offset:8192
    ds_read_b64_tr_b16 v[214:215], v11 offset:8448
    v_mfma_f32_16x16x32_bf16 v[84:87], v[196:199], v[40:43], v[84:87]
    ds_read_b64_tr_b16 v[216:217], v10 offset:10240
    ds_read_b64_tr_b16 v[218:219], v10 offset:10496
    v_cvt_pk_bf16_f32 v160, v160, v161
    v_mfma_f32_16x16x32_bf16 v[224:227], v[60:63], v[72:75], v[224:227]
    v_cvt_pk_bf16_f32 v161, v162, v163
    s_waitcnt lgkmcnt(10)
    v_mfma_f32_16x16x32_bf16 v[80:83], v[200:203], v[44:47], v[80:83]
    ds_read_b64_tr_b16 v[220:221], v11 offset:10240
    ds_read_b64_tr_b16 v[222:223], v11 offset:10496
    v_cvt_pk_bf16_f32 v162, v164, v165
    v_mfma_f32_16x16x32_bf16 v[84:87], v[204:207], v[44:47], v[84:87]
    s_waitcnt lgkmcnt(8)
    v_max3_u32 v252, v232, v234, v236
    v_max3_u32 v252, v252, v238, v16
    v_max3_u32 v252, v252, v18, v20
    v_max_u32 v252, v252, v22
    v_cmp_eq_u32 vcc, -1, v252
    s_cbranch_vccnz p_retry3
p_back3:
    s_barrier
    ds_read_b64_tr_b16 v[176:177], v8 offset:12288
    ds_read_b64_tr_b16 v[178:179], v8 offset:12544
    v_cvt_pk_bf16_f32 v163, v166, v167
    v_mfma_f32_16x16x32_bf16 v[228:231], v[72:75], v[72:75], v[228:231]
    ds_read_b64_tr_b16 v[180:181], v9 offset:12288
    ds_read_b64_tr_b16 v[182:183], v9 offset:12544
    s_waitcnt lgkmcnt(8)
    v_mfma_f32_16x16x32_bf16 v[156:159], v[208:211], v[48:51], v[156:159]
    ds_read_b64_tr_b16 v[184:185], v8 offset:14336
    ds_read_b64_tr_b16 v[186:187], v8 offset:14592
    v_mfma_f32_16x16x32_bf16 v[152:155], v[212:215], v[48:51], v[152:155]
    ds_read_b64_tr_b16 v[188:189], v9 offset:14336
    ds_read_b64_tr_b16 v[190:191], v9 offset:14592
    v_cvt_pk_bf16_f32 v80, v80, v81
    v_mfma_f32_16x16x32_bf16 v[224:227], v[60:63], v[160:163], v[224:227]
    ds_read_b64_tr_b16 v[192:193], v10 offset:12288
    ds_read_b64_tr_b16 v[194:195], v10 offset:12544
    v_cvt_pk_bf16_f32 v81, v82, v83
    s_waitcnt lgkmcnt(10)
    v_mfma_f32_16x16x32_bf16 v[156:159], v[216:219], v[52:55], v[156:159]
    ds_read_b64_tr_b16 v[196:197], v11 offset:12288
    ds_read_b64_tr_b16 v[198:199], v11 offset:12544
    v_cvt_pk_bf16_f32 v82, v84, v85
    v_mfma_f32_16x16x32_bf16 v[152:155], v[220:223], v[52:55], v[152:155]
    ds_read_b64_tr_b16 v[200:201], v10 offset:14336
    v_cvt_pk_bf16_f32 v83, v86, v87
    v_mfma_f32_16x16x32_bf16 v[228:231], v[160:163], v[160:163], v[228:231]
    ds_read_b64_tr_b16 v[202:203], v10 offset:14592
    s_waitcnt lgkmcnt(10)
    v_mfma_f32_16x16x32_bf16 v[88:91], v[176:179], v[40:43], v[88:91]
    ds_read_b64_tr_b16 v[204:205], v11 offset:14336
    ds_read_b64_tr_b16 v[206:207], v11 offset:14592
    v_mfma_f32_16x16x32_bf16 v[92:95], v[180:183], v[40:43], v[92:95]
    ds_read_b64_tr_b16 v[208:209], v8 offset:16384
    v_cvt_pk_bf16_f32 v152, v152, v153
    v_mfma_f32_16x16x32_bf16 v[224:227], v[60:63], v[80:83], v[224:227]
    ds_read_b64_tr_b16 v[210:211], v8 offset:16640
    v_cvt_pk_bf16_f32 v153, v154, v155
    s_waitcnt lgkmcnt(10)
    v_mfma_f32_16x16x32_bf16 v[88:91], v[184:187], v[44:47], v[88:91]
    ds_read_b64_tr_b16 v[212:213], v9 offset:16384
    ds_read_b64_tr_b16 v[214:215], v9 offset:16640
    v_cvt_pk_bf16_f32 v154, v156, v157
    v_mfma_f32_16x16x32_bf16 v[92:95], v[188:191], v[44:47], v[92:95]
    ds_read_b64_tr_b16 v[216:217], v8 offset:18432
    v_cvt_pk_bf16_f32 v155, v158, v159
    v_mfma_f32_16x16x32_bf16 v[228:231], v[80:83], v[80:83], v[228:231]
    ds_read_b64_tr_b16 v[218:219], v8 offset:18688
    s_waitcnt lgkmcnt(10)
    v_mfma_f32_16x16x32_bf16 v[148:151], v[192:195], v[48:51], v[148:151]
    ds_read_b64_tr_b16 v[220:221], v9 offset:18432
    ds_read_b64_tr_b16 v[222:223], v9 offset:18688
    v_mfma_f32_16x16x32_bf16 v[144:147], v[196:199], v[48:51], v[144:147]
    s_waitcnt vmcnt(0)
    ds_read_b128 v[232:235], v15 offset:20480
    v_cvt_pk_bf16_f32 v88, v88, v89
    v_mfma_f32_16x16x32_bf16 v[224:227], v[60:63], v[152:155], v[224:227]
    ds_read_b128 v[236:239], v15 offset:21504
    v_cvt_pk_bf16_f32 v89, v90, v91
    s_waitcnt lgkmcnt(10)
    v_mfma_f32_16x16x32_bf16 v[148:151], v[200:203], v[52:55], v[148:151]
    ds_read_b128 v[16:19], v15 offset:24576
    ds_read_b128 v[20:23], v15 offset:25600
    v_cvt_pk_bf16_f32 v90, v92, v93
    v_mfma_f32_16x16x32_bf16 v[144:147], v[204:207], v[52:55], v[144:147]
    ds_read_b64_tr_b16 v[176:177], v10 offset:16384
    ds_read_b64_tr_b16 v[178:179], v10 offset:16640
    v_cvt_pk_bf16_f32 v91, v94, v95
    v_mfma_f32_16x16x32_bf16 v[228:231], v[152:155], v[152:155], v[228:231]
    s_waitcnt lgkmcnt(10)
    v_mfma_f32_16x16x32_bf16 v[96:99], v[208:211], v[40:43], v[96:99]
    ds_read_b64_tr_b16 v[180:181], v11 offset:16384
    ds_read_b64_tr_b16 v[182:183], v11 offset:16640
    v_mfma_f32_16x16x32_bf16 v[100:103], v[212:215], v[40:43], v[100:103]
    ds_read_b64_tr_b16 v[184:185], v10 offset:18432
    ds_read_b64_tr_b16 v[186:187], v10 offset:18688
    v_cvt_pk_bf16_f32 v144, v144, v145
    v_mfma_f32_16x16x32_bf16 v[224:227], v[60:63], v[88:91], v[224:227]
    v_cvt_pk_bf16_f32 v145, v146, v147
    s_waitcnt lgkmcnt(10)
    v_mfma_f32_16x16x32_bf16 v[96:99], v[216:219], v[44:47], v[96:99]
    ds_read_b64_tr_b16 v[188:189], v11 offset:18432
    ds_read_b64_tr_b16 v[190:191], v11 offset:18688
    v_cvt_pk_bf16_f32 v146, v148, v149
    v_mfma_f32_16x16x32_bf16 v[100:103], v[220:223], v[44:47], v[100:103]
    s_waitcnt lgkmcnt(8)
    v_max3_u32 v252, v232, v234, v236
    v_max3_u32 v252, v252, v238, v16
    v_max3_u32 v252, v252, v18, v20
    v_max_u32 v252, v252, v22
    v_cmp_eq_u32 vcc, -1, v252
    s_cbranch_vccnz p_retry5
p_back5:
    s_barrier
    ds_read_b64_tr_b16 v[192:193], v8 offset:20480
    ds_read_b64_tr_b16 v[194:195], v8 offset:20736
    v_cvt_pk_bf16_f32 v147, v150, v151
    v_mfma_f32_16x16x32_bf16 v[228:231], v[88:91], v[88:91], v[228:231]
    ds_read_b64_tr_b16 v[196:197], v9 offset:20480
    ds_read_b64_tr_b16 v[198:199], v9 offset:20736
    s_waitcnt lgkmcnt(8)
    v_mfma_f32_16x16x32_bf16 v[140:143], v[176:179], v[48:51], v[140:143]
    ds_read_b64_tr_b16 v[200:201], v8 offset:22528
    ds_read_b64_tr_b16 v[202:203], v8 offset:22784
    v_mfma_f32_16x16x32_bf16 v[136:139], v[180:183], v[48:51], v[136:139]
    ds_read_b64_tr_b16 v[204:205], v9 offset:22528
    ds_read_b64_tr_b16 v[206:207], v9 offset:22784
    v_cvt_pk_bf16_f32 v96, v96, v97
    v_mfma_f32_16x16x32_bf16 v[224:227], v[60:63], v[144:147], v[224:227]
    ds_read_b64_tr_b16 v[208:209], v10 offset:20480
    ds_read_b64_tr_b16 v[210:211], v10 offset:20736
    v_cvt_pk_bf16_f32 v97, v98, v99
    s_waitcnt lgkmcnt(10)
    v_mfma_f32_16x16x32_bf16 v[140:143], v[184:187], v[52:55], v[140:143]
    ds_read_b64_tr_b16 v[212:213], v11 offset:20480
    ds_read_b64_tr_b16 v[214:215], v11 offset:20736
    v_cvt_pk_bf16_f32 v98, v100, v101
    v_mfma_f32_16x16x32_bf16 v[136:139], v[188:191], v[52:55], v[136:139]
    ds_read_b64_tr_b16 v[216:217], v10 offset:22528
    v_cvt_pk_bf16_f32 v99, v102, v103
    v_mfma_f32_16x16x32_bf16 v[228:231], v[144:147], v[144:147], v[228:231]
    ds_read_b64_tr_b16 v[218:219], v10 offset:22784
    s_waitcnt lgkmcnt(10)
    v_mfma_f32_16x16x32_bf16 v[104:107], v[192:195], v[40:43], v[104:107]
    ds_read_b64_tr_b16 v[220:221], v11 offset:22528
    ds_read_b64_tr_b16 v[222:223], v11 offset:22784
    v_mfma_f32_16x16x32_bf16 v[108:111], v[196:199], v[40:43], v[108:111]
    ds_read_b64_tr_b16 v[176:177], v8 offset:24576
    v_cvt_pk_bf16_f32 v136, v136, v137
    v_mfma_f32_16x16x32_bf16 v[224:227], v[60:63], v[96:99], v[224:227]
    ds_read_b64_tr_b16 v[178:179], v8 offset:24832
    v_cvt_pk_bf16_f32 v137, v138, v139
    s_waitcnt lgkmcnt(10)
    v_mfma_f32_16x16x32_bf16 v[104:107], v[200:203], v[44:47], v[104:107]
    ds_read_b64_tr_b16 v[180:181], v9 offset:24576
    ds_read_b64_tr_b16 v[182:183], v9 offset:24832
    v_cvt_pk_bf16_f32 v138, v140, v141
    v_mfma_f32_16x16x32_bf16 v[108:111], v[204:207], v[44:47], v[108:111]
    ds_read_b64_tr_b16 v[184:185], v8 offset:26624
    v_cvt_pk_bf16_f32 v139, v142, v143
    v_mfma_f32_16x16x32_bf16 v[228:231], v[96:99], v[96:99], v[228:231]
    ds_read_b64_tr_b16 v[186:187], v8 offset:26880
    s_waitcnt lgkmcnt(10)
    v_mfma_f32_16x16x32_bf16 v[132:135], v[208:211], v[48:51], v[132:135]
    ds_read_b64_tr_b16 v[188:189], v9 offset:26624
    ds_read_b64_tr_b16 v[190:191], v9 offset:26880
    v_mfma_f32_16x16x32_bf16 v[128:131], v[212:215], v[48:51], v[128:131]
    ds_read_b64_tr_b16 v[192:193], v10 offset:24576
    v_cvt_pk_bf16_f32 v104, v104, v105
    v_mfma_f32_16x16x32_bf16 v[224:227], v[60:63], v[136:139], v[224:227]
    ds_read_b64_tr_b16 v[194:195], v10 offset:24832
    v_cvt_pk_bf16_f32 v105, v106, v107
    s_waitcnt lgkmcnt(10)
    v_mfma_f32_16x16x32_bf16 v[132:135], v[216:219], v[52:55], v[132:135]
    ds_read_b64_tr_b16 v[196:197], v11 offset:24576
    ds_read_b64_tr_b16 v[198:199], v11 offset:24832
    v_cvt_pk_bf16_f32 v106, v108, v109
    v_mfma_f32_16x16x32_bf16 v[128:131], v[220:223], v[52:55], v[128:131]
    ds_read_b64_tr_b16 v[200:201], v10 offset:26624
    v_cvt_pk_bf16_f32 v107, v110, v111
    v_mfma_f32_16x16x32_bf16 v[228:231], v[136:139], v[136:139], v[228:231]
    ds_read_b64_tr_b16 v[202:203], v10 offset:26880
    s_add_u32 m0, s0, 65536
    s_waitcnt lgkmcnt(10)
    v_mfma_f32_16x16x32_bf16 v[112:115], v[176:179], v[40:43], v[112:115]
    ds_read_b64_tr_b16 v[204:205], v11 offset:26624
    ds_read_b64_tr_b16 v[206:207], v11 offset:26880
    s_add_u32 s85, s86, 65536
    v_mfma_f32_16x16x32_bf16 v[116:119], v[180:183], v[40:43], v[116:119]
    ds_read_b128 v[208:211], v56 offset:0
    buffer_load_dwordx4 v56, s[8:11], s85 offen offset:0 sc1 lds
    v_mfma_f32_16x16x32_bf16 v[224:227], v[60:63], v[104:107], v[224:227]
    ds_read_b128 v[212:215], v56 offset:1024
    buffer_load_dwordx4 v56, s[8:11], s85 offen offset:1024 sc1 lds
    s_waitcnt lgkmcnt(10)
    v_mfma_f32_16x16x32_bf16 v[112:115], v[184:187], v[44:47], v[112:115]
    ds_read_b128 v[216:219], v56 offset:2048
    v_cvt_pk_bf16_f32 v128, v128, v129
    v_mfma_f32_16x16x32_bf16 v[116:119], v[188:191], v[44:47], v[116:119]
    ds_read_b128 v[220:223], v56 offset:3072
    v_cvt_pk_bf16_f32 v129, v130, v131
    v_mfma_f32_16x16x32_bf16 v[228:231], v[104:107], v[104:107], v[228:231]
    ds_read_b128 v[176:179], v56 offset:4096
    v_cvt_pk_bf16_f32 v130, v132, v133
    s_waitcnt lgkmcnt(9)
    v_mfma_f32_16x16x32_bf16 v[124:127], v[192:195], v[48:51], v[124:127]
    ds_read_b128 v[180:183], v56 offset:5120
    v_cvt_pk_bf16_f32 v131, v134, v135
    v_mfma_f32_16x16x32_bf16 v[120:123], v[196:199], v[48:51], v[120:123]
    ds_read_b128 v[184:187], v56 offset:6144
    buffer_load_dwordx4 v56, s[8:11], s85 offen offset:2048 sc1 lds
    v_mfma_f32_16x16x32_bf16 v[224:227], v[60:63], v[128:131], v[224:227]
    ds_read_b128 v[188:191], v56 offset:7168
    v_cvt_pk_bf16_f32 v112, v112, v113
    s_waitcnt lgkmcnt(8)
    v_mfma_f32_16x16x32_bf16 v[124:127], v[200:203], v[52:55], v[124:127]
    ds_read_b128 v[192:195], v56 offset:8192
    v_cvt_pk_bf16_f32 v113, v114, v115
    v_mfma_f32_16x16x32_bf16 v[120:123], v[204:207], v[52:55], v[120:123]
    ds_read_b128 v[196:199], v56 offset:9216
    v_cvt_pk_bf16_f32 v114, v116, v117
    v_mfma_f32_16x16x32_bf16 v[228:231], v[128:131], v[128:131], v[228:231]
    ds_read_b128 v[200:203], v56 offset:10240
    v_cvt_pk_bf16_f32 v115, v118, v119
    s_waitcnt lgkmcnt(6)
    v_mfma_f32_16x16x32_bf16 v[68:71], v[208:211], v[64:67], 0
    ds_read_b128 v[204:207], v56 offset:11264
    ds_read_b128 v[208:211], v56 offset:12288
    v_mfma_f32_16x16x32_bf16 v[76:79], v[212:215], v[64:67], 0
    ds_read_b128 v[212:215], v56 offset:13312
    buffer_load_dwordx4 v56, s[8:11], s85 offen offset:3072 sc1 lds
    v_mfma_f32_16x16x32_bf16 v[84:87], v[216:219], v[64:67], 0
    s_add_u32 m0, s0, 81920
    s_add_u32 s85, s86, 81920
    v_mfma_f32_16x16x32_bf16 v[92:95], v[220:223], v[64:67], 0
    buffer_load_dwordx4 v56, s[8:11], s85 offen offset:0 sc1 lds
    v_cvt_pk_bf16_f32 v120, v120, v121
    v_mfma_f32_16x16x32_bf16 v[100:103], v[176:179], v[64:67], 0
    ds_read_b128 v[216:219], v56 offset:14336
    s_waitcnt lgkmcnt(5)
    v_mfma_f32_16x16x32_bf16 v[108:111], v[180:183], v[64:67], 0
    ds_read_b128 v[220:223], v56 offset:15360
    v_cndmask_b32 v123, v123, v59, s[78:79]
    v_mfma_f32_16x16x32_bf16 v[116:119], v[184:187], v[64:67], 0
    ds_read_b128 v[176:179], v56 offset:16384
    v_cvt_pk_bf16_f32 v121, v122, v123
    v_mfma_f32_16x16x32_bf16 v[68:71], v[188:191], v[72:75], v[68:71]
    ds_read_b128 v[180:183], v56 offset:17408
    v_cvt_pk_bf16_f32 v122, v124, v125
    v_mfma_f32_16x16x32_bf16 v[76:79], v[192:195], v[72:75], v[76:79]
    ds_read_b128 v[184:187], v56 offset:18432
    v_cvt_pk_bf16_f32 v123, v126, v127
    v_mfma_f32_16x16x32_bf16 v[84:87], v[196:199], v[72:75], v[84:87]
    ds_read_b128 v[188:191], v56 offset:19456
    s_waitcnt lgkmcnt(6)
    v_mfma_f32_16x16x32_bf16 v[92:95], v[200:203], v[72:75], v[92:95]
    ds_read_b128 v[192:195], v56 offset:20480
    s_barrier
    v_mfma_f32_16x16x32_bf16 v[100:103], v[204:207], v[72:75], v[100:103]
    ds_read_b128 v[196:199], v56 offset:21504
    buffer_load_dwordx4 v56, s[8:11], s85 offen offset:1024 sc1 lds
    v_mfma_f32_16x16x32_bf16 v[108:111], v[208:211], v[72:75], v[108:111]
    ds_read_b128 v[200:203], v56 offset:22528
    buffer_load_dwordx4 v56, s[8:11], s85 offen offset:2048 sc1 lds
    v_mfma_f32_16x16x32_bf16 v[116:119], v[212:215], v[72:75], v[116:119]
    ds_read_b128 v[204:207], v56 offset:23552
    buffer_load_dwordx4 v56, s[8:11], s85 offen offset:3072 sc1 lds
    v_mfma_f32_16x16x32_bf16 v[224:227], v[60:63], v[112:115], v[224:227]
    ds_read_b128 v[208:211], v56 offset:24576
    v_mfma_f32_16x16x32_bf16 v[228:231], v[112:115], v[112:115], v[228:231]
    ds_read_b128 v[212:215], v56 offset:25600
    v_mfma_f32_16x16x32_bf16 v[224:227], v[60:63], v[120:123], v[224:227]
    s_add_u32 m0, s91, 98304
    s_add_u32 s85, s60, 98304
    v_mfma_f32_16x16x32_bf16 v[228:231], v[120:123], v[120:123], v[228:231]
    buffer_load_dwordx4 v56, s[8:11], s85 offen offset:0 sc1 lds
    s_waitcnt lgkmcnt(7)
    v_mfma_f32_16x16x32_bf16 v[68:71], v[216:219], v[80:83], v[68:71]
    ds_read_b128 v[216:219], v56 offset:26624
    v_mfma_f32_16x16x32_bf16 v[76:79], v[220:223], v[80:83], v[76:79]
    ds_read_b128 v[220:223], v56 offset:27648
    v_mfma_f32_16x16x32_bf16 v[84:87], v[176:179], v[80:83], v[84:87]
    ds_read_b128 v[176:179], v56 offset:28672
    s_add_u32 s80, s96, 0
    v_mfma_f32_16x16x32_bf16 v[92:95], v[180:183], v[80:83], v[92:95]
    ds_read_b128 v[180:183], v56 offset:29696
    buffer_store_dwordx4 v[240:243], v56, s[8:11], s80 offen sc1
    v_mfma_f32_16x16x32_bf16 v[100:103], v[184:187], v[80:83], v[100:103]
    ds_read_b128 v[184:187], v56 offset:30720
    s_waitcnt lgkmcnt(7)
    v_mfma_f32_16x16x32_bf16 v[108:111], v[188:191], v[80:83], v[108:111]
    ds_read_b128 v[188:191], v56 offset:31744
    v_cndmask_b32 v18, 0, v228, s[38:39]
    v_mfma_f32_16x16x32_bf16 v[116:119], v[192:195], v[80:83], v[116:119]
    ds_read_b128 v[192:195], v56 offset:32768
    v_cndmask_b32 v18, v18, v229, s[40:41]
    v_mfma_f32_16x16x32_bf16 v[68:71], v[196:199], v[88:91], v[68:71]
    ds_read_b128 v[196:199], v56 offset:33792
    v_cndmask_b32 v18, v18, v230, s[42:43]
    v_mfma_f32_16x16x32_bf16 v[76:79], v[200:203], v[88:91], v[76:79]
    ds_read_b128 v[200:203], v56 offset:34816
    v_mfma_f32_16x16x32_bf16 v[84:87], v[204:207], v[88:91], v[84:87]
    ds_read_b128 v[204:207], v56 offset:35840
    s_waitcnt lgkmcnt(7)
    v_mfma_f32_16x16x32_bf16 v[92:95], v[208:211], v[88:91], v[92:95]
    ds_read_b128 v[208:211], v56 offset:36864
    v_cndmask_b32 v18, v18, v231, s[44:45]
    v_mfma_f32_16x16x32_bf16 v[100:103], v[212:215], v[88:91], v[100:103]
    ds_read_b128 v[212:215], v56 offset:37888
    v_mov_b32 v252, v18
    v_mfma_f32_16x16x32_bf16 v[108:111], v[216:219], v[88:91], v[108:111]
    ds_read_b128 v[216:219], v56 offset:38912
    s_add_u32 s80, s96, 16384
    v_mfma_f32_16x16x32_bf16 v[116:119], v[220:223], v[88:91], v[116:119]
    ds_read_b128 v[220:223], v56 offset:39936
    buffer_store_dwordx4 v[240:243], v56, s[8:11], s80 offen sc1
    v_mfma_f32_16x16x32_bf16 v[68:71], v[176:179], v[96:99], v[68:71]
    ds_read_b128 v[176:179], v56 offset:40960
    s_waitcnt lgkmcnt(7)
    v_mfma_f32_16x16x32_bf16 v[76:79], v[180:183], v[96:99], v[76:79]
    ds_read_b128 v[180:183], v56 offset:41984
    v_permlane16_swap_b32 v18, v252
    v_mfma_f32_16x16x32_bf16 v[84:87], v[184:187], v[96:99], v[84:87]
    ds_read_b128 v[184:187], v56 offset:43008
    v_add_f32 v18, v18, v252
    v_mfma_f32_16x16x32_bf16 v[92:95], v[188:191], v[96:99], v[92:95]
    ds_read_b128 v[188:191], v56 offset:44032
    v_mov_b32 v252, v18
    v_mfma_f32_16x16x32_bf16 v[100:103], v[192:195], v[96:99], v[100:103]
    ds_read_b128 v[192:195], v56 offset:45056
    v_mfma_f32_16x16x32_bf16 v[108:111], v[196:199], v[96:99], v[108:111]
    ds_read_b128 v[196:199], v56 offset:46080
    s_waitcnt lgkmcnt(7)
    v_mfma_f32_16x16x32_bf16 v[116:119], v[200:203], v[96:99], v[116:119]
    ds_read_b128 v[200:203], v56 offset:47104
    v_permlane32_swap_b32 v18, v252
    v_mfma_f32_16x16x32_bf16 v[68:71], v[204:207], v[104:107], v[68:71]
    ds_read_b128 v[204:207], v56 offset:48128
    v_add_f32 v18, v18, v252
    v_mfma_f32_16x16x32_bf16 v[76:79], v[208:211], v[104:107], v[76:79]
    ds_read_b128 v[208:211], v56 offset:49152
    s_add_u32 s80, s96, 32768
    v_mfma_f32_16x16x32_bf16 v[84:87], v[212:215], v[104:107], v[84:87]
    ds_read_b128 v[212:215], v12 offset:0
    buffer_store_dwordx4 v[240:243], v56, s[8:11], s80 offen sc1
    v_mfma_f32_16x16x32_bf16 v[92:95], v[216:219], v[104:107], v[92:95]
    ds_read_b128 v[216:219], v12 offset:1024
    s_waitcnt lgkmcnt(7)
    v_mfma_f32_16x16x32_bf16 v[100:103], v[220:223], v[104:107], v[100:103]
    ds_read_b128 v[220:223], v12 offset:2048
    v_mul_f32 v19, 0x3b124925, v224
    v_mfma_f32_16x16x32_bf16 v[108:111], v[176:179], v[104:107], v[108:111]
    ds_read_b128 v[176:179], v12 offset:3072
    v_mul_f32 v18, 0x3b124925, v18
    v_mfma_f32_16x16x32_bf16 v[116:119], v[180:183], v[104:107], v[116:119]
    ds_read_b128 v[180:183], v12 offset:4096
    v_fma_f32 v18, -v19, v19, v18
    v_mfma_f32_16x16x32_bf16 v[68:71], v[184:187], v[112:115], v[68:71]
    ds_read_b128 v[184:187], v12 offset:5120
    v_mfma_f32_16x16x32_bf16 v[76:79], v[188:191], v[112:115], v[76:79]
    ds_read_b128 v[188:191], v12 offset:6144
    s_waitcnt lgkmcnt(7)
    v_mfma_f32_16x16x32_bf16 v[84:87], v[192:195], v[112:115], v[84:87]
    ds_read_b128 v[192:195], v12 offset:7168
    v_max_f32 v18, 0, v18
    v_mfma_f32_16x16x32_bf16 v[92:95], v[196:199], v[112:115], v[92:95]
    ds_read_b128 v[196:199], v12 offset:8192
    v_add_f32 v18, 0x3727c5ac, v18
    v_mfma_f32_16x16x32_bf16 v[100:103], v[200:203], v[112:115], v[100:103]
    ds_read_b128 v[200:203], v12 offset:9216
    buffer_store_dwordx2 v[240:241], v58, s[8:11], s97 offen sc1
    v_mfma_f32_16x16x32_bf16 v[108:111], v[204:207], v[112:115], v[108:111]
    ds_read_b128 v[204:207], v12 offset:10240
    v_rsq_f32 v252, v18
    v_mfma_f32_16x16x32_bf16 v[116:119], v[208:211], v[112:115], v[116:119]
    ds_read_b128 v[208:211], v12 offset:11264
    s_waitcnt lgkmcnt(7)
    v_mfma_f32_16x16x32_bf16 v[68:71], v[212:215], v[120:123], v[68:71]
    ds_read_b128 v[212:215], v12 offset:12288
    s_barrier
    v_mfma_f32_16x16x32_bf16 v[76:79], v[216:219], v[120:123], v[76:79]
    ds_read_b128 v[216:219], v12 offset:13312
    v_sub_f32 v19, 0, v19
    v_mfma_f32_16x16x32_bf16 v[84:87], v[220:223], v[120:123], v[84:87]
    s_waitcnt vmcnt(4)
    s_barrier
    ds_read_b128 v[220:223], v12 offset:14336
    v_mfma_f32_16x16x32_bf16 v[92:95], v[176:179], v[120:123], v[92:95]
    ds_read_b128 v[176:179], v12 offset:15360
    v_mul_f32 v18, v18, v252
    v_mfma_f32_16x16x32_bf16 v[100:103], v[180:183], v[120:123], v[100:103]
    ds_read_b128 v[180:183], v12 offset:16384
    s_waitcnt lgkmcnt(7)
    v_mfma_f32_16x16x32_bf16 v[108:111], v[184:187], v[120:123], v[108:111]
    ds_read_b128 v[184:187], v12 offset:17408
    v_mul_f32 v17, 0xc0135761, v252
    v_mfma_f32_16x16x32_bf16 v[116:119], v[188:191], v[120:123], v[116:119]
    ds_read_b128 v[188:191], v12 offset:18432
    v_mul_f32 v252, v252, v252
    v_mfma_f32_16x16x32_bf16 v[68:71], v[192:195], v[128:131], v[68:71]
    ds_read_b128 v[192:195], v12 offset:19456
    s_add_u32 m0, s0, 106496
    v_mfma_f32_16x16x32_bf16 v[76:79], v[196:199], v[128:131], v[76:79]
    ds_read_b128 v[196:199], v12 offset:20480
    s_add_u32 s85, s86, 114688
    v_mfma_f32_16x16x32_bf16 v[84:87], v[200:203], v[128:131], v[84:87]
    ds_read_b128 v[200:203], v12 offset:21504
    s_waitcnt lgkmcnt(7)
    v_mfma_f32_16x16x32_bf16 v[92:95], v[204:207], v[128:131], v[92:95]
    ds_read_b128 v[204:207], v12 offset:22528
    buffer_load_dwordx4 v56, s[8:11], s85 offen offset:0 sc1 lds
    v_mfma_f32_16x16x32_bf16 v[100:103], v[208:211], v[128:131], v[100:103]
    ds_read_b128 v[208:211], v12 offset:23552
    v_mul_f32 v252, 0x3d372713, v252
    v_mfma_f32_16x16x32_bf16 v[108:111], v[212:215], v[128:131], v[108:111]
    ds_read_b128 v[212:215], v12 offset:24576
    v_mul_f32 v16, v252, v17
    v_mfma_f32_16x16x32_bf16 v[116:119], v[216:219], v[128:131], v[116:119]
    ds_read_b128 v[216:219], v12 offset:25600
    buffer_load_dwordx4 v56, s[8:11], s85 offen offset:1024 sc1 lds
    v_mfma_f32_16x16x32_bf16 v[68:71], v[220:223], v[136:139], v[68:71]
    ds_read_b128 v[220:223], v12 offset:26624
    s_waitcnt lgkmcnt(7)
    v_mfma_f32_16x16x32_bf16 v[76:79], v[176:179], v[136:139], v[76:79]
    ds_read_b128 v[176:179], v12 offset:27648
    v_mfma_f32_16x16x32_bf16 v[84:87], v[180:183], v[136:139], v[84:87]
    ds_read_b128 v[180:183], v12 offset:28672
    v_mfma_f32_16x16x32_bf16 v[92:95], v[184:187], v[136:139], v[92:95]
    ds_read_b128 v[184:187], v12 offset:29696
    buffer_load_dwordx4 v56, s[8:11], s85 offen offset:2048 sc1 lds
    v_mfma_f32_16x16x32_bf16 v[100:103], v[188:191], v[136:139], v[100:103]
    ds_read_b128 v[188:191], v12 offset:30720
    v_mfma_f32_16x16x32_bf16 v[108:111], v[192:195], v[136:139], v[108:111]
    ds_read_b128 v[192:195], v12 offset:31744
    s_waitcnt lgkmcnt(7)
    v_mfma_f32_16x16x32_bf16 v[116:119], v[196:199], v[136:139], v[116:119]
    ds_read_b128 v[196:199], v12 offset:32768
    v_mfma_f32_16x16x32_bf16 v[68:71], v[200:203], v[144:147], v[68:71]
    ds_read_b128 v[200:203], v12 offset:33792
    v_mfma_f32_16x16x32_bf16 v[76:79], v[204:207], v[144:147], v[76:79]
    ds_read_b128 v[204:207], v12 offset:34816
    buffer_load_dwordx4 v56, s[8:11], s85 offen offset:3072 sc1 lds
    v_mfma_f32_16x16x32_bf16 v[84:87], v[208:211], v[144:147], v[84:87]
    ds_read_b128 v[208:211], v12 offset:35840
    v_mfma_f32_16x16x32_bf16 v[92:95], v[212:215], v[144:147], v[92:95]
    ds_read_b128 v[212:215], v12 offset:36864
    s_waitcnt lgkmcnt(7)
    v_mfma_f32_16x16x32_bf16 v[100:103], v[216:219], v[144:147], v[100:103]
    ds_read_b128 v[216:219], v12 offset:37888
    v_mfma_f32_16x16x32_bf16 v[108:111], v[220:223], v[144:147], v[108:111]
    ds_read_b128 v[220:223], v12 offset:38912
    v_mfma_f32_16x16x32_bf16 v[116:119], v[176:179], v[144:147], v[116:119]
    ds_read_b128 v[176:179], v12 offset:39936
    s_add_u32 m0, s0, 122880
    v_mfma_f32_16x16x32_bf16 v[68:71], v[180:183], v[152:155], v[68:71]
    ds_read_b128 v[180:183], v12 offset:40960
    s_add_u32 s85, s86, 131072
    v_mfma_f32_16x16x32_bf16 v[76:79], v[184:187], v[152:155], v[76:79]
    ds_read_b128 v[184:187], v12 offset:41984
    s_waitcnt lgkmcnt(7)
    v_mfma_f32_16x16x32_bf16 v[84:87], v[188:191], v[152:155], v[84:87]
    ds_read_b128 v[188:191], v12 offset:43008
    buffer_load_dwordx4 v56, s[8:11], s85 offen offset:0 sc1 lds
    v_mfma_f32_16x16x32_bf16 v[92:95], v[192:195], v[152:155], v[92:95]
    ds_read_b128 v[192:195], v12 offset:44032
    v_mfma_f32_16x16x32_bf16 v[100:103], v[196:199], v[152:155], v[100:103]
    ds_read_b128 v[196:199], v12 offset:45056
    buffer_load_dwordx4 v56, s[8:11], s85 offen offset:1024 sc1 lds
    v_mfma_f32_16x16x32_bf16 v[108:111], v[200:203], v[152:155], v[108:111]
    ds_read_b128 v[200:203], v12 offset:46080
    v_mfma_f32_16x16x32_bf16 v[116:119], v[204:207], v[152:155], v[116:119]
    ds_read_b128 v[204:207], v12 offset:47104
    s_waitcnt lgkmcnt(7)
    v_mfma_f32_16x16x32_bf16 v[68:71], v[208:211], v[160:163], v[68:71]
    ds_read_b128 v[208:211], v12 offset:48128
    v_mfma_f32_16x16x32_bf16 v[76:79], v[212:215], v[160:163], v[76:79]
    ds_read_b128 v[212:215], v12 offset:49152
    v_mfma_f32_16x16x32_bf16 v[84:87], v[216:219], v[160:163], v[84:87]
    ds_read_b128 v[124:127], v14 offset:0
    ds_read_b128 v[132:135], v14 offset:64
    v_mfma_f32_16x16x32_bf16 v[92:95], v[220:223], v[160:163], v[92:95]
    ds_read_b128 v[140:143], v14 offset:128
    ds_read_b128 v[148:151], v14 offset:192
    v_mfma_f32_16x16x32_bf16 v[100:103], v[176:179], v[160:163], v[100:103]
    ds_read_b128 v[156:159], v14 offset:256
    s_waitcnt lgkmcnt(9)
    v_mfma_f32_16x16x32_bf16 v[108:111], v[180:183], v[160:163], v[108:111]
    ds_read_b128 v[164:167], v14 offset:320
    ds_read_b128 v[172:175], v14 offset:384
    v_mfma_f32_16x16x32_bf16 v[116:119], v[184:187], v[160:163], v[116:119]
    buffer_load_dwordx4 v56, s[8:11], s85 offen offset:2048 sc1 lds
    v_mfma_f32_16x16x32_bf16 v[68:71], v[188:191], v[168:171], v[68:71]
    buffer_load_dwordx4 v56, s[8:11], s85 offen offset:3072 sc1 lds
    v_mfma_f32_16x16x32_bf16 v[76:79], v[192:195], v[168:171], v[76:79]
    v_mfma_f32_16x16x32_bf16 v[84:87], v[196:199], v[168:171], v[84:87]
    s_waitcnt lgkmcnt(7)
    v_mfma_f32_16x16x32_bf16 v[92:95], v[200:203], v[168:171], v[92:95]
    v_mfma_f32_16x16x32_bf16 v[100:103], v[204:207], v[168:171], v[100:103]
    v_mfma_f32_16x16x32_bf16 v[108:111], v[208:211], v[168:171], v[108:111]
    s_add_u32 m0, s0, 139264
    s_add_u32 s85, s86, 147456
    v_mfma_f32_16x16x32_bf16 v[116:119], v[212:215], v[168:171], v[116:119]
    buffer_load_dwordx4 v56, s[8:11], s85 offen offset:0 sc1 lds
    buffer_load_dwordx4 v56, s[8:11], s85 offen offset:1024 sc1 lds
    s_waitcnt lgkmcnt(0)
    v_pk_fma_f32 v[68:69], v[124:125], v[18:19], v[68:69] op_sel:[0,1,0] op_sel_hi:[1,1,1]
    v_pk_fma_f32 v[70:71], v[126:127], v[18:19], v[70:71] op_sel:[0,1,0] op_sel_hi:[1,1,1]
    v_pk_mul_f32 v[176:177], v[68:69], v[68:69]
    v_pk_mul_f32 v[178:179], v[70:71], v[70:71]
    v_pk_fma_f32 v[176:177], v[176:177], v[16:17], v[16:17] op_sel:[0,0,1] op_sel_hi:[1,0,1]
    v_pk_fma_f32 v[178:179], v[178:179], v[16:17], v[16:17] op_sel:[0,0,1] op_sel_hi:[1,0,1]
    v_pk_mul_f32 v[176:177], v[176:177], v[68:69]
    v_pk_mul_f32 v[178:179], v[178:179], v[70:71]
    v_exp_f32 v176, v176
    v_exp_f32 v177, v177
    v_exp_f32 v178, v178
    v_exp_f32 v179, v179
    buffer_load_dwordx4 v56, s[8:11], s85 offen offset:2048 sc1 lds
    v_pk_fma_f32 v[176:177], v[176:177], v[18:19], v[18:19] op_sel_hi:[1,0,0]
    v_pk_fma_f32 v[178:179], v[178:179], v[18:19], v[18:19] op_sel_hi:[1,0,0]
    v_rcp_f32 v176, v176
    v_rcp_f32 v177, v177
    v_rcp_f32 v178, v178
    v_rcp_f32 v179, v179
    v_pk_mul_f32 v[68:69], v[68:69], v[176:177]
    v_pk_mul_f32 v[70:71], v[70:71], v[178:179]
    v_pk_add_f32 v[20:21], v[68:69], v[70:71]
    v_pk_mul_f32 v[22:23], v[68:69], v[68:69]
    v_pk_fma_f32 v[22:23], v[70:71], v[70:71], v[22:23]
    v_pk_fma_f32 v[76:77], v[132:133], v[18:19], v[76:77] op_sel:[0,1,0] op_sel_hi:[1,1,1]
    v_pk_fma_f32 v[78:79], v[134:135], v[18:19], v[78:79] op_sel:[0,1,0] op_sel_hi:[1,1,1]
    buffer_load_dwordx4 v56, s[8:11], s85 offen offset:3072 sc1 lds
    v_pk_mul_f32 v[176:177], v[76:77], v[76:77]
    v_pk_mul_f32 v[178:179], v[78:79], v[78:79]
    v_pk_fma_f32 v[176:177], v[176:177], v[16:17], v[16:17] op_sel:[0,0,1] op_sel_hi:[1,0,1]
    v_pk_fma_f32 v[178:179], v[178:179], v[16:17], v[16:17] op_sel:[0,0,1] op_sel_hi:[1,0,1]
    v_pk_mul_f32 v[176:177], v[176:177], v[76:77]
    v_pk_mul_f32 v[178:179], v[178:179], v[78:79]
    v_exp_f32 v176, v176
    v_exp_f32 v177, v177
    v_exp_f32 v178, v178
    v_exp_f32 v179, v179
    v_pk_fma_f32 v[176:177], v[176:177], v[18:19], v[18:19] op_sel_hi:[1,0,0]
    v_pk_fma_f32 v[178:179], v[178:179], v[18:19], v[18:19] op_sel_hi:[1,0,0]
    v_rcp_f32 v176, v176
    s_add_u32 m0, s92, 155648
    s_add_u32 s85, s61, 163840
    buffer_load_dwordx4 v56, s[8:11], s85 offen offset:0 sc1 lds
    v_rcp_f32 v177, v177
    v_rcp_f32 v178, v178
    v_rcp_f32 v179, v179
    v_pk_mul_f32 v[76:77], v[76:77], v[176:177]
    v_pk_mul_f32 v[78:79], v[78:79], v[178:179]
    v_pk_add_f32 v[20:21], v[20:21], v[76:77]
    v_pk_fma_f32 v[22:23], v[76:77], v[76:77], v[22:23]
    v_pk_add_f32 v[20:21], v[20:21], v[78:79]
    v_pk_fma_f32 v[22:23], v[78:79], v[78:79], v[22:23]
    v_pk_fma_f32 v[84:85], v[140:141], v[18:19], v[84:85] op_sel:[0,1,0] op_sel_hi:[1,1,1]
    v_pk_fma_f32 v[86:87], v[142:143], v[18:19], v[86:87] op_sel:[0,1,0] op_sel_hi:[1,1,1]
    v_pk_mul_f32 v[176:177], v[84:85], v[84:85]
    v_pk_mul_f32 v[178:179], v[86:87], v[86:87]
    buffer_load_dwordx4 v56, s[8:11], s85 offen offset:1024 sc1 lds
    v_pk_fma_f32 v[176:177], v[176:177], v[16:17], v[16:17] op_sel:[0,0,1] op_sel_hi:[1,0,1]
    v_pk_fma_f32 v[178:179], v[178:179], v[16:17], v[16:17] op_sel:[0,0,1] op_sel_hi:[1,0,1]
    v_pk_mul_f32 v[176:177], v[176:177], v[84:85]
    v_pk_mul_f32 v[178:179], v[178:179], v[86:87]
    v_exp_f32 v176, v176
    v_exp_f32 v177, v177
    v_exp_f32 v178, v178
    v_exp_f32 v179, v179
    v_pk_fma_f32 v[176:177], v[176:177], v[18:19], v[18:19] op_sel_hi:[1,0,0]
    v_pk_fma_f32 v[178:179], v[178:179], v[18:19], v[18:19] op_sel_hi:[1,0,0]
    v_rcp_f32 v176, v176
    v_rcp_f32 v177, v177
    v_rcp_f32 v178, v178
    s_add_u32 m0, s0, 0
    s_add_u32 s85, s86, 172032
    buffer_load_dwordx4 v56, s[8:11], s85 offen offset:0 sc1 lds
    v_rcp_f32 v179, v179
    v_pk_mul_f32 v[84:85], v[84:85], v[176:177]
    v_pk_mul_f32 v[86:87], v[86:87], v[178:179]
    v_pk_add_f32 v[20:21], v[20:21], v[84:85]
    v_pk_fma_f32 v[22:23], v[84:85], v[84:85], v[22:23]
    v_pk_add_f32 v[20:21], v[20:21], v[86:87]
    v_pk_fma_f32 v[22:23], v[86:87], v[86:87], v[22:23]
    v_pk_fma_f32 v[92:93], v[148:149], v[18:19], v[92:93] op_sel:[0,1,0] op_sel_hi:[1,1,1]
    v_pk_fma_f32 v[94:95], v[150:151], v[18:19], v[94:95] op_sel:[0,1,0] op_sel_hi:[1,1,1]
    v_pk_mul_f32 v[176:177], v[92:93], v[92:93]
    v_pk_mul_f32 v[178:179], v[94:95], v[94:95]
    v_pk_fma_f32 v[176:177], v[176:177], v[16:17], v[16:17] op_sel:[0,0,1] op_sel_hi:[1,0,1]
    v_pk_fma_f32 v[178:179], v[178:179], v[16:17], v[16:17] op_sel:[0,0,1] op_sel_hi:[1,0,1]
    buffer_load_dwordx4 v56, s[8:11], s85 offen offset:1024 sc1 lds
    v_pk_mul_f32 v[176:177], v[176:177], v[92:93]
    v_pk_mul_f32 v[178:179], v[178:179], v[94:95]
    v_exp_f32 v176, v176
    v_exp_f32 v177, v177
    v_exp_f32 v178, v178
    v_exp_f32 v179, v179
    v_pk_fma_f32 v[176:177], v[176:177], v[18:19], v[18:19] op_sel_hi:[1,0,0]
    v_pk_fma_f32 v[178:179], v[178:179], v[18:19], v[18:19] op_sel_hi:[1,0,0]
    v_rcp_f32 v176, v176
    v_rcp_f32 v177, v177
    v_rcp_f32 v178, v178
    v_rcp_f32 v179, v179
    v_pk_mul_f32 v[92:93], v[92:93], v[176:177]
    buffer_load_dwordx4 v56, s[8:11], s85 offen offset:2048 sc1 lds
    v_pk_mul_f32 v[94:95], v[94:95], v[178:179]
    v_pk_add_f32 v[20:21], v[20:21], v[92:93]
    v_pk_fma_f32 v[22:23], v[92:93], v[92:93], v[22:23]
    v_pk_add_f32 v[20:21], v[20:21], v[94:95]
    v_pk_fma_f32 v[22:23], v[94:95], v[94:95], v[22:23]
    v_pk_fma_f32 v[100:101], v[156:157], v[18:19], v[100:101] op_sel:[0,1,0] op_sel_hi:[1,1,1]
    v_pk_fma_f32 v[102:103], v[158:159], v[18:19], v[102:103] op_sel:[0,1,0] op_sel_hi:[1,1,1]
    v_pk_mul_f32 v[176:177], v[100:101], v[100:101]
    v_pk_mul_f32 v[178:179], v[102:103], v[102:103]
    v_pk_fma_f32 v[176:177], v[176:177], v[16:17], v[16:17] op_sel:[0,0,1] op_sel_hi:[1,0,1]
    v_pk_fma_f32 v[178:179], v[178:179], v[16:17], v[16:17] op_sel:[0,0,1] op_sel_hi:[1,0,1]
    v_pk_mul_f32 v[176:177], v[176:177], v[100:101]
    v_pk_mul_f32 v[178:179], v[178:179], v[102:103]
    buffer_load_dwordx4 v56, s[8:11], s85 offen offset:3072 sc1 lds
    v_exp_f32 v176, v176
    v_exp_f32 v177, v177
    v_exp_f32 v178, v178
    v_exp_f32 v179, v179
    v_pk_fma_f32 v[176:177], v[176:177], v[18:19], v[18:19] op_sel_hi:[1,0,0]
    v_pk_fma_f32 v[178:179], v[178:179], v[18:19], v[18:19] op_sel_hi:[1,0,0]
    v_rcp_f32 v176, v176
    v_rcp_f32 v177, v177
    v_rcp_f32 v178, v178
    v_rcp_f32 v179, v179
    v_pk_mul_f32 v[100:101], v[100:101], v[176:177]
    v_pk_mul_f32 v[102:103], v[102:103], v[178:179]
    v_pk_add_f32 v[20:21], v[20:21], v[100:101]
    s_add_u32 m0, s0, 16384
    s_add_u32 s85, s86, 188416
    buffer_load_dwordx4 v56, s[8:11], s85 offen offset:0 sc1 lds
    v_pk_fma_f32 v[22:23], v[100:101], v[100:101], v[22:23]
    v_pk_add_f32 v[20:21], v[20:21], v[102:103]
    v_pk_fma_f32 v[22:23], v[102:103], v[102:103], v[22:23]
    v_pk_fma_f32 v[108:109], v[164:165], v[18:19], v[108:109] op_sel:[0,1,0] op_sel_hi:[1,1,1]
    v_pk_fma_f32 v[110:111], v[166:167], v[18:19], v[110:111] op_sel:[0,1,0] op_sel_hi:[1,1,1]
    v_pk_mul_f32 v[176:177], v[108:109], v[108:109]
    v_pk_mul_f32 v[178:179], v[110:111], v[110:111]
    v_pk_fma_f32 v[176:177], v[176:177], v[16:17], v[16:17] op_sel:[0,0,1] op_sel_hi:[1,0,1]
    v_pk_fma_f32 v[178:179], v[178:179], v[16:17], v[16:17] op_sel:[0,0,1] op_sel_hi:[1,0,1]
    v_pk_mul_f32 v[176:177], v[176:177], v[108:109]
    v_pk_mul_f32 v[178:179], v[178:179], v[110:111]
    v_exp_f32 v176, v176
    v_exp_f32 v177, v177
    buffer_load_dwordx4 v56, s[8:11], s85 offen offset:1024 sc1 lds
    v_exp_f32 v178, v178
    v_exp_f32 v179, v179
    v_pk_fma_f32 v[176:177], v[176:177], v[18:19], v[18:19] op_sel_hi:[1,0,0]
    v_pk_fma_f32 v[178:179], v[178:179], v[18:19], v[18:19] op_sel_hi:[1,0,0]
    v_rcp_f32 v176, v176
    v_rcp_f32 v177, v177
    v_rcp_f32 v178, v178
    v_rcp_f32 v179, v179
    v_pk_mul_f32 v[108:109], v[108:109], v[176:177]
    v_pk_mul_f32 v[110:111], v[110:111], v[178:179]
    v_pk_add_f32 v[20:21], v[20:21], v[108:109]
    v_pk_fma_f32 v[22:23], v[108:109], v[108:109], v[22:23]
    v_pk_add_f32 v[20:21], v[20:21], v[110:111]
    v_pk_fma_f32 v[22:23], v[110:111], v[110:111], v[22:23]
    v_pk_fma_f32 v[116:117], v[172:173], v[18:19], v[116:117] op_sel:[0,1,0] op_sel_hi:[1,1,1]
    v_pk_fma_f32 v[118:119], v[174:175], v[18:19], v[118:119] op_sel:[0,1,0] op_sel_hi:[1,1,1]
    v_pk_mul_f32 v[176:177], v[116:117], v[116:117]
    v_pk_mul_f32 v[178:179], v[118:119], v[118:119]
    v_pk_fma_f32 v[176:177], v[176:177], v[16:17], v[16:17] op_sel:[0,0,1] op_sel_hi:[1,0,1]
    v_pk_fma_f32 v[178:179], v[178:179], v[16:17], v[16:17] op_sel:[0,0,1] op_sel_hi:[1,0,1]
    v_pk_mul_f32 v[176:177], v[176:177], v[116:117]
    v_pk_mul_f32 v[178:179], v[178:179], v[118:119]
    v_exp_f32 v176, v176
    v_exp_f32 v177, v177
    v_exp_f32 v178, v178
    v_exp_f32 v179, v179
    v_pk_fma_f32 v[176:177], v[176:177], v[18:19], v[18:19] op_sel_hi:[1,0,0]
    v_pk_fma_f32 v[178:179], v[178:179], v[18:19], v[18:19] op_sel_hi:[1,0,0]
    v_rcp_f32 v176, v176
    v_rcp_f32 v177, v177
    v_rcp_f32 v178, v178
    v_rcp_f32 v179, v179
    v_pk_mul_f32 v[116:117], v[116:117], v[176:177]
    v_pk_mul_f32 v[118:119], v[118:119], v[178:179]
    v_pk_add_f32 v[20:21], v[20:21], v[116:117]
    v_pk_fma_f32 v[22:23], v[116:117], v[116:117], v[22:23]
    v_pk_add_f32 v[20:21], v[20:21], v[118:119]
    v_pk_fma_f32 v[22:23], v[118:119], v[118:119], v[22:23]
    v_add_f32 v20, v20, v21
    v_add_f32 v22, v22, v23
    s_waitcnt vmcnt(20)
    s_nop 0
    v_permlane16_swap_b32 v20, v22
    v_add_f32 v20, v20, v22
    v_mov_b32 v22, v20
    s_nop 1
    v_permlane32_swap_b32 v20, v22
    v_add_f32 v20, v20, v22
    v_and_b32 v20, -2, v20
    s_mov_b32 exec_hi, 0
    buffer_store_dword v20, v248, s[8:11], s51 offen sc1
    s_mov_b32 exec_hi, -1
    s_waitcnt vmcnt(7)
    s_barrier
    ds_read_b128 v[176:179], v13 offset:0
    ds_read_b128 v[180:183], v13 offset:1024
    ds_read_b128 v[184:187], v13 offset:2048
    ds_read_b128 v[188:191], v13 offset:3072
    ds_read_b128 v[192:195], v13 offset:4096
    ds_read_b128 v[196:199], v13 offset:5120
    ds_read_b128 v[200:203], v13 offset:6144
    ds_read_b128 v[204:207], v13 offset:7168
    ds_read_b128 v[208:211], v13 offset:8192
    ds_read_b128 v[212:215], v13 offset:9216
    s_waitcnt lgkmcnt(8)
    v_mfma_f32_16x16x32_bf16 v[124:127], v[176:179], v[64:67], 0
    ds_read_b128 v[216:219], v13 offset:10240
    v_mfma_f32_16x16x32_bf16 v[132:135], v[180:183], v[64:67], 0
    ds_read_b128 v[220:223], v13 offset:11264
    s_waitcnt lgkmcnt(8)
    v_mfma_f32_16x16x32_bf16 v[140:143], v[184:187], v[64:67], 0
    ds_read_b128 v[176:179], v13 offset:12288
    buffer_load_dwordx4 v56, s[8:11], s85 offen offset:2048 sc1 lds
    v_mfma_f32_16x16x32_bf16 v[148:151], v[188:191], v[64:67], 0
    ds_read_b128 v[180:183], v13 offset:13312
    s_waitcnt lgkmcnt(8)
    v_mfma_f32_16x16x32_bf16 v[156:159], v[192:195], v[64:67], 0
    ds_read_b128 v[184:187], v13 offset:14336
    v_mfma_f32_16x16x32_bf16 v[164:167], v[196:199], v[64:67], 0
    ds_read_b128 v[188:191], v13 offset:15360
    s_waitcnt lgkmcnt(8)
    v_mfma_f32_16x16x32_bf16 v[172:175], v[200:203], v[64:67], 0
    ds_read_b128 v[192:195], v13 offset:16384
    v_mfma_f32_16x16x32_bf16 v[124:127], v[204:207], v[72:75], v[124:127]
    ds_read_b128 v[196:199], v13 offset:17408
    s_waitcnt lgkmcnt(8)
    v_mfma_f32_16x16x32_bf16 v[132:135], v[208:211], v[72:75], v[132:135]
    ds_read_b128 v[200:203], v13 offset:18432
    buffer_load_dwordx4 v56, s[8:11], s85 offen offset:3072 sc1 lds
    v_mfma_f32_16x16x32_bf16 v[140:143], v[212:215], v[72:75], v[140:143]
    ds_read_b128 v[204:207], v13 offset:19456
    s_waitcnt lgkmcnt(8)
    v_mfma_f32_16x16x32_bf16 v[148:151], v[216:219], v[72:75], v[148:151]
    ds_read_b128 v[208:211], v13 offset:20480
    v_mfma_f32_16x16x32_bf16 v[156:159], v[220:223], v[72:75], v[156:159]
    ds_read_b128 v[212:215], v13 offset:21504
    s_waitcnt lgkmcnt(8)
    v_mfma_f32_16x16x32_bf16 v[164:167], v[176:179], v[72:75], v[164:167]
    ds_read_b128 v[216:219], v13 offset:22528
    s_add_u32 m0, s92, 32768
    v_mfma_f32_16x16x32_bf16 v[172:175], v[180:183], v[72:75], v[172:175]
    ds_read_b128 v[220:223], v13 offset:23552
    s_waitcnt lgkmcnt(8)
    v_mfma_f32_16x16x32_bf16 v[124:127], v[184:187], v[80:83], v[124:127]
    ds_read_b128 v[176:179], v13 offset:24576
    s_add_u32 s85, s61, 204800
    v_mfma_f32_16x16x32_bf16 v[132:135], v[188:191], v[80:83], v[132:135]
    ds_read_b128 v[180:183], v13 offset:25600
    s_waitcnt lgkmcnt(8)
    v_mfma_f32_16x16x32_bf16 v[140:143], v[192:195], v[80:83], v[140:143]
    ds_read_b128 v[184:187], v13 offset:26624
    buffer_load_dwordx4 v56, s[8:11], s85 offen offset:0 sc1 lds
    v_mfma_f32_16x16x32_bf16 v[148:151], v[196:199], v[80:83], v[148:151]
    ds_read_b128 v[188:191], v13 offset:27648
    s_waitcnt lgkmcnt(8)
    v_mfma_f32_16x16x32_bf16 v[156:159], v[200:203], v[80:83], v[156:159]
    ds_read_b128 v[192:195], v13 offset:28672
    buffer_load_dwordx4 v56, s[8:11], s85 offen offset:1024 sc1 lds
    v_mfma_f32_16x16x32_bf16 v[164:167], v[204:207], v[80:83], v[164:167]
    ds_read_b128 v[196:199], v13 offset:29696
    s_waitcnt lgkmcnt(8)
    v_mfma_f32_16x16x32_bf16 v[172:175], v[208:211], v[80:83], v[172:175]
    ds_read_b128 v[200:203], v13 offset:30720
    v_mfma_f32_16x16x32_bf16 v[124:127], v[212:215], v[88:91], v[124:127]
    ds_read_b128 v[204:207], v13 offset:31744
    s_waitcnt lgkmcnt(8)
    v_mfma_f32_16x16x32_bf16 v[132:135], v[216:219], v[88:91], v[132:135]
    ds_read_b128 v[208:211], v13 offset:32768
    s_add_u32 m0, s91, 40960
    v_mfma_f32_16x16x32_bf16 v[140:143], v[220:223], v[88:91], v[140:143]
    ds_read_b128 v[212:215], v13 offset:33792
    s_waitcnt lgkmcnt(8)
    v_mfma_f32_16x16x32_bf16 v[148:151], v[176:179], v[88:91], v[148:151]
    ds_read_b128 v[216:219], v13 offset:34816
    s_add_u32 s85, s60, 212992
    v_mfma_f32_16x16x32_bf16 v[156:159], v[180:183], v[88:91], v[156:159]
    ds_read_b128 v[220:223], v13 offset:35840
    s_waitcnt lgkmcnt(8)
    v_mfma_f32_16x16x32_bf16 v[164:167], v[184:187], v[88:91], v[164:167]
    ds_read_b128 v[176:179], v13 offset:36864
    buffer_load_dwordx4 v56, s[8:11], s85 offen offset:0 sc1 lds
    v_mfma_f32_16x16x32_bf16 v[172:175], v[188:191], v[88:91], v[172:175]
    ds_read_b128 v[180:183], v13 offset:37888
    s_waitcnt lgkmcnt(8)
    v_mfma_f32_16x16x32_bf16 v[124:127], v[192:195], v[96:99], v[124:127]
    ds_read_b128 v[184:187], v13 offset:38912
    s_add_u32 m0, s0, 49152
    v_mfma_f32_16x16x32_bf16 v[132:135], v[196:199], v[96:99], v[132:135]
    ds_read_b128 v[188:191], v13 offset:39936
    s_waitcnt lgkmcnt(8)
    v_mfma_f32_16x16x32_bf16 v[140:143], v[200:203], v[96:99], v[140:143]
    ds_read_b128 v[192:195], v13 offset:40960
    s_add_u32 s85, s99, 0
    v_mfma_f32_16x16x32_bf16 v[148:151], v[204:207], v[96:99], v[148:151]
    ds_read_b128 v[196:199], v13 offset:41984
    s_waitcnt lgkmcnt(8)
    v_mfma_f32_16x16x32_bf16 v[156:159], v[208:211], v[96:99], v[156:159]
    ds_read_b128 v[200:203], v13 offset:43008
    buffer_load_dwordx4 v56, s[8:11], s85 offen offset:0 sc1 lds
    v_mfma_f32_16x16x32_bf16 v[164:167], v[212:215], v[96:99], v[164:167]
    ds_read_b128 v[204:207], v13 offset:44032
    s_waitcnt lgkmcnt(8)
    v_mfma_f32_16x16x32_bf16 v[172:175], v[216:219], v[96:99], v[172:175]
    ds_read_b128 v[208:211], v13 offset:45056
    v_mfma_f32_16x16x32_bf16 v[124:127], v[220:223], v[104:107], v[124:127]
    ds_read_b128 v[212:215], v13 offset:46080
    s_waitcnt lgkmcnt(8)
    v_mfma_f32_16x16x32_bf16 v[132:135], v[176:179], v[104:107], v[132:135]
    ds_read_b128 v[216:219], v13 offset:47104
    buffer_load_dwordx2 v[20:21], v249, s[8:11], s89 offen sc1
    v_mfma_f32_16x16x32_bf16 v[140:143], v[180:183], v[104:107], v[140:143]
    ds_read_b128 v[220:223], v13 offset:48128
    s_waitcnt lgkmcnt(8)
    v_mfma_f32_16x16x32_bf16 v[148:151], v[184:187], v[104:107], v[148:151]
    ds_read_b128 v[176:179], v13 offset:49152
    buffer_load_dwordx2 v[22:23], v249, s[8:11], s89 offen offset:128 sc1
    v_mfma_f32_16x16x32_bf16 v[156:159], v[188:191], v[104:107], v[156:159]
    ds_read_b128 v[180:183], v13 offset:50176
    s_waitcnt lgkmcnt(8)
    v_mfma_f32_16x16x32_bf16 v[164:167], v[192:195], v[104:107], v[164:167]
    ds_read_b128 v[184:187], v13 offset:51200
    buffer_load_dwordx4 v56, s[8:11], s85 offen offset:1024 sc1 lds
    v_mfma_f32_16x16x32_bf16 v[172:175], v[196:199], v[104:107], v[172:175]
    ds_read_b128 v[188:191], v13 offset:52224
    s_waitcnt lgkmcnt(8)
    v_mfma_f32_16x16x32_bf16 v[124:127], v[200:203], v[112:115], v[124:127]
    ds_read_b128 v[192:195], v13 offset:53248
    v_mfma_f32_16x16x32_bf16 v[132:135], v[204:207], v[112:115], v[132:135]
    ds_read_b128 v[196:199], v13 offset:54272
    s_waitcnt lgkmcnt(8)
    v_mfma_f32_16x16x32_bf16 v[140:143], v[208:211], v[112:115], v[140:143]
    ds_read_b128 v[200:203], v13 offset:55296
    buffer_load_dwordx4 v56, s[8:11], s85 offen offset:2048 sc1 lds
    v_mfma_f32_16x16x32_bf16 v[148:151], v[212:215], v[112:115], v[148:151]
    ds_read_b128 v[204:207], v13 offset:56320
    s_waitcnt lgkmcnt(8)
    v_mfma_f32_16x16x32_bf16 v[156:159], v[216:219], v[112:115], v[156:159]
    s_waitcnt vmcnt(13)
    s_barrier
    ds_read_b128 v[208:211], v56 offset:0
    v_mfma_f32_16x16x32_bf16 v[164:167], v[220:223], v[112:115], v[164:167]
    ds_read_b128 v[212:215], v56 offset:1024
    s_waitcnt lgkmcnt(8)
    v_mfma_f32_16x16x32_bf16 v[172:175], v[176:179], v[112:115], v[172:175]
    ds_read_b128 v[216:219], v56 offset:2048
    buffer_load_dwordx4 v56, s[8:11], s85 offen offset:3072 sc1 lds
    v_mfma_f32_16x16x32_bf16 v[124:127], v[180:183], v[120:123], v[124:127]
    ds_read_b128 v[220:223], v56 offset:3072
    s_waitcnt lgkmcnt(8)
    v_mfma_f32_16x16x32_bf16 v[132:135], v[184:187], v[120:123], v[132:135]
    ds_read_b128 v[176:179], v56 offset:4096
    v_mfma_f32_16x16x32_bf16 v[140:143], v[188:191], v[120:123], v[140:143]
    ds_read_b128 v[180:183], v56 offset:5120
    s_waitcnt lgkmcnt(8)
    v_mfma_f32_16x16x32_bf16 v[148:151], v[192:195], v[120:123], v[148:151]
    ds_read_b128 v[184:187], v56 offset:6144
    v_mfma_f32_16x16x32_bf16 v[156:159], v[196:199], v[120:123], v[156:159]
    s_add_u32 m0, s0, 65536
    s_waitcnt lgkmcnt(7)
    v_mfma_f32_16x16x32_bf16 v[164:167], v[200:203], v[120:123], v[164:167]
    s_add_u32 s85, s99, 32768
    buffer_load_dwordx4 v56, s[8:11], s85 offen offset:0 sc1 lds
    v_mfma_f32_16x16x32_bf16 v[172:175], v[204:207], v[120:123], v[172:175]
    s_waitcnt lgkmcnt(5)
    v_mfma_f32_16x16x32_bf16 v[124:127], v[208:211], v[128:131], v[124:127]
    v_mfma_f32_16x16x32_bf16 v[132:135], v[212:215], v[128:131], v[132:135]
    s_waitcnt lgkmcnt(3)
    v_mfma_f32_16x16x32_bf16 v[140:143], v[216:219], v[128:131], v[140:143]
    buffer_load_dwordx4 v56, s[8:11], s85 offen offset:1024 sc1 lds
    v_mfma_f32_16x16x32_bf16 v[148:151], v[220:223], v[128:131], v[148:151]
    s_waitcnt lgkmcnt(1)
    v_mfma_f32_16x16x32_bf16 v[156:159], v[176:179], v[128:131], v[156:159]
    s_barrier
    v_mfma_f32_16x16x32_bf16 v[164:167], v[180:183], v[128:131], v[164:167]
    s_waitcnt lgkmcnt(0)
    v_mfma_f32_16x16x32_bf16 v[172:175], v[184:187], v[128:131], v[172:175]
    s_waitcnt vmcnt(5)
    s_mov_b32 s98, 0
interleave_layers__spectral_fnet__mixer_gmlp__prompt_kernel_st_6:
    v_max3_u32 v252, v20, v21, v22
    v_max_u32 v252, v252, v23
    v_cmp_eq_u32 vcc, -1, v252
    s_cbranch_vccz interleave_layers__spectral_fnet__mixer_gmlp__prompt_kernel_st_6_x
    s_add_u32 s98, s98, 1
    s_cmp_gt_u32 s98, 1048576
    s_cbranch_scc1 interleave_layers__spectral_fnet__mixer_gmlp__prompt_kernel_st_6_x
    buffer_load_dwordx2 v[20:21], v249, s[8:11], s89 offen sc1
    buffer_load_dwordx2 v[22:23], v249, s[8:11], s89 offen offset:128 sc1
    s_waitcnt vmcnt(0)
    s_branch interleave_layers__spectral_fnet__mixer_gmlp__prompt_kernel_st_6
interleave_layers__spectral_fnet__mixer_gmlp__prompt_kernel_st_6_x:
    v_pk_add_f32 v[20:21], v[20:21], v[22:23]
    s_nop 1
    v_permlane16_swap_b32 v20, v21
    v_add_f32 v20, v20, v21
    v_mov_b32 v21, v20
    s_nop 1
    v_permlane32_swap_b32 v20, v21
    v_add_f32 v20, v20, v21
    v_mov_b32 v21, v20
    s_nop 1
    v_permlane16_swap_b32 v20, v21
    v_mul_f32 v20, 0x3a924925, v20
    v_mul_f32 v21, 0x3a924925, v21
    v_fma_f32 v21, -v20, v20, v21
    v_max_f32 v21, 0, v21
    v_add_f32 v21, 0x3727c5ac, v21
    v_rsq_f32 v21, v21
    s_nop 0
    v_mul_f32 v20, -v20, v21
    v_pk_fma_f32 v[68:69], v[68:69], v[20:21], v[20:21] op_sel:[0,1,0] op_sel_hi:[1,1,0]
    v_pk_fma_f32 v[70:71], v[70:71], v[20:21], v[20:21] op_sel:[0,1,0] op_sel_hi:[1,1,0]
    v_cvt_pk_bf16_f32 v68, v68, v69
    v_cvt_pk_bf16_f32 v69, v70, v71
    ds_write_b64 v244, v[68:69] offset:0
    v_pk_fma_f32 v[76:77], v[76:77], v[20:21], v[20:21] op_sel:[0,1,0] op_sel_hi:[1,1,0]
    v_pk_fma_f32 v[78:79], v[78:79], v[20:21], v[20:21] op_sel:[0,1,0] op_sel_hi:[1,1,0]
    v_cvt_pk_bf16_f32 v76, v76, v77
    v_cvt_pk_bf16_f32 v77, v78, v79
    ds_write_b64 v244, v[76:77] offset:512
    ds_read_b64_tr_b16 v[176:177], v245 offset:0
    ds_read_b64_tr_b16 v[178:179], v246 offset:256
    v_pk_fma_f32 v[84:85], v[84:85], v[20:21], v[20:21] op_sel:[0,1,0] op_sel_hi:[1,1,0]
    v_pk_fma_f32 v[86:87], v[86:87], v[20:21], v[20:21] op_sel:[0,1,0] op_sel_hi:[1,1,0]
    v_cvt_pk_bf16_f32 v84, v84, v85
    v_cvt_pk_bf16_f32 v85, v86, v87
    ds_write_b64 v244, v[84:85] offset:1024
    v_pk_fma_f32 v[92:93], v[92:93], v[20:21], v[20:21] op_sel:[0,1,0] op_sel_hi:[1,1,0]
    v_pk_fma_f32 v[94:95], v[94:95], v[20:21], v[20:21] op_sel:[0,1,0] op_sel_hi:[1,1,0]
    v_cvt_pk_bf16_f32 v92, v92, v93
    v_cvt_pk_bf16_f32 v93, v94, v95
    ds_write_b64 v244, v[92:93] offset:1536
    ds_read_b64_tr_b16 v[180:181], v245 offset:1024
    ds_read_b64_tr_b16 v[182:183], v246 offset:1280
    s_waitcnt lgkmcnt(4)
    s_add_u32 s80, s58, 0
    buffer_store_dwordx4 v[176:179], v247, s[8:11], s80 offen sc1
    v_pk_fma_f32 v[100:101], v[100:101], v[20:21], v[20:21] op_sel:[0,1,0] op_sel_hi:[1,1,0]
    v_pk_fma_f32 v[102:103], v[102:103], v[20:21], v[20:21] op_sel:[0,1,0] op_sel_hi:[1,1,0]
    v_cvt_pk_bf16_f32 v100, v100, v101
    v_cvt_pk_bf16_f32 v101, v102, v103
    ds_write_b64 v244, v[100:101] offset:2048
    v_pk_fma_f32 v[108:109], v[108:109], v[20:21], v[20:21] op_sel:[0,1,0] op_sel_hi:[1,1,0]
    v_pk_fma_f32 v[110:111], v[110:111], v[20:21], v[20:21] op_sel:[0,1,0] op_sel_hi:[1,1,0]
    v_cvt_pk_bf16_f32 v108, v108, v109
    v_cvt_pk_bf16_f32 v109, v110, v111
    ds_write_b64 v244, v[108:109] offset:2560
    ds_read_b64_tr_b16 v[184:185], v245 offset:2048
    ds_read_b64_tr_b16 v[186:187], v246 offset:2304
    s_waitcnt lgkmcnt(4)
    s_add_u32 s80, s58, 131072
    buffer_store_dwordx4 v[180:183], v247, s[8:11], s80 offen sc1
    v_pk_fma_f32 v[116:117], v[116:117], v[20:21], v[20:21] op_sel:[0,1,0] op_sel_hi:[1,1,0]
    v_pk_fma_f32 v[118:119], v[118:119], v[20:21], v[20:21] op_sel:[0,1,0] op_sel_hi:[1,1,0]
    v_cvt_pk_bf16_f32 v116, v116, v117
    v_cvt_pk_bf16_f32 v117, v118, v119
    ds_write_b64 v244, v[116:117] offset:3072
    ds_read_b64_tr_b16 v[188:189], v245 offset:3072
    ds_read_b64_tr_b16 v[190:191], v246 offset:3328
    s_waitcnt lgkmcnt(3)
    s_add_u32 s80, s58, 262144
    buffer_store_dwordx4 v[184:187], v247, s[8:11], s80 offen sc1
    s_waitcnt lgkmcnt(0)
    s_add_u32 s80, s58, 393216
    s_mov_b32 exec_hi, 0
    buffer_store_dwordx4 v[188:191], v247, s[8:11], s80 offen sc1
    s_mov_b32 exec_hi, -1
    s_barrier
    ds_read_b128 v[192:195], v56 offset:7168
    ds_read_b128 v[196:199], v56 offset:8192
    ds_read_b128 v[200:203], v56 offset:9216
    ds_read_b128 v[204:207], v56 offset:10240
    ds_read_b128 v[208:211], v56 offset:11264
    ds_read_b128 v[212:215], v56 offset:12288
    ds_read_b128 v[216:219], v56 offset:13312
    ds_read_b128 v[220:223], v56 offset:14336
    s_waitcnt lgkmcnt(6)
    v_mfma_f32_16x16x32_bf16 v[124:127], v[192:195], v[136:139], v[124:127]
    ds_read_b128 v[176:179], v56 offset:15360
    ds_read_b128 v[180:183], v56 offset:16384
    v_mfma_f32_16x16x32_bf16 v[132:135], v[196:199], v[136:139], v[132:135]
    ds_read_b128 v[184:187], v56 offset:17408
    s_waitcnt lgkmcnt(7)
    v_mfma_f32_16x16x32_bf16 v[140:143], v[200:203], v[136:139], v[140:143]
    ds_read_b128 v[188:191], v56 offset:18432
    buffer_load_dwordx4 v56, s[8:11], s85 offen offset:2048 sc1 lds
    v_mfma_f32_16x16x32_bf16 v[148:151], v[204:207], v[136:139], v[148:151]
    ds_read_b128 v[192:195], v56 offset:19456
    s_waitcnt lgkmcnt(7)
    v_mfma_f32_16x16x32_bf16 v[156:159], v[208:211], v[136:139], v[156:159]
    ds_read_b128 v[196:199], v56 offset:20480
    buffer_load_dwordx4 v56, s[8:11], s85 offen offset:3072 sc1 lds
    v_mfma_f32_16x16x32_bf16 v[164:167], v[212:215], v[136:139], v[164:167]
    ds_read_b128 v[200:203], v56 offset:21504
    s_waitcnt lgkmcnt(7)
    v_mfma_f32_16x16x32_bf16 v[172:175], v[216:219], v[136:139], v[172:175]
    ds_read_b128 v[204:207], v56 offset:22528
    s_add_u32 m0, s0, 81920
    v_mfma_f32_16x16x32_bf16 v[124:127], v[220:223], v[144:147], v[124:127]
    ds_read_b128 v[208:211], v56 offset:23552
    s_waitcnt lgkmcnt(7)
    v_mfma_f32_16x16x32_bf16 v[132:135], v[176:179], v[144:147], v[132:135]
    ds_read_b128 v[212:215], v56 offset:24576
    s_add_u32 s85, s99, 65536
    v_mfma_f32_16x16x32_bf16 v[140:143], v[180:183], v[144:147], v[140:143]
    ds_read_b128 v[216:219], v56 offset:25600
    s_waitcnt lgkmcnt(7)
    v_mfma_f32_16x16x32_bf16 v[148:151], v[184:187], v[144:147], v[148:151]
    ds_read_b128 v[220:223], v56 offset:26624
    buffer_load_dwordx4 v56, s[8:11], s85 offen offset:0 sc1 lds
    v_mfma_f32_16x16x32_bf16 v[156:159], v[188:191], v[144:147], v[156:159]
    ds_read_b128 v[176:179], v56 offset:27648
    s_waitcnt lgkmcnt(7)
    v_mfma_f32_16x16x32_bf16 v[164:167], v[192:195], v[144:147], v[164:167]
    ds_read_b128 v[180:183], v56 offset:28672
    buffer_load_dwordx4 v56, s[8:11], s85 offen offset:1024 sc1 lds
    v_mfma_f32_16x16x32_bf16 v[172:175], v[196:199], v[144:147], v[172:175]
    ds_read_b128 v[184:187], v56 offset:29696
    s_waitcnt lgkmcnt(7)
    v_mfma_f32_16x16x32_bf16 v[124:127], v[200:203], v[152:155], v[124:127]
    ds_read_b128 v[188:191], v56 offset:30720
    buffer_load_dwordx4 v56, s[8:11], s85 offen offset:2048 sc1 lds
    v_mfma_f32_16x16x32_bf16 v[132:135], v[204:207], v[152:155], v[132:135]
    ds_read_b128 v[192:195], v56 offset:31744
    s_waitcnt lgkmcnt(7)
    v_mfma_f32_16x16x32_bf16 v[140:143], v[208:211], v[152:155], v[140:143]
    ds_read_b128 v[196:199], v56 offset:32768
    buffer_load_dwordx4 v56, s[8:11], s85 offen offset:3072 sc1 lds
    v_mfma_f32_16x16x32_bf16 v[148:151], v[212:215], v[152:155], v[148:151]
    ds_read_b128 v[200:203], v56 offset:33792
    s_waitcnt lgkmcnt(7)
    v_mfma_f32_16x16x32_bf16 v[156:159], v[216:219], v[152:155], v[156:159]
    ds_read_b128 v[204:207], v56 offset:34816
    s_add_u32 m0, s0, 114688
    v_mfma_f32_16x16x32_bf16 v[164:167], v[220:223], v[152:155], v[164:167]
    ds_read_b128 v[208:211], v56 offset:35840
    s_waitcnt lgkmcnt(7)
    v_mfma_f32_16x16x32_bf16 v[172:175], v[176:179], v[152:155], v[172:175]
    ds_read_b128 v[212:215], v56 offset:36864
    s_add_u32 s85, s99, 131072
    v_mfma_f32_16x16x32_bf16 v[124:127], v[180:183], v[160:163], v[124:127]
    ds_read_b128 v[216:219], v56 offset:37888
    s_waitcnt lgkmcnt(7)
    v_mfma_f32_16x16x32_bf16 v[132:135], v[184:187], v[160:163], v[132:135]
    ds_read_b128 v[220:223], v56 offset:38912
    buffer_load_dwordx4 v56, s[8:11], s85 offen offset:0 sc1 lds
    v_mfma_f32_16x16x32_bf16 v[140:143], v[188:191], v[160:163], v[140:143]
    ds_read_b128 v[176:179], v56 offset:39936
    s_waitcnt lgkmcnt(7)
    v_mfma_f32_16x16x32_bf16 v[148:151], v[192:195], v[160:163], v[148:151]
    ds_read_b128 v[180:183], v56 offset:40960
    buffer_load_dwordx4 v56, s[8:11], s85 offen offset:1024 sc1 lds
    v_mfma_f32_16x16x32_bf16 v[156:159], v[196:199], v[160:163], v[156:159]
    ds_read_b128 v[184:187], v56 offset:41984
    s_waitcnt lgkmcnt(7)
    v_mfma_f32_16x16x32_bf16 v[164:167], v[200:203], v[160:163], v[164:167]
    ds_read_b128 v[68:71], v14 offset:448
    ds_read_b128 v[76:79], v14 offset:512
    v_mfma_f32_16x16x32_bf16 v[172:175], v[204:207], v[160:163], v[172:175]
    ds_read_b128 v[84:87], v14 offset:576
    ds_read_b128 v[92:95], v14 offset:640
    s_waitcnt lgkmcnt(9)
    v_mfma_f32_16x16x32_bf16 v[124:127], v[208:211], v[168:171], v[124:127]
    ds_read_b128 v[100:103], v14 offset:704
    ds_read_b128 v[108:111], v14 offset:768
    ds_read_b128 v[116:119], v14 offset:832
    v_mfma_f32_16x16x32_bf16 v[132:135], v[212:215], v[168:171], v[132:135]
    s_waitcnt lgkmcnt(10)
    v_mfma_f32_16x16x32_bf16 v[140:143], v[216:219], v[168:171], v[140:143]
    v_mfma_f32_16x16x32_bf16 v[148:151], v[220:223], v[168:171], v[148:151]
    s_waitcnt lgkmcnt(8)
    v_mfma_f32_16x16x32_bf16 v[156:159], v[176:179], v[168:171], v[156:159]
    v_mfma_f32_16x16x32_bf16 v[164:167], v[180:183], v[168:171], v[164:167]
    s_waitcnt lgkmcnt(7)
    v_mfma_f32_16x16x32_bf16 v[172:175], v[184:187], v[168:171], v[172:175]
    s_waitcnt lgkmcnt(0)
    s_lshl_b32 s84, s63, 7
    v_lshlrev_b32 v236, 10, v0
    v_bfe_u32 v237, s26, v0, 1
    v_lshl_add_u32 v236, v237, 13, v236
    v_mov_b32 v237, 1
    s_waitcnt vmcnt(8)
    s_barrier
    s_mov_b64 exec, s[46:47]
    buffer_atomic_add v237, v236, s[8:11], s84 offen sc1
    s_mov_b64 exec, -1
    buffer_load_dwordx4 v56, s[8:11], s85 offen offset:2048 sc1 lds
    v_pk_fma_f32 v[124:125], v[68:69], v[18:19], v[124:125] op_sel:[0,1,0] op_sel_hi:[1,1,1]
    v_pk_fma_f32 v[126:127], v[70:71], v[18:19], v[126:127] op_sel:[0,1,0] op_sel_hi:[1,1,1]
    v_pk_fma_f32 v[132:133], v[76:77], v[18:19], v[132:133] op_sel:[0,1,0] op_sel_hi:[1,1,1]
    v_pk_fma_f32 v[134:135], v[78:79], v[18:19], v[134:135] op_sel:[0,1,0] op_sel_hi:[1,1,1]
    v_pk_fma_f32 v[140:141], v[84:85], v[18:19], v[140:141] op_sel:[0,1,0] op_sel_hi:[1,1,1]
    buffer_load_dwordx4 v56, s[8:11], s85 offen offset:3072 sc1 lds
    v_pk_fma_f32 v[142:143], v[86:87], v[18:19], v[142:143] op_sel:[0,1,0] op_sel_hi:[1,1,1]
    v_pk_fma_f32 v[148:149], v[92:93], v[18:19], v[148:149] op_sel:[0,1,0] op_sel_hi:[1,1,1]
    v_pk_fma_f32 v[150:151], v[94:95], v[18:19], v[150:151] op_sel:[0,1,0] op_sel_hi:[1,1,1]
    v_pk_fma_f32 v[156:157], v[100:101], v[18:19], v[156:157] op_sel:[0,1,0] op_sel_hi:[1,1,1]
    s_add_u32 m0, s0, 131072
    s_add_u32 s85, s99, 163840
    buffer_load_dwordx4 v56, s[8:11], s85 offen offset:0 sc1 lds
    v_pk_fma_f32 v[158:159], v[102:103], v[18:19], v[158:159] op_sel:[0,1,0] op_sel_hi:[1,1,1]
    v_pk_fma_f32 v[164:165], v[108:109], v[18:19], v[164:165] op_sel:[0,1,0] op_sel_hi:[1,1,1]
    v_pk_fma_f32 v[166:167], v[110:111], v[18:19], v[166:167] op_sel:[0,1,0] op_sel_hi:[1,1,1]
    v_pk_fma_f32 v[172:173], v[116:117], v[18:19], v[172:173] op_sel:[0,1,0] op_sel_hi:[1,1,1]
    buffer_load_dwordx4 v56, s[8:11], s85 offen offset:1024 sc1 lds
    v_pk_fma_f32 v[174:175], v[118:119], v[18:19], v[174:175] op_sel:[0,1,0] op_sel_hi:[1,1,1]
    s_mul_i32 s76, s62, 16384
    v_add_u32 v8, s76, v56
    s_add_u32 s76, s76, 393468
    buffer_load_dwordx4 v56, s[8:11], s85 offen offset:2048 sc1 lds
    v_lshl_add_u32 v14, v0, 8, s76
    s_add_u32 s77, s62, 1
    s_and_b32 s77, s77, 3
    s_mul_i32 s77, s77, 3072
    buffer_load_dwordx4 v56, s[8:11], s85 offen offset:3072 sc1 lds
    s_add_u32 s77, s77, 0
    v_add_u32 v9, s77, v56
    s_add_u32 s77, s62, 2
    s_and_b32 s77, s77, 3
    s_add_u32 m0, s0, 147456
    s_add_u32 s85, s99, 196608
    buffer_load_dwordx4 v56, s[8:11], s85 offen offset:0 sc1 lds
    s_mul_i32 s77, s77, 3072
    s_add_u32 s77, s77, 1024
    v_add_u32 v10, s77, v56
    s_add_u32 s77, s62, 3
    buffer_load_dwordx4 v56, s[8:11], s85 offen offset:1024 sc1 lds
    s_and_b32 s77, s77, 3
    s_mul_i32 s77, s77, 3072
    s_add_u32 s77, s77, 2048
    v_add_u32 v11, s77, v56
    buffer_load_dwordx4 v56, s[8:11], s85 offen offset:2048 sc1 lds
    s_add_u32 s77, s93, 0
    v_add_u32 v12, s77, v56
    v_add_u32 v13, 106496, v56
    s_lshl_b32 s76, s67, 3
    buffer_load_dwordx4 v56, s[8:11], s85 offen offset:3072 sc1 lds
    s_add_u32 s76, s76, s63
    s_lshl_b32 s76, s76, 7
    s_add_u32 s76, s76, s27
    v_mov_b32 v238, s76
    s_min_u32 s83, s63, 6
    s_lshl_b32 s77, s83, 4
    s_set_gpr_idx_on s77, gpr_idx(SRC0)
    v_mov_b32 v176, v58
    v_mov_b32 v177, v59
    v_mov_b32 v178, v64
    v_mov_b32 v179, v65
    v_mov_b32 v180, v66
    v_mov_b32 v181, v67
    v_mov_b32 v182, v72
    v_mov_b32 v183, v73
    v_mov_b32 v184, v74
    v_mov_b32 v185, v75
    s_set_gpr_idx_off
    s_lshl_b32 s83, s83, 6
    s_sub_u32 s83, 224, s83
    s_mul_i32 s77, s62, 2560
    s_add_u32 s77, s77, 24576
    v_mul_u32_u24 v21, 160, v1
    v_add_u32 v21, s77, v21
    v_lshlrev_b32 v22, 3, v2
    v_add_u32 v23, v22, v21
    ds_write_b64 v23, v[176:177] offset:0
    ds_write_b64 v23, v[178:179] offset:32
    ds_write_b64 v23, v[180:181] offset:64
    ds_write_b64 v23, v[182:183] offset:96
    ds_write_b64 v23, v[184:185] offset:128
    s_and_b64 exec, s[46:47], 1
    buffer_load_dword v239, v238, s[8:11], 0 offen sc1
    s_mov_b64 exec, -1
    s_add_u32 m0, s0, 98304
    s_add_u32 s85, s99, 98304
    buffer_load_dwordx4 v56, s[8:11], s85 offen offset:0 sc1 lds
    buffer_load_dwordx4 v56, s[8:11], s85 offen offset:1024 sc1 lds
    buffer_load_dwordx4 v56, s[8:11], s85 offen offset:2048 sc1 lds
    buffer_load_dwordx4 v56, s[8:11], s85 offen offset:3072 sc1 lds
    s_waitcnt vmcnt(4)
    s_and_b64 exec, s[46:47], 1
    v_cmp_gt_u32 vcc, s59, v239
    s_cbranch_vccz interleave_layers__spectral_fnet__mixer_gmlp__prompt_kernel_ct_7
    s_mov_b32 s98, 0
interleave_layers__spectral_fnet__mixer_gmlp__prompt_kernel_poll_8:
    buffer_load_dword v239, v238, s[8:11], 0 offen sc1
    s_add_u32 s98, s98, 1
    s_cmp_gt_u32 s98, 1048576
    s_cbranch_scc1 interleave_layers__spectral_fnet__mixer_gmlp__prompt_kernel_poll_8_x
    s_waitcnt vmcnt(0)
    v_cmp_gt_u32 vcc, s59, v239
    s_cbranch_vccnz interleave_layers__spectral_fnet__mixer_gmlp__prompt_kernel_poll_8
interleave_layers__spectral_fnet__mixer_gmlp__prompt_kernel_poll_8_x:
interleave_layers__spectral_fnet__mixer_gmlp__prompt_kernel_ct_7:
    s_mov_b64 exec, -1
    s_add_u32 s59, s59, 32
    s_waitcnt lgkmcnt(0)
    s_barrier
    s_branch mid_join
x_retry0:
    s_add_u32 s98, s98, 1
    s_cmp_gt_u32 s98, 1048576
    s_cbranch_scc1 x_back0
    s_mov_b32 s83, s84
    s_add_u32 s84, s24, 0
    buffer_load_dwordx4 v[176:179], v56, s[8:11], s84 offen offset:0 sc1
    buffer_load_dwordx4 v[180:183], v56, s[8:11], s84 offen offset:1024 sc1
    s_mov_b32 s84, s83
    s_waitcnt vmcnt(0)
    v_max3_u32 v17, v176, v178, v180
    v_max_u32 v17, v17, v182
    v_cmp_eq_u32 vcc, -1, v17
    s_cbranch_vccnz x_retry0
    s_branch x_back0
x_retry1:
    s_add_u32 s98, s98, 1
    s_cmp_gt_u32 s98, 1048576
    s_cbranch_scc1 x_back1
    s_mov_b32 s83, s84
    s_add_u32 s84, s24, 0
    buffer_load_dwordx4 v[184:187], v56, s[8:11], s84 offen offset:2048 sc1
    buffer_load_dwordx4 v[188:191], v56, s[8:11], s84 offen offset:3072 sc1
    s_mov_b32 s84, s83
    s_waitcnt vmcnt(0)
    v_max3_u32 v17, v184, v186, v188
    v_max_u32 v17, v17, v190
    v_cmp_eq_u32 vcc, -1, v17
    s_cbranch_vccnz x_retry1
    s_branch x_back1
x_retry2:
    s_add_u32 s98, s98, 1
    s_cmp_gt_u32 s98, 1048576
    s_cbranch_scc1 x_back2
    s_mov_b32 s83, s84
    s_add_u32 s84, s24, 4096
    buffer_load_dwordx4 v[192:195], v56, s[8:11], s84 offen offset:0 sc1
    buffer_load_dwordx4 v[196:199], v56, s[8:11], s84 offen offset:1024 sc1
    s_mov_b32 s84, s83
    s_waitcnt vmcnt(0)
    v_max3_u32 v17, v192, v194, v196
    v_max_u32 v17, v17, v198
    v_cmp_eq_u32 vcc, -1, v17
    s_cbranch_vccnz x_retry2
    s_branch x_back2
x_retry3:
    s_add_u32 s98, s98, 1
    s_cmp_gt_u32 s98, 1048576
    s_cbranch_scc1 x_back3
    s_mov_b32 s83, s84
    s_add_u32 s84, s24, 4096
    buffer_load_dwordx4 v[200:203], v56, s[8:11], s84 offen offset:2048 sc1
    buffer_load_dwordx4 v[204:207], v56, s[8:11], s84 offen offset:3072 sc1
    s_mov_b32 s84, s83
    s_waitcnt vmcnt(0)
    v_max3_u32 v17, v200, v202, v204
    v_max_u32 v17, v17, v206
    v_cmp_eq_u32 vcc, -1, v17
    s_cbranch_vccnz x_retry3
    s_branch x_back3
x_retry4:
    s_add_u32 s98, s98, 1
    s_cmp_gt_u32 s98, 1048576
    s_cbranch_scc1 x_back4
    s_mov_b32 s83, s84
    s_add_u32 s84, s24, 16384
    buffer_load_dwordx4 v[208:211], v56, s[8:11], s84 offen offset:0 sc1
    buffer_load_dwordx4 v[212:215], v56, s[8:11], s84 offen offset:1024 sc1
    s_mov_b32 s84, s83
    s_waitcnt vmcnt(0)
    v_max3_u32 v17, v208, v210, v212
    v_max_u32 v17, v17, v214
    v_cmp_eq_u32 vcc, -1, v17
    s_cbranch_vccnz x_retry4
    s_branch x_back4
x_retry5:
    s_add_u32 s98, s98, 1
    s_cmp_gt_u32 s98, 1048576
    s_cbranch_scc1 x_back5
    s_mov_b32 s83, s84
    s_add_u32 s84, s24, 16384
    buffer_load_dwordx4 v[216:219], v56, s[8:11], s84 offen offset:2048 sc1
    buffer_load_dwordx4 v[220:223], v56, s[8:11], s84 offen offset:3072 sc1
    s_mov_b32 s84, s83
    s_waitcnt vmcnt(0)
    v_max3_u32 v17, v216, v218, v220
    v_max_u32 v17, v17, v222
    v_cmp_eq_u32 vcc, -1, v17
    s_cbranch_vccnz x_retry5
    s_branch x_back5
x_retry6:
    s_add_u32 s98, s98, 1
    s_cmp_gt_u32 s98, 1048576
    s_cbranch_scc1 x_back6
    s_mov_b32 s83, s84
    s_add_u32 s84, s24, 20480
    buffer_load_dwordx4 v[224:227], v56, s[8:11], s84 offen offset:0 sc1
    buffer_load_dwordx4 v[228:231], v56, s[8:11], s84 offen offset:1024 sc1
    s_mov_b32 s84, s83
    s_waitcnt vmcnt(0)
    v_max3_u32 v17, v224, v226, v228
    v_max_u32 v17, v17, v230
    v_cmp_eq_u32 vcc, -1, v17
    s_cbranch_vccnz x_retry6
    s_branch x_back6
p_retry0:
    s_add_u32 s98, s98, 1
    s_cmp_gt_u32 s98, 1048576
    s_cbranch_scc1 p_back0
    s_add_u32 m0, s48, 0
    s_add_u32 s85, s49, 0
    buffer_load_dwordx4 v56, s[8:11], s85 offen sc1 lds
    buffer_load_dwordx4 v56, s[8:11], s85 offen offset:1024 sc1 lds
    s_add_u32 m0, s48, 4096
    s_add_u32 s85, s49, 4096
    buffer_load_dwordx4 v56, s[8:11], s85 offen sc1 lds
    buffer_load_dwordx4 v56, s[8:11], s85 offen offset:1024 sc1 lds
    s_add_u32 m0, s48, 8192
    s_add_u32 s85, s49, 16384
    buffer_load_dwordx4 v56, s[8:11], s85 offen sc1 lds
    buffer_load_dwordx4 v56, s[8:11], s85 offen offset:1024 sc1 lds
    s_add_u32 m0, s48, 12288
    s_add_u32 s85, s49, 20480
    buffer_load_dwordx4 v56, s[8:11], s85 offen sc1 lds
    buffer_load_dwordx4 v56, s[8:11], s85 offen offset:1024 sc1 lds
    s_add_u32 m0, s48, 16384
    s_add_u32 s85, s49, 32768
    buffer_load_dwordx4 v56, s[8:11], s85 offen sc1 lds
    buffer_load_dwordx4 v56, s[8:11], s85 offen offset:1024 sc1 lds
    s_add_u32 m0, s48, 20480
    s_add_u32 s85, s49, 36864
    buffer_load_dwordx4 v56, s[8:11], s85 offen sc1 lds
    buffer_load_dwordx4 v56, s[8:11], s85 offen offset:1024 sc1 lds
    s_add_u32 m0, s48, 24576
    s_add_u32 s85, s49, 49152
    buffer_load_dwordx4 v56, s[8:11], s85 offen sc1 lds
    buffer_load_dwordx4 v56, s[8:11], s85 offen offset:1024 sc1 lds
    s_waitcnt vmcnt(12)
    ds_read_b128 v[232:235], v15 offset:0
    ds_read_b128 v[236:239], v15 offset:1024
    s_waitcnt lgkmcnt(0)
    v_max3_u32 v252, v232, v234, v236
    v_max_u32 v252, v252, v238
    v_cmp_eq_u32 vcc, -1, v252
    s_cbranch_vccnz p_retry0
    s_branch p_back0
p_retry1:
    s_add_u32 s98, s98, 1
    s_cmp_gt_u32 s98, 1048576
    s_cbranch_scc1 p_back1
    s_add_u32 m0, s48, 4096
    s_add_u32 s85, s49, 4096
    buffer_load_dwordx4 v56, s[8:11], s85 offen sc1 lds
    buffer_load_dwordx4 v56, s[8:11], s85 offen offset:1024 sc1 lds
    s_add_u32 m0, s48, 8192
    s_add_u32 s85, s49, 16384
    buffer_load_dwordx4 v56, s[8:11], s85 offen sc1 lds
    buffer_load_dwordx4 v56, s[8:11], s85 offen offset:1024 sc1 lds
    s_add_u32 m0, s48, 12288
    s_add_u32 s85, s49, 20480
    buffer_load_dwordx4 v56, s[8:11], s85 offen sc1 lds
    buffer_load_dwordx4 v56, s[8:11], s85 offen offset:1024 sc1 lds
    s_add_u32 m0, s48, 16384
    s_add_u32 s85, s49, 32768
    buffer_load_dwordx4 v56, s[8:11], s85 offen sc1 lds
    buffer_load_dwordx4 v56, s[8:11], s85 offen offset:1024 sc1 lds
    s_add_u32 m0, s48, 20480
    s_add_u32 s85, s49, 36864
    buffer_load_dwordx4 v56, s[8:11], s85 offen sc1 lds
    buffer_load_dwordx4 v56, s[8:11], s85 offen offset:1024 sc1 lds
    s_add_u32 m0, s48, 24576
    s_add_u32 s85, s49, 49152
    buffer_load_dwordx4 v56, s[8:11], s85 offen sc1 lds
    buffer_load_dwordx4 v56, s[8:11], s85 offen offset:1024 sc1 lds
    s_waitcnt vmcnt(8)
    ds_read_b128 v[232:235], v15 offset:4096
    ds_read_b128 v[236:239], v15 offset:5120
    ds_read_b128 v[16:19], v15 offset:8192
    ds_read_b128 v[20:23], v15 offset:9216
    s_waitcnt lgkmcnt(0)
    v_max3_u32 v252, v232, v234, v236
    v_max3_u32 v252, v252, v238, v16
    v_max3_u32 v252, v252, v18, v20
    v_max_u32 v252, v252, v22
    v_cmp_eq_u32 vcc, -1, v252
    s_cbranch_vccnz p_retry1
    s_branch p_back1
p_retry3:
    s_add_u32 s98, s98, 1
    s_cmp_gt_u32 s98, 1048576
    s_cbranch_scc1 p_back3
    s_add_u32 m0, s48, 12288
    s_add_u32 s85, s49, 20480
    buffer_load_dwordx4 v56, s[8:11], s85 offen sc1 lds
    buffer_load_dwordx4 v56, s[8:11], s85 offen offset:1024 sc1 lds
    s_add_u32 m0, s48, 16384
    s_add_u32 s85, s49, 32768
    buffer_load_dwordx4 v56, s[8:11], s85 offen sc1 lds
    buffer_load_dwordx4 v56, s[8:11], s85 offen offset:1024 sc1 lds
    s_add_u32 m0, s48, 20480
    s_add_u32 s85, s49, 36864
    buffer_load_dwordx4 v56, s[8:11], s85 offen sc1 lds
    buffer_load_dwordx4 v56, s[8:11], s85 offen offset:1024 sc1 lds
    s_add_u32 m0, s48, 24576
    s_add_u32 s85, s49, 49152
    buffer_load_dwordx4 v56, s[8:11], s85 offen sc1 lds
    buffer_load_dwordx4 v56, s[8:11], s85 offen offset:1024 sc1 lds
    s_waitcnt vmcnt(4)
    ds_read_b128 v[232:235], v15 offset:12288
    ds_read_b128 v[236:239], v15 offset:13312
    ds_read_b128 v[16:19], v15 offset:16384
    ds_read_b128 v[20:23], v15 offset:17408
    s_waitcnt lgkmcnt(0)
    v_max3_u32 v252, v232, v234, v236
    v_max3_u32 v252, v252, v238, v16
    v_max3_u32 v252, v252, v18, v20
    v_max_u32 v252, v252, v22
    v_cmp_eq_u32 vcc, -1, v252
    s_cbranch_vccnz p_retry3
    s_branch p_back3
p_retry5:
    s_add_u32 s98, s98, 1
    s_cmp_gt_u32 s98, 1048576
    s_cbranch_scc1 p_back5
    s_add_u32 m0, s48, 20480
    s_add_u32 s85, s49, 36864
    buffer_load_dwordx4 v56, s[8:11], s85 offen sc1 lds
    buffer_load_dwordx4 v56, s[8:11], s85 offen offset:1024 sc1 lds
    s_add_u32 m0, s48, 24576
    s_add_u32 s85, s49, 49152
    buffer_load_dwordx4 v56, s[8:11], s85 offen sc1 lds
    buffer_load_dwordx4 v56, s[8:11], s85 offen offset:1024 sc1 lds
    s_waitcnt vmcnt(0)
    ds_read_b128 v[232:235], v15 offset:20480
    ds_read_b128 v[236:239], v15 offset:21504
    ds_read_b128 v[16:19], v15 offset:24576
    ds_read_b128 v[20:23], v15 offset:25600
    s_waitcnt lgkmcnt(0)
    v_max3_u32 v252, v232, v234, v236
    v_max3_u32 v252, v252, v238, v16
    v_max3_u32 v252, v252, v18, v20
    v_max_u32 v252, v252, v22
    v_cmp_eq_u32 vcc, -1, v252
    s_cbranch_vccnz p_retry5
    s_branch p_back5
x_idle:
    v_lshlrev_b32 v8, 7, v0
    s_lshl_b32 s76, s90, 1
    s_bitcmp1_b32 s62, 0
    s_addc_u32 s76, s76, 0
    s_mul_i32 s76, s76, 25088
    s_add_u32 s76, s76, 896
    buffer_load_dword v9, v8, s[12:15], s76 offen
    s_add_u32 s76, s76, 5632
    buffer_load_dword v9, v8, s[12:15], s76 offen
    s_add_u32 s76, s76, 5632
    buffer_load_dword v9, v8, s[12:15], s76 offen
    s_add_u32 s76, s76, 5632
    buffer_load_dword v9, v8, s[12:15], s76 offen
    s_add_u32 s76, s76, 5632
    s_mov_b64 s[36:37], 0
    s_add_u32 s87, s87, 12582912
    s_add_u32 s58, s58, 12582912
    s_add_u32 s88, s88, 8388608
    s_add_u32 s96, s96, 8388608
    s_add_u32 s97, s97, 8388608
    s_add_u32 s89, s89, 8388608
    s_add_u32 s51, s51, 8388608
    s_add_u32 s49, s49, 4194304
    s_xor_b32 s49, s49, s27
    v_lshlrev_b32 v167, 3, v2
    v_sub_u32 v168, v1, v167
    v_add_u32 v167, v1, v167
    v_mov_b32 v169, 0x3f80
    v_add_u32 v164, 1, v168
    v_lshlrev_b32 v165, 4, v164
    v_lshlrev_b32 v165, v165, v169
    v_ashrrev_i32 v164, 1, v164
    v_cmp_eq_u32 s[76:77], 0, v164
    v_cmp_eq_u32 s[78:79], 1, v164
    v_cmp_eq_u32 s[80:81], 2, v164
    v_cmp_eq_u32 s[82:83], 3, v164
    v_cndmask_b32 v232, 0, v165, s[76:77]
    v_cndmask_b32 v233, 0, v165, s[78:79]
    v_cndmask_b32 v234, 0, v165, s[80:81]
    v_cndmask_b32 v235, 0, v165, s[82:83]
    v_add_u32 v164, 17, v168
    v_ashrrev_i32 v164, 1, v164
    v_cmp_eq_u32 s[76:77], 0, v164
    v_cmp_eq_u32 s[78:79], 1, v164
    v_cmp_eq_u32 s[80:81], 2, v164
    v_cmp_eq_u32 s[82:83], 3, v164
    v_cndmask_b32 v236, 0, v165, s[76:77]
    v_cndmask_b32 v237, 0, v165, s[78:79]
    v_cndmask_b32 v238, 0, v165, s[80:81]
    v_cndmask_b32 v239, 0, v165, s[82:83]
    v_add_u32 v164, -15, v168
    v_ashrrev_i32 v164, 1, v164
    v_cmp_eq_u32 s[76:77], 0, v164
    v_cmp_eq_u32 s[78:79], 1, v164
    v_cmp_eq_u32 s[80:81], 2, v164
    v_cmp_eq_u32 s[82:83], 3, v164
    v_cndmask_b32 v240, 0, v165, s[76:77]
    v_cndmask_b32 v241, 0, v165, s[78:79]
    v_cndmask_b32 v242, 0, v165, s[80:81]
    v_cndmask_b32 v243, 0, v165, s[82:83]
    v_sub_u32 v164, 15, v167
    v_ashrrev_i32 v164, 1, v164
    v_cmp_eq_u32 s[76:77], 0, v164
    v_cmp_eq_u32 s[78:79], 1, v164
    v_cmp_eq_u32 s[80:81], 2, v164
    v_cmp_eq_u32 s[82:83], 3, v164
    v_cndmask_b32 v244, 0, v165, s[76:77]
    v_cndmask_b32 v245, 0, v165, s[78:79]
    v_cndmask_b32 v246, 0, v165, s[80:81]
    v_cndmask_b32 v247, 0, v165, s[82:83]
    v_sub_u32 v164, 31, v167
    v_ashrrev_i32 v164, 1, v164
    v_cmp_eq_u32 s[76:77], 0, v164
    v_cmp_eq_u32 s[78:79], 1, v164
    v_cmp_eq_u32 s[80:81], 2, v164
    v_cmp_eq_u32 s[82:83], 3, v164
    v_cndmask_b32 v248, 0, v165, s[76:77]
    v_cndmask_b32 v249, 0, v165, s[78:79]
    v_cndmask_b32 v250, 0, v165, s[80:81]
    v_cndmask_b32 v251, 0, v165, s[82:83]
    s_add_u32 m0, s0, 0
    s_add_u32 s85, s86, 0
    buffer_load_dwordx4 v56, s[8:11], s85 offen offset:0 sc1 lds
    buffer_load_dwordx4 v56, s[8:11], s85 offen offset:1024 sc1 lds
    buffer_load_dwordx4 v56, s[8:11], s85 offen offset:2048 sc1 lds
    buffer_load_dwordx4 v56, s[8:11], s85 offen offset:3072 sc1 lds
    s_add_u32 m0, s0, 16384
    s_add_u32 s85, s86, 16384
    buffer_load_dwordx4 v56, s[8:11], s85 offen offset:0 sc1 lds
    buffer_load_dwordx4 v56, s[8:11], s85 offen offset:1024 sc1 lds
    buffer_load_dwordx4 v56, s[8:11], s85 offen offset:2048 sc1 lds
    buffer_load_dwordx4 v56, s[8:11], s85 offen offset:3072 sc1 lds
    s_waitcnt vmcnt(0)
    s_mov_b32 s98, 0
xi_loop:
    s_add_u32 s84, s24, 0
    buffer_load_dwordx4 v[176:179], v56, s[8:11], s84 offen offset:0 sc1
    buffer_load_dwordx4 v[180:183], v56, s[8:11], s84 offen offset:1024 sc1
    buffer_load_dwordx4 v[184:187], v56, s[8:11], s84 offen offset:2048 sc1
    buffer_load_dwordx4 v[188:191], v56, s[8:11], s84 offen offset:3072 sc1
    s_add_u32 s84, s24, 4096
    buffer_load_dwordx4 v[192:195], v56, s[8:11], s84 offen offset:0 sc1
    buffer_load_dwordx4 v[196:199], v56, s[8:11], s84 offen offset:1024 sc1
    buffer_load_dwordx4 v[200:203], v56, s[8:11], s84 offen offset:2048 sc1
    buffer_load_dwordx4 v[204:207], v56, s[8:11], s84 offen offset:3072 sc1
    s_add_u32 s84, s24, 16384
    buffer_load_dwordx4 v[208:211], v56, s[8:11], s84 offen offset:0 sc1
    buffer_load_dwordx4 v[212:215], v56, s[8:11], s84 offen offset:1024 sc1
    buffer_load_dwordx4 v[216:219], v56, s[8:11], s84 offen offset:2048 sc1
    buffer_load_dwordx4 v[220:223], v56, s[8:11], s84 offen offset:3072 sc1
    s_add_u32 s84, s24, 20480
    buffer_load_dwordx4 v[224:227], v56, s[8:11], s84 offen offset:0 sc1
    buffer_load_dwordx4 v[228:231], v56, s[8:11], s84 offen offset:1024 sc1
    s_waitcnt vmcnt(0)
    v_max3_u32 v17, v176, v178, v180
    v_max3_u32 v17, v17, v182, v184
    v_max3_u32 v17, v17, v186, v188
    v_max3_u32 v17, v17, v190, v192
    v_max3_u32 v17, v17, v194, v196
    v_max3_u32 v17, v17, v198, v200
    v_max3_u32 v17, v17, v202, v204
    v_max3_u32 v17, v17, v206, v208
    v_max3_u32 v17, v17, v210, v212
    v_max3_u32 v17, v17, v214, v216
    v_max3_u32 v17, v17, v218, v220
    v_max3_u32 v17, v17, v222, v224
    v_max3_u32 v17, v17, v226, v228
    v_max_u32 v17, v17, v230
    v_cmp_eq_u32 vcc, -1, v17
    s_cbranch_vccz xi_done
    s_add_u32 s98, s98, 1
    s_cmp_gt_u32 s98, 1048576
    s_cbranch_scc1 xi_done
    s_branch xi_loop
xi_done:
    s_branch a1_join
k4_retry0:
    s_add_u32 s98, s98, 1
    s_cmp_gt_u32 s98, 1048576
    s_cbranch_scc1 k4_back0
    s_mov_b32 s79, s78
    s_add_u32 s78, s88, 0
    buffer_load_dwordx4 v[176:179], v56, s[8:11], s78 offen offset:0 sc1
    buffer_load_dwordx4 v[180:183], v56, s[8:11], s78 offen offset:1024 sc1
    buffer_load_dwordx4 v[184:187], v56, s[8:11], s78 offen offset:2048 sc1
    buffer_load_dwordx4 v[188:191], v56, s[8:11], s78 offen offset:3072 sc1
    s_mov_b32 s78, s79
    s_waitcnt vmcnt(0)
    v_max3_u32 v15, v176, v178, v180
    v_max3_u32 v15, v15, v182, v184
    v_max3_u32 v15, v15, v186, v188
    v_max_u32 v15, v15, v190
    v_cmp_eq_u32 vcc, -1, v15
    s_cbranch_vccnz k4_retry0
    s_branch k4_back0
k4_retry1:
    s_add_u32 s98, s98, 1
    s_cmp_gt_u32 s98, 1048576
    s_cbranch_scc1 k4_back1
    s_mov_b32 s79, s78
    s_add_u32 s78, s88, 4096
    buffer_load_dwordx4 v[192:195], v56, s[8:11], s78 offen offset:0 sc1
    buffer_load_dwordx4 v[196:199], v56, s[8:11], s78 offen offset:1024 sc1
    buffer_load_dwordx4 v[200:203], v56, s[8:11], s78 offen offset:2048 sc1
    buffer_load_dwordx4 v[204:207], v56, s[8:11], s78 offen offset:3072 sc1
    s_mov_b32 s78, s79
    s_waitcnt vmcnt(0)
    v_max3_u32 v15, v192, v194, v196
    v_max3_u32 v15, v15, v198, v200
    v_max3_u32 v15, v15, v202, v204
    v_max_u32 v15, v15, v206
    v_cmp_eq_u32 vcc, -1, v15
    s_cbranch_vccnz k4_retry1
    s_branch k4_back1
k4_retry2:
    s_add_u32 s98, s98, 1
    s_cmp_gt_u32 s98, 1048576
    s_cbranch_scc1 k4_back2
    s_mov_b32 s79, s78
    s_add_u32 s78, s88, 16384
    buffer_load_dwordx4 v[208:211], v56, s[8:11], s78 offen offset:0 sc1
    buffer_load_dwordx4 v[212:215], v56, s[8:11], s78 offen offset:1024 sc1
    buffer_load_dwordx4 v[216:219], v56, s[8:11], s78 offen offset:2048 sc1
    buffer_load_dwordx4 v[220:223], v56, s[8:11], s78 offen offset:3072 sc1
    s_mov_b32 s78, s79
    s_waitcnt vmcnt(0)
    v_max3_u32 v15, v208, v210, v212
    v_max3_u32 v15, v15, v214, v216
    v_max3_u32 v15, v15, v218, v220
    v_max_u32 v15, v15, v222
    v_cmp_eq_u32 vcc, -1, v15
    s_cbranch_vccnz k4_retry2
    s_branch k4_back2
k4_retry3:
    s_add_u32 s98, s98, 1
    s_cmp_gt_u32 s98, 1048576
    s_cbranch_scc1 k4_back3
    s_mov_b32 s79, s78
    s_add_u32 s78, s88, 20480
    buffer_load_dwordx4 v[224:227], v56, s[8:11], s78 offen offset:0 sc1
    buffer_load_dwordx4 v[228:231], v56, s[8:11], s78 offen offset:1024 sc1
    buffer_load_dwordx4 v[232:235], v56, s[8:11], s78 offen offset:2048 sc1
    buffer_load_dwordx4 v[236:239], v56, s[8:11], s78 offen offset:3072 sc1
    s_mov_b32 s78, s79
    s_waitcnt vmcnt(0)
    v_max3_u32 v15, v224, v226, v228
    v_max3_u32 v15, v15, v230, v232
    v_max3_u32 v15, v15, v234, v236
    v_max_u32 v15, v15, v238
    v_cmp_eq_u32 vcc, -1, v15
    s_cbranch_vccnz k4_retry3
    s_branch k4_back3
k4_retry4:
    s_add_u32 s98, s98, 1
    s_cmp_gt_u32 s98, 1048576
    s_cbranch_scc1 k4_back4
    s_mov_b32 s79, s78
    s_add_u32 s78, s88, 32768
    buffer_load_dwordx4 v[80:83], v56, s[8:11], s78 offen offset:0 sc1
    buffer_load_dwordx4 v[84:87], v56, s[8:11], s78 offen offset:1024 sc1
    buffer_load_dwordx4 v[88:91], v56, s[8:11], s78 offen offset:2048 sc1
    buffer_load_dwordx4 v[92:95], v56, s[8:11], s78 offen offset:3072 sc1
    s_mov_b32 s78, s79
    s_waitcnt vmcnt(0)
    v_max3_u32 v15, v80, v82, v84
    v_max3_u32 v15, v15, v86, v88
    v_max3_u32 v15, v15, v90, v92
    v_max_u32 v15, v15, v94
    v_cmp_eq_u32 vcc, -1, v15
    s_cbranch_vccnz k4_retry4
    s_branch k4_back4
k4_retry5:
    s_add_u32 s98, s98, 1
    s_cmp_gt_u32 s98, 1048576
    s_cbranch_scc1 k4_back5
    s_mov_b32 s79, s78
    s_add_u32 s78, s88, 36864
    buffer_load_dwordx4 v[152:155], v56, s[8:11], s78 offen offset:0 sc1
    buffer_load_dwordx4 v[156:159], v56, s[8:11], s78 offen offset:1024 sc1
    buffer_load_dwordx4 v[160:163], v56, s[8:11], s78 offen offset:2048 sc1
    buffer_load_dwordx4 v[164:167], v56, s[8:11], s78 offen offset:3072 sc1
    s_mov_b32 s78, s79
    s_waitcnt vmcnt(0)
    v_max3_u32 v15, v152, v154, v156
    v_max3_u32 v15, v15, v158, v160
    v_max3_u32 v15, v15, v162, v164
    v_max_u32 v15, v15, v166
    v_cmp_eq_u32 vcc, -1, v15
    s_cbranch_vccnz k4_retry5
    s_branch k4_back5
k4_retry6:
    s_add_u32 s98, s98, 1
    s_cmp_gt_u32 s98, 1048576
    s_cbranch_scc1 k4_back6
    s_mov_b32 s79, s78
    s_add_u32 s78, s88, 49152
    buffer_load_dwordx2 v[64:65], v58, s[8:11], s78 offen offset:0 sc1
    buffer_load_dwordx2 v[66:67], v58, s[8:11], s78 offen offset:512 sc1
    buffer_load_dwordx2 v[68:69], v58, s[8:11], s78 offen offset:1024 sc1
    buffer_load_dwordx2 v[70:71], v58, s[8:11], s78 offen offset:1536 sc1
    buffer_load_dwordx2 v[72:73], v58, s[8:11], s78 offen offset:2048 sc1
    buffer_load_dwordx2 v[74:75], v58, s[8:11], s78 offen offset:2560 sc1
    buffer_load_dwordx2 v[76:77], v58, s[8:11], s78 offen offset:3072 sc1
    buffer_load_dwordx2 v[78:79], v58, s[8:11], s78 offen offset:3584 sc1
    s_mov_b32 s78, s79
    s_waitcnt vmcnt(0)
    v_max3_u32 v15, v64, v66, v68
    v_max3_u32 v15, v15, v70, v72
    v_max3_u32 v15, v15, v74, v76
    v_max_u32 v15, v15, v78
    v_cmp_eq_u32 vcc, -1, v15
    s_cbranch_vccnz k4_retry6
    s_branch k4_back6
rp_entry:
    s_mov_b64 s[4:5], s[36:37]
    s_mov_b64 s[16:17], s[48:49]
    s_mov_b64 s[20:21], s[50:51]
    s_mov_b64 s[28:29], s[52:53]
    s_mov_b64 s[24:25], s[54:55]
    s_mov_b32 s32, s58
    s_mov_b32 s33, s59
    s_mov_b32 s34, 256
    s_lshl_b32 s76, s64, 2
    s_add_u32 s76, s76, s62
    s_bfe_u32 s77, s76, 0x10005
    s_lshl_b32 s88, s76, 3
    s_add_u32 s88, s88, s77
    s_lshl_b32 s88, s88, 13
    s_add_u32 s88, s88, 16777216
    s_add_u32 s89, s88, 53248
    s_lshl_b32 s77, s63, 7
    s_add_u32 s51, s89, s77
    s_lshl_b32 s50, s62, 19
    s_and_b32 s77, s63, 6
    s_add_u32 s77, s77, s63
    s_lshl_b32 s77, s77, 12
    s_add_u32 s50, s50, s77
    s_lshl_b32 s77, s64, 7
    s_add_u32 s50, s50, s77
    s_add_u32 s50, s50, 41943040
    s_mov_b32 s1, 0
    s_cmp_eq_u32 s62, 0
    s_cselect_b32 s46, 0xff, 0
    s_mov_b32 s47, 0
    s_mov_b32 s74, 0x05040100
    s_mov_b32 s75, 0x07060302
    s_mov_b32 s38, 0x100001
    s_mov_b32 s39, 0x10000100
    s_mov_b32 s40, 0x200002
    s_mov_b32 s41, 0x20000200
    s_mov_b32 s42, 0x400004
    s_mov_b32 s43, 0x40000400
    s_mov_b32 s44, 0x800008
    s_mov_b32 s45, 0x80000800
    v_mov_b32 v60, 0x3f803f80
    v_mov_b32 v61, 0x3f803f80
    v_mov_b32 v62, 0x3f803f80
    v_mov_b32 v63, 0x3f803f80
    s_lshl_b32 s76, s64, 2
    s_add_u32 s76, s76, s62
    s_cmp_lg_u32 s76, 120
    s_cbranch_scc1 noinit
    v_lshlrev_b32 v16, 7, v0
    v_mov_b32 v17, 0
    s_mov_b32 s77, 8192
    s_mov_b32 s78, 20480
    buffer_store_dword v17, v16, s[8:11], s78 offen sc1
    buffer_store_dword v17, v16, s[8:11], 0 offen sc1
    buffer_store_dword v17, v16, s[8:11], s77 offen sc1
    v_mov_b32 v18, 1
    s_waitcnt vmcnt(0)
    s_mov_b64 exec, 1
    buffer_store_dword v18, v17, s[32:35], 0 offen sc1
    s_mov_b64 exec, -1
noinit:
    s_cmp_lg_u32 s76, 124
    s_cbranch_scc1 noprobe
    v_lshrrev_b32 v18, 3, v0
    v_and_b32 v19, 0x70, v56
    v_lshl_add_u32 v18, v18, 12, v19
    s_mov_b32 s77, 34603008
    v_mov_b32 v64, 0
    v_mov_b32 v65, 0
    v_mov_b32 v66, 0
    v_mov_b32 v67, 0
    buffer_store_dwordx4 v[64:67], v18, s[8:11], s77 offen offset:0 sc1
    buffer_store_dwordx4 v[64:67], v18, s[8:11], s77 offen offset:256 sc1
noprobe:
    v_lshrrev_b32 v12, 3, v0
    v_mul_u32_u24 v12, 3584, v12
    v_and_b32 v13, 7, v0
    v_lshl_add_u32 v12, v13, 4, v12
    s_mul_i32 s76, s62, 28672
    s_lshl_b32 s77, s64, 7
    s_add_u32 s84, s76, s77
    s_cmp_ge_u32 s64, 28
    s_cbranch_scc1 rp_skip0
    s_add_u32 m0, s91, 106496
    s_nop 0
    buffer_load_dwordx4 v12, s[16:19], s84 offen lds
    s_add_u32 s84, s84, 114688
    s_add_u32 m0, s91, 110592
    s_nop 0
    buffer_load_dwordx4 v12, s[16:19], s84 offen lds
    s_add_u32 s84, s84, 114688
    s_add_u32 m0, s91, 114688
    s_nop 0
    buffer_load_dwordx4 v12, s[16:19], s84 offen lds
    s_add_u32 s84, s84, 114688
    s_add_u32 m0, s91, 118784
    s_nop 0
    buffer_load_dwordx4 v12, s[16:19], s84 offen lds
    s_add_u32 s84, s84, 114688
    s_add_u32 m0, s91, 122880
    s_nop 0
    buffer_load_dwordx4 v12, s[16:19], s84 offen lds
    s_add_u32 s84, s84, 114688
    s_add_u32 m0, s91, 126976
    s_nop 0
    buffer_load_dwordx4 v12, s[16:19], s84 offen lds
    s_add_u32 s84, s84, 114688
    s_add_u32 m0, s91, 131072
    s_nop 0
    buffer_load_dwordx4 v12, s[16:19], s84 offen lds
    s_add_u32 s84, s84, 114688
    s_add_u32 m0, s91, 135168
    s_nop 0
    buffer_load_dwordx4 v12, s[16:19], s84 offen lds
    s_add_u32 s84, s84, 114688
rp_skip0:
    v_lshlrev_b32 v167, 3, v2
    v_sub_u32 v168, v1, v167
    v_add_u32 v167, v1, v167
    v_mov_b32 v169, 0x3f80
    v_add_u32 v164, 1, v168
    v_lshlrev_b32 v165, 4, v164
    v_lshlrev_b32 v165, v165, v169
    v_ashrrev_i32 v164, 1, v164
    v_cmp_eq_u32 s[76:77], 0, v164
    v_cmp_eq_u32 s[78:79], 1, v164
    v_cmp_eq_u32 s[80:81], 2, v164
    v_cmp_eq_u32 s[82:83], 3, v164
    v_cndmask_b32 v232, 0, v165, s[76:77]
    v_cndmask_b32 v233, 0, v165, s[78:79]
    v_cndmask_b32 v234, 0, v165, s[80:81]
    v_cndmask_b32 v235, 0, v165, s[82:83]
    v_add_u32 v164, 17, v168
    v_ashrrev_i32 v164, 1, v164
    v_cmp_eq_u32 s[76:77], 0, v164
    v_cmp_eq_u32 s[78:79], 1, v164
    v_cmp_eq_u32 s[80:81], 2, v164
    v_cmp_eq_u32 s[82:83], 3, v164
    v_cndmask_b32 v236, 0, v165, s[76:77]
    v_cndmask_b32 v237, 0, v165, s[78:79]
    v_cndmask_b32 v238, 0, v165, s[80:81]
    v_cndmask_b32 v239, 0, v165, s[82:83]
    v_add_u32 v164, -15, v168
    v_ashrrev_i32 v164, 1, v164
    v_cmp_eq_u32 s[76:77], 0, v164
    v_cmp_eq_u32 s[78:79], 1, v164
    v_cmp_eq_u32 s[80:81], 2, v164
    v_cmp_eq_u32 s[82:83], 3, v164
    v_cndmask_b32 v240, 0, v165, s[76:77]
    v_cndmask_b32 v241, 0, v165, s[78:79]
    v_cndmask_b32 v242, 0, v165, s[80:81]
    v_cndmask_b32 v243, 0, v165, s[82:83]
    v_sub_u32 v164, 15, v167
    v_ashrrev_i32 v164, 1, v164
    v_cmp_eq_u32 s[76:77], 0, v164
    v_cmp_eq_u32 s[78:79], 1, v164
    v_cmp_eq_u32 s[80:81], 2, v164
    v_cmp_eq_u32 s[82:83], 3, v164
    v_cndmask_b32 v244, 0, v165, s[76:77]
    v_cndmask_b32 v245, 0, v165, s[78:79]
    v_cndmask_b32 v246, 0, v165, s[80:81]
    v_cndmask_b32 v247, 0, v165, s[82:83]
    v_sub_u32 v164, 31, v167
    v_ashrrev_i32 v164, 1, v164
    v_cmp_eq_u32 s[76:77], 0, v164
    v_cmp_eq_u32 s[78:79], 1, v164
    v_cmp_eq_u32 s[80:81], 2, v164
    v_cmp_eq_u32 s[82:83], 3, v164
    v_cndmask_b32 v248, 0, v165, s[76:77]
    v_cndmask_b32 v249, 0, v165, s[78:79]
    v_cndmask_b32 v250, 0, v165, s[80:81]
    v_cndmask_b32 v251, 0, v165, s[82:83]
    s_lshl_b32 s78, s64, 2
    s_add_u32 s78, s78, s62
    s_lshr_b32 s79, s78, 6
    s_lshl_b32 s24, s78, 2
    s_add_u32 s24, s24, s79
    s_lshl_b32 s24, s24, 13
    s_add_u32 s24, s24, 37748736
    s_and_b32 s79, s63, 4
    s_add_u32 s79, s79, s63
    s_lshl_b32 s25, s79, 11
    s_add_u32 s25, s25, s24
    s_lshl_b32 s96, s63, 10
    s_add_u32 s96, s96, s88
    s_lshl_b32 s97, s63, 9
    s_add_u32 s97, s97, s88
    s_add_u32 s97, s97, 49152
    s_and_b32 s80, s62, 2
    s_add_u32 s80, s80, s62
    s_lshl_b32 s80, s80, 12
    s_min_u32 s99, s63, 6
    s_lshl_b32 s99, s99, 18
    s_add_u32 s99, s99, 54525952
    s_add_u32 s99, s99, s80
    s_lshl_b32 s80, s62, 12
    s_lshr_b32 s79, s63, 2
    s_lshl_b32 s86, s63, 6
    s_lshl_b32 s86, s86, 13
    s_mul_i32 s86, s63, 540672
    s_add_u32 s86, s86, 50331648
    s_add_u32 s60, s86, s91
    s_add_u32 s61, s86, s92
    s_add_u32 s86, s86, s80
    s_mul_i32 s87, s63, 466944
    s_add_u32 s87, s87, 58720256
    s_lshr_b32 s58, s66, 5
    s_lshl_b32 s58, s58, 3
    s_and_b32 s79, s66, 7
    s_add_u32 s58, s58, s79
    s_lshl_b32 s58, s58, 2
    s_bfe_u32 s79, s66, 0x20003
    s_add_u32 s58, s58, s79
    s_lshl_b32 s58, s58, 8
    s_and_b32 s79, s62, 1
    s_mul_i32 s80, s79, 32768
    s_add_u32 s58, s58, s80
    s_bfe_u32 s80, s63, 0x10001
    s_lshl_b32 s80, s80, 13
    s_add_u32 s58, s58, s87
    s_lshl_b32 s79, s79, 11
    s_and_b32 s49, s66, 31
    s_lshl_b32 s49, s49, 16
    s_add_u32 s49, s49, s79
    s_cmp_ge_u32 s62, 2
    s_cselect_b32 s80, 28672, 0
    s_add_u32 s48, s80, s79
    s_add_u32 s48, s48, 106496
    s_add_u32 s49, s49, 41943040
    s_mul_i32 s93, s62, 3072
    s_lshl_b32 s0, s62, 12
    s_mov_b32 s59, 32
    s_mov_b64 s[36:37], -1
    v_lshl_add_u32 v57, v1, 6, s68
    v_mul_u32_u24 v57, 896, v57
    v_lshl_add_u32 v57, v2, 4, v57
    s_lshl_b32 s79, s63, 7
    v_add_u32 v57, s79, v57
    s_mov_b32 s99, 0x20000000
    s_mov_b32 s88, 0x20000000
    s_cmp_lg_u32 s64, 31
    s_cbranch_scc1 nocal
    s_cmp_lg_u32 s62, 0
    s_cbranch_scc1 calbar
    s_add_u32 s84, s8, 34603008
    s_addc_u32 s85, s9, 0
    s_mov_b32 s26, 0
    v_mov_b32 v17, 0
    s_waitcnt vmcnt(0)
    s_mov_b32 s78, 1
    s_mov_b32 s80, 34611200
    s_mov_b64 exec, 1
    buffer_load_dword v18, v17, s[8:11], s80 offen sc1
    s_mov_b64 exec, -1
    v_lshl_add_u32 v176, v1, 6, s68
    v_cvt_f32_u32 v177, v176
    v_mul_f32 v177, 0x3a000000, v177
    v_cvt_f32_u32 v178, v2
    v_mul_f32 v178, 4.0, v178
    v_mul_f32 v178, v178, v177
    s_mov_b32 s76, 0x41500000
    v_cos_f32 v179, v178
    v_sin_f32 v180, v178
    v_add_f32 v178, v178, v177
    v_cvt_pk_bf16_f32 v40, v179, v180
    v_xor_b32 v48, 0x80000000, v40
    v_cos_f32 v179, v178
    v_sin_f32 v180, v178
    v_add_f32 v178, v178, v177
    v_cvt_pk_bf16_f32 v41, v179, v180
    v_xor_b32 v49, 0x80000000, v41
    v_cos_f32 v179, v178
    v_sin_f32 v180, v178
    v_add_f32 v178, v178, v177
    v_cvt_pk_bf16_f32 v42, v179, v180
    v_xor_b32 v50, 0x80000000, v42
    v_cos_f32 v179, v178
    v_sin_f32 v180, v178
    v_fma_f32 v178, s76, v177, v178
    v_cvt_pk_bf16_f32 v43, v179, v180
    v_xor_b32 v51, 0x80000000, v43
    v_cos_f32 v179, v178
    v_sin_f32 v180, v178
    v_add_f32 v178, v178, v177
    v_cvt_pk_bf16_f32 v44, v179, v180
    v_xor_b32 v52, 0x80000000, v44
    s_load_dword s78, s[84:85], 0 glc
    s_mov_b32 s80, 0
    s_waitcnt vmcnt(0)
cal0:
    s_add_u32 s80, s80, 1
    s_lshr_b32 s81, s80, 10
    s_add_u32 s81, s81, s78
    s_cmp_eq_u32 s81, 1
    s_cbranch_scc1 cal0
    s_add_u32 s26, s26, s80
    s_waitcnt lgkmcnt(0)
    s_mov_b32 s78, 1
    s_mov_b32 s80, 34603264
    s_mov_b64 exec, 1
    buffer_load_dword v18, v17, s[8:11], s80 offen sc1
    s_mov_b64 exec, -1
    v_lshl_add_u32 v176, v1, 6, s68
    v_cvt_f32_u32 v177, v176
    v_mul_f32 v177, 0x3a000000, v177
    v_cvt_f32_u32 v178, v2
    v_mul_f32 v178, 4.0, v178
    v_mul_f32 v178, v178, v177
    s_mov_b32 s76, 0x41500000
    v_cos_f32 v179, v178
    v_sin_f32 v180, v178
    v_add_f32 v178, v178, v177
    v_cvt_pk_bf16_f32 v40, v179, v180
    v_xor_b32 v48, 0x80000000, v40
    v_cos_f32 v179, v178
    v_sin_f32 v180, v178
    v_add_f32 v178, v178, v177
    v_cvt_pk_bf16_f32 v41, v179, v180
    v_xor_b32 v49, 0x80000000, v41
    v_cos_f32 v179, v178
    v_sin_f32 v180, v178
    v_add_f32 v178, v178, v177
    v_cvt_pk_bf16_f32 v42, v179, v180
    v_xor_b32 v50, 0x80000000, v42
    v_cos_f32 v179, v178
    v_sin_f32 v180, v178
    v_fma_f32 v178, s76, v177, v178
    v_cvt_pk_bf16_f32 v43, v179, v180
    v_xor_b32 v51, 0x80000000, v43
    v_cos_f32 v179, v178
    v_sin_f32 v180, v178
    v_add_f32 v178, v178, v177
    v_cvt_pk_bf16_f32 v44, v179, v180
    v_xor_b32 v52, 0x80000000, v44
    s_load_dword s78, s[84:85], 8448 glc
    s_mov_b32 s80, 0
    s_waitcnt vmcnt(0)
cal1:
    s_add_u32 s80, s80, 1
    s_lshr_b32 s81, s80, 10
    s_add_u32 s81, s81, s78
    s_cmp_eq_u32 s81, 1
    s_cbranch_scc1 cal1
    s_sub_u32 s26, s26, s80
    s_waitcnt lgkmcnt(0)
    s_mov_b32 s78, 1
    s_mov_b32 s80, 34615296
    s_mov_b64 exec, 1
    buffer_load_dword v18, v17, s[8:11], s80 offen sc1
    s_mov_b64 exec, -1
    v_lshl_add_u32 v176, v1, 6, s68
    v_cvt_f32_u32 v177, v176
    v_mul_f32 v177, 0x3a000000, v177
    v_cvt_f32_u32 v178, v2
    v_mul_f32 v178, 4.0, v178
    v_mul_f32 v178, v178, v177
    s_mov_b32 s76, 0x41500000
    v_cos_f32 v179, v178
    v_sin_f32 v180, v178
    v_add_f32 v178, v178, v177
    v_cvt_pk_bf16_f32 v40, v179, v180
    v_xor_b32 v48, 0x80000000, v40
    v_cos_f32 v179, v178
    v_sin_f32 v180, v178
    v_add_f32 v178, v178, v177
    v_cvt_pk_bf16_f32 v41, v179, v180
    v_xor_b32 v49, 0x80000000, v41
    v_cos_f32 v179, v178
    v_sin_f32 v180, v178
    v_add_f32 v178, v178, v177
    v_cvt_pk_bf16_f32 v42, v179, v180
    v_xor_b32 v50, 0x80000000, v42
    v_cos_f32 v179, v178
    v_sin_f32 v180, v178
    v_fma_f32 v178, s76, v177, v178
    v_cvt_pk_bf16_f32 v43, v179, v180
    v_xor_b32 v51, 0x80000000, v43
    v_cos_f32 v179, v178
    v_sin_f32 v180, v178
    v_add_f32 v178, v178, v177
    v_cvt_pk_bf16_f32 v44, v179, v180
    v_xor_b32 v52, 0x80000000, v44
    s_load_dword s78, s[84:85], 4096 glc
    s_mov_b32 s80, 0
    s_waitcnt vmcnt(0)
cal2:
    s_add_u32 s80, s80, 1
    s_lshr_b32 s81, s80, 10
    s_add_u32 s81, s81, s78
    s_cmp_eq_u32 s81, 1
    s_cbranch_scc1 cal2
    s_add_u32 s26, s26, s80
    s_waitcnt lgkmcnt(0)
    s_mov_b32 s78, 1
    s_mov_b32 s80, 34607360
    s_mov_b64 exec, 1
    buffer_load_dword v18, v17, s[8:11], s80 offen sc1
    s_mov_b64 exec, -1
    v_lshl_add_u32 v176, v1, 6, s68
    v_cvt_f32_u32 v177, v176
    v_mul_f32 v177, 0x3a000000, v177
    v_cvt_f32_u32 v178, v2
    v_mul_f32 v178, 4.0, v178
    v_mul_f32 v178, v178, v177
    s_mov_b32 s76, 0x41500000
    v_cos_f32 v179, v178
    v_sin_f32 v180, v178
    v_add_f32 v178, v178, v177
    v_cvt_pk_bf16_f32 v40, v179, v180
    v_xor_b32 v48, 0x80000000, v40
    v_cos_f32 v179, v178
    v_sin_f32 v180, v178
    v_add_f32 v178, v178, v177
    v_cvt_pk_bf16_f32 v41, v179, v180
    v_xor_b32 v49, 0x80000000, v41
    v_cos_f32 v179, v178
    v_sin_f32 v180, v178
    v_add_f32 v178, v178, v177
    v_cvt_pk_bf16_f32 v42, v179, v180
    v_xor_b32 v50, 0x80000000, v42
    v_cos_f32 v179, v178
    v_sin_f32 v180, v178
    v_fma_f32 v178, s76, v177, v178
    v_cvt_pk_bf16_f32 v43, v179, v180
    v_xor_b32 v51, 0x80000000, v43
    v_cos_f32 v179, v178
    v_sin_f32 v180, v178
    v_add_f32 v178, v178, v177
    v_cvt_pk_bf16_f32 v44, v179, v180
    v_xor_b32 v52, 0x80000000, v44
    s_load_dword s78, s[84:85], 12544 glc
    s_mov_b32 s80, 0
    s_waitcnt vmcnt(0)
cal3:
    s_add_u32 s80, s80, 1
    s_lshr_b32 s81, s80, 10
    s_add_u32 s81, s81, s78
    s_cmp_eq_u32 s81, 1
    s_cbranch_scc1 cal3
    s_sub_u32 s26, s26, s80
    s_waitcnt lgkmcnt(0)
    s_getreg_b32 s78, hwreg(HW_REG_XCC_ID)
    s_cmp_gt_i32 s26, 0
    s_cselect_b32 s80, 4, 0
    s_xor_b32 s80, s80, s78
    s_and_b32 s80, s80, 4
    s_sub_u32 s78, s78, s67
    s_add_u32 s78, s78, s80
    s_add_u32 s78, s78, 0
    s_and_b32 s78, s78, 7
    s_lshr_b32 s78, 0xf0f0, s78
    s_and_b32 s78, s78, 0xff
    s_or_b32 s78, s78, 0x100
    v_mov_b32 v18, s78
    s_mov_b64 exec, 1
    buffer_store_dword v18, v17, s[32:35], 0 offen offset:128 sc1
    s_mov_b64 exec, -1
calbar:
    s_barrier
nocal:
    v_lshl_add_u32 v176, v1, 6, s68
    v_cvt_f32_u32 v177, v176
    v_mul_f32 v177, 0x3a000000, v177
    v_cvt_f32_u32 v178, v2
    v_mul_f32 v178, 4.0, v178
    v_mul_f32 v178, v178, v177
    s_mov_b32 s76, 0x41500000
    v_cos_f32 v179, v178
    v_sin_f32 v180, v178
    v_add_f32 v178, v178, v177
    v_cvt_pk_bf16_f32 v40, v179, v180
    v_xor_b32 v48, 0x80000000, v40
    v_cos_f32 v179, v178
    v_sin_f32 v180, v178
    v_add_f32 v178, v178, v177
    v_cvt_pk_bf16_f32 v41, v179, v180
    v_xor_b32 v49, 0x80000000, v41
    v_cos_f32 v179, v178
    v_sin_f32 v180, v178
    v_add_f32 v178, v178, v177
    v_cvt_pk_bf16_f32 v42, v179, v180
    v_xor_b32 v50, 0x80000000, v42
    v_cos_f32 v179, v178
    v_sin_f32 v180, v178
    v_fma_f32 v178, s76, v177, v178
    v_cvt_pk_bf16_f32 v43, v179, v180
    v_xor_b32 v51, 0x80000000, v43
    v_cos_f32 v179, v178
    v_sin_f32 v180, v178
    v_add_f32 v178, v178, v177
    v_cvt_pk_bf16_f32 v44, v179, v180
    v_xor_b32 v52, 0x80000000, v44
    v_cos_f32 v179, v178
    v_sin_f32 v180, v178
    v_add_f32 v178, v178, v177
    v_cvt_pk_bf16_f32 v45, v179, v180
    v_xor_b32 v53, 0x80000000, v45
    v_cos_f32 v179, v178
    v_sin_f32 v180, v178
    v_add_f32 v178, v178, v177
    v_cvt_pk_bf16_f32 v46, v179, v180
    v_xor_b32 v54, 0x80000000, v46
    v_cos_f32 v179, v178
    v_sin_f32 v180, v178
    v_fma_f32 v178, s76, v177, v178
    v_cvt_pk_bf16_f32 v47, v179, v180
    v_xor_b32 v55, 0x80000000, v47
    v_lshlrev_b32 v179, 26, v176
    v_sub_u32 v180, 0, v176
    v_lshlrev_b32 v180, 26, v180
    v_and_b32 v179, 0x80000000, v179
    v_and_b32 v180, 0x80000000, v180
    s_mov_b64 exec, 0xffff
    v_or_b32 v40, 0x3f803f80, v179
    v_or_b32 v48, 0x3f803f80, v180
    s_mov_b64 exec, -1
    v_mov_b32 v164, -1
    v_mov_b32 v165, -1
    v_mov_b32 v166, -1
    v_mov_b32 v167, -1
    v_and_b32 v168, 1, v2
    v_lshlrev_b32 v168, 13, v168
    v_lshl_add_u32 v168, v1, 3, v168
    v_lshrrev_b32 v169, 5, v0
    v_lshl_add_u32 v168, v169, 23, v168
    s_cmp_ge_u32 s64, 28
    s_cbranch_scc1 rp_skip8
    s_add_u32 m0, s91, 139264
    s_nop 0
    buffer_load_dwordx4 v12, s[16:19], s84 offen lds
    s_add_u32 s84, s84, 114688
    s_add_u32 m0, s91, 143360
    s_nop 0
    buffer_load_dwordx4 v12, s[16:19], s84 offen lds
    s_add_u32 s84, s84, 114688
    s_add_u32 m0, s91, 147456
    s_nop 0
    buffer_load_dwordx4 v12, s[16:19], s84 offen lds
    s_add_u32 s84, s84, 114688
    s_add_u32 m0, s91, 151552
    s_nop 0
    buffer_load_dwordx4 v12, s[16:19], s84 offen lds
    s_add_u32 s84, s84, 114688
    s_add_u32 m0, s91, 155648
    s_nop 0
    buffer_load_dwordx4 v12, s[16:19], s84 offen lds
    s_add_u32 s84, s84, 114688
    s_add_u32 m0, s91, 159744
    s_nop 0
    buffer_load_dwordx4 v12, s[16:19], s84 offen lds
    s_add_u32 s84, s84, 114688
rp_skip8:
    buffer_load_dword v252, v252, s[20:23], 0 offen
    buffer_load_ushort v4, v160, s[28:31], 0 offen
    s_andn2_b32 s78, s51, 8192
    buffer_store_dwordx2 v[164:165], v168, s[8:11], s78 offen sc1
    s_cmp_ge_u32 s64, 28
    s_cbranch_scc1 rp_done
    v_lshrrev_b32 v13, 2, v0
    v_and_b32 v14, 3, v0
    s_lshl_b32 s76, s62, 5
    s_add_u32 s76, s76, 106496
    v_lshl_add_u32 v14, v14, 3, s76
    v_lshl_add_u32 v12, v13, 7, v14
    s_lshl_b32 s83, s64, 2
    s_add_u32 s83, s83, s62
    s_cmp_ge_u32 s83, 56
    s_cselect_b32 s77, 56, 0
    s_cselect_b32 s79, 0, 448
    s_sub_u32 s76, s83, s77
    s_mul_i32 s77, s76, 37
    s_lshr_b32 s77, s77, 8
    s_mul_i32 s77, s77, 540224
    s_lshl_b32 s76, s76, 6
    s_add_u32 s76, s76, s77
    s_add_u32 s76, s76, s79
    s_add_u32 s82, s76, 50432000
    s_add_u32 s83, s82, 8192
    s_waitcnt vmcnt(3)
    s_barrier
    ds_read_b64_tr_b16 v[64:65], v12 offset:0
    ds_read_b64_tr_b16 v[66:67], v12 offset:2048
    ds_read_b64_tr_b16 v[68:69], v12 offset:4096
    ds_read_b64_tr_b16 v[70:71], v12 offset:6144
    ds_read_b64_tr_b16 v[72:73], v12 offset:8192
    ds_read_b64_tr_b16 v[74:75], v12 offset:10240
    ds_read_b64_tr_b16 v[76:77], v12 offset:12288
    ds_read_b64_tr_b16 v[78:79], v12 offset:14336
    ds_read_b64_tr_b16 v[80:81], v12 offset:16384
    ds_read_b64_tr_b16 v[82:83], v12 offset:18432
    ds_read_b64_tr_b16 v[84:85], v12 offset:20480
    ds_read_b64_tr_b16 v[86:87], v12 offset:22528
    ds_read_b64_tr_b16 v[88:89], v12 offset:24576
    ds_read_b64_tr_b16 v[90:91], v12 offset:26624
    s_waitcnt lgkmcnt(0)
    v_mfma_f32_16x16x32_bf16 v[120:123], v[64:67], v[60:63], 0
    v_mfma_f32_16x16x32_bf16 v[120:123], v[68:71], v[60:63], v[120:123]
    v_mfma_f32_16x16x32_bf16 v[120:123], v[72:75], v[60:63], v[120:123]
    v_mfma_f32_16x16x32_bf16 v[120:123], v[76:79], v[60:63], v[120:123]
    v_mfma_f32_16x16x32_bf16 v[120:123], v[80:83], v[60:63], v[120:123]
    v_mfma_f32_16x16x32_bf16 v[120:123], v[84:87], v[60:63], v[120:123]
    v_mfma_f32_16x16x32_bf16 v[120:123], v[88:91], v[60:63], v[120:123]
    ds_read_b64_tr_b16 v[92:93], v12 offset:28672
    ds_read_b64_tr_b16 v[94:95], v12 offset:30720
    ds_read_b64_tr_b16 v[96:97], v12 offset:32768
    ds_read_b64_tr_b16 v[98:99], v12 offset:34816
    ds_read_b64_tr_b16 v[100:101], v12 offset:36864
    ds_read_b64_tr_b16 v[102:103], v12 offset:38912
    ds_read_b64_tr_b16 v[104:105], v12 offset:40960
    ds_read_b64_tr_b16 v[106:107], v12 offset:43008
    ds_read_b64_tr_b16 v[108:109], v12 offset:45056
    ds_read_b64_tr_b16 v[110:111], v12 offset:47104
    ds_read_b64_tr_b16 v[112:113], v12 offset:49152
    ds_read_b64_tr_b16 v[114:115], v12 offset:51200
    ds_read_b64_tr_b16 v[116:117], v12 offset:53248
    ds_read_b64_tr_b16 v[118:119], v12 offset:55296
    s_waitcnt lgkmcnt(0)
    v_mfma_f32_16x16x32_bf16 v[120:123], v[92:95], v[60:63], v[120:123]
    v_mfma_f32_16x16x32_bf16 v[120:123], v[96:99], v[60:63], v[120:123]
    v_mfma_f32_16x16x32_bf16 v[120:123], v[100:103], v[60:63], v[120:123]
    v_mfma_f32_16x16x32_bf16 v[120:123], v[104:107], v[60:63], v[120:123]
    v_mfma_f32_16x16x32_bf16 v[120:123], v[108:111], v[60:63], v[120:123]
    v_mfma_f32_16x16x32_bf16 v[120:123], v[112:115], v[60:63], v[120:123]
    v_mfma_f32_16x16x32_bf16 v[120:123], v[116:119], v[60:63], v[120:123]
    s_mov_b32 exec_lo, 0x00010001
    s_mov_b32 exec_hi, 0x00010001
    s_nop 5
    buffer_store_dwordx4 v[120:123], v0, s[8:11], s82 offen sc1
    s_mov_b64 exec, -1
rp_done:
    v_lshrrev_b32 v8, 1, v1
    v_xor_b32 v8, v8, v2
    v_lshlrev_b32 v8, 4, v8
    v_lshl_add_u32 v8, v1, 7, v8
    v_add_u32 v8, s94, v8
    v_xor_b32 v9, 64, v8
    v_mov_b32 v15, 0
    s_add_u32 m0, s94, 0
    s_nop 0
    buffer_load_dwordx4 v20, s[4:7], 0 offen offset:0 sc1 lds
    s_add_u32 m0, s94, 1024
    s_nop 0
    buffer_load_dwordx4 v21, s[4:7], 0 offen offset:0 sc1 lds
    s_add_u32 m0, s94, 1920
    s_nop 0
    buffer_load_dwordx4 v20, s[4:7], 0 offen offset:128 sc1 lds
    s_add_u32 m0, s94, 2944
    s_nop 0
    buffer_load_dwordx4 v21, s[4:7], 0 offen offset:128 sc1 lds
    s_add_u32 m0, s94, 3840
    s_nop 0
    buffer_load_dwordx4 v20, s[4:7], 0 offen offset:256 sc1 lds
    s_add_u32 m0, s94, 4864
    s_nop 0
    buffer_load_dwordx4 v21, s[4:7], 0 offen offset:256 sc1 lds
    s_add_u32 m0, s94, 5760
    s_nop 0
    buffer_load_dwordx4 v20, s[4:7], 0 offen offset:384 sc1 lds
    s_add_u32 m0, s94, 6784
    s_nop 0
    buffer_load_dwordx4 v21, s[4:7], 0 offen offset:384 sc1 lds
    s_add_u32 m0, s94, 7680
    s_nop 0
    buffer_load_dwordx4 v20, s[4:7], 0 offen offset:512 sc1 lds
    s_add_u32 m0, s94, 8704
    s_nop 0
    buffer_load_dwordx4 v21, s[4:7], 0 offen offset:512 sc1 lds
    s_add_u32 m0, s94, 9600
    s_nop 0
    buffer_load_dwordx4 v20, s[4:7], 0 offen offset:640 sc1 lds
    s_add_u32 m0, s94, 10624
    s_nop 0
    buffer_load_dwordx4 v21, s[4:7], 0 offen offset:640 sc1 lds
    s_add_u32 m0, s94, 11520
    s_nop 0
    buffer_load_dwordx4 v20, s[4:7], 0 offen offset:768 sc1 lds
    s_add_u32 m0, s94, 12544
    s_nop 0
    buffer_load_dwordx4 v21, s[4:7], 0 offen offset:768 sc1 lds
xo_have:
    s_mul_i32 s83, s62, 8448
    s_add_u32 s84, s83, 106496
    s_add_u32 s83, s83, 57344
    s_mov_b32 s82, s94
    v_lshrrev_b32 v163, 5, v0
    v_xor_b32 v23, v0, v163
    v_and_b32 v23, 31, v23
    v_lshlrev_b32 v23, 4, v23
    v_lshl_add_u32 v23, v163, 18, v23
    v_and_b32 v163, 1, v1
    v_xor_b32 v20, v2, v163
    v_lshlrev_b32 v20, 4, v20
    v_lshl_add_u32 v20, v163, 9, v20
    v_lshrrev_b32 v163, 1, v1
    v_mul_u32_u24 v163, 1056, v163
    v_add_u32 v163, v163, v20
    v_add_u32 v20, s82, v163
    v_add_u32 v21, s83, v163
    v_add_u32 v22, s84, v163
    s_waitcnt vmcnt(0)
    ds_read_b128 v[176:179], v8 offset:0
    ds_read_b128 v[180:183], v9 offset:0
    ds_read_b128 v[184:187], v8 offset:2048
    ds_read_b128 v[188:191], v9 offset:2048
    ds_read_b128 v[192:195], v8 offset:4096
    ds_read_b128 v[196:199], v9 offset:4096
    ds_read_b128 v[200:203], v8 offset:6144
    ds_read_b128 v[204:207], v9 offset:6144
    ds_read_b128 v[208:211], v8 offset:8192
    ds_read_b128 v[212:215], v9 offset:8192
    ds_read_b128 v[216:219], v8 offset:10240
    ds_read_b128 v[220:223], v9 offset:10240
    ds_read_b128 v[224:227], v8 offset:12288
    ds_read_b128 v[228:231], v9 offset:12288
    s_waitcnt lgkmcnt(0)
    s_add_u32 m0, s82, 0
    s_add_u32 s95, s62, 0
    s_bitcmp1_b32 s95, 1
    s_cselect_b32 s77, s69, s64
    s_and_b32 s95, s95, 1
    s_lshl_b32 s95, s95, 10
    s_add_u32 s95, s95, s77
    s_lshl_b32 s95, s95, 12
    s_add_u32 s95, s95, s91
    s_add_u32 s95, s95, 0
    buffer_load_dwordx4 v23, s[20:23], s95 offen lds
    s_add_u32 m0, s82, 1056
    s_add_u32 s95, s95, 524288
    buffer_load_dwordx4 v23, s[20:23], s95 offen lds
    s_add_u32 m0, s82, 2112
    s_add_u32 s95, s95, 524288
    buffer_load_dwordx4 v23, s[20:23], s95 offen lds
    s_add_u32 m0, s82, 3168
    s_add_u32 s95, s95, 524288
    buffer_load_dwordx4 v23, s[20:23], s95 offen lds
    s_add_u32 m0, s82, 4224
    s_add_u32 s95, s95, 524288
    buffer_load_dwordx4 v23, s[20:23], s95 offen lds
    s_add_u32 m0, s82, 5280
    s_add_u32 s95, s95, 524288
    buffer_load_dwordx4 v23, s[20:23], s95 offen lds
    s_add_u32 m0, s82, 6336
    s_add_u32 s95, s95, 524288
    buffer_load_dwordx4 v23, s[20:23], s95 offen lds
    s_add_u32 m0, s82, 7392
    s_add_u32 s95, s95, 524288
    buffer_load_dwordx4 v23, s[20:23], s95 offen lds
    s_barrier
    s_branch a1_join
finish:
done:
    s_endpgm
codeend:
.section .rodata,"a"
.p2align 6
.amdhsa_kernel interleave_layers__spectral_fnet__mixer_gmlp__prompt_kernel
  .amdhsa_next_free_vgpr 512
  .amdhsa_next_free_sgpr 102
  .amdhsa_accum_offset 256
  .amdhsa_group_segment_fixed_size 0
  .amdhsa_kernarg_size 104
  .amdhsa_user_sgpr_count 2
  .amdhsa_user_sgpr_kernarg_segment_ptr 1
  .amdhsa_system_sgpr_workgroup_id_x 1
.end_amdhsa_kernel
```
